```python
import torch

def _softmax(x, axis=-1):
    return torch.softmax(x, dim=axis)
def _gelu(x):
    return torch.nn.functional.gelu(x, approximate="tanh")
def _silu(x):
    return torch.nn.functional.silu(x)
def _sigmoid(x):
    return torch.sigmoid(x)
def _layernorm(x, axis=-1, eps=1e-5):
    m = x.mean(dim=axis, keepdim=True)
    v = x.var(dim=axis, keepdim=True, unbiased=False)
    return (x - m) / torch.sqrt(v + eps)
def _scatter_add(tgt, idx, src, axis=0):
    return tgt.clone().index_add_(axis, idx, src)
def _segment_sum(src, seg, n):
    out = torch.zeros((n,) + src.shape[1:], dtype=src.dtype)
    return out.index_add_(0, seg, src)
def _pad(x, pw):
    flat = tuple(v for pair in reversed(pw) for v in pair)
    return torch.nn.functional.pad(x, flat)

kernel_name = 'recurrent_scan__sliding_local_dilated__geglu_ffn__prompt'

def setup_inputs():

    _w = (lambda a: (lambda t: t.to(torch.bfloat16) if t.is_floating_point() else t)(torch.as_tensor(a)))
    def _A_setup():
        B, S, D = 1, 2048, 576
        return {
            "x": _w((lambda *s: torch.randn(*s, dtype=torch.bfloat16) * 0.05)(B, S, D)),
            "wqkv": _w((lambda *s: torch.randn(*s, dtype=torch.bfloat16) * 0.05)(D, 3 * D)),
            "wo": _w((lambda *s: torch.randn(*s, dtype=torch.bfloat16) * 0.05)(D, D)),
        }
    _A_in = _A_setup()

    def _B_setup():
        B, S, D, F = 1, 2048, 576, 4608
        return {
            "x": _w((lambda *s: torch.randn(*s, dtype=torch.bfloat16) * 0.05)(B, S, D)),
            "w_gate": _w((lambda *s: torch.randn(*s, dtype=torch.bfloat16) * 0.05)(D, F)),
            "w_up": _w((lambda *s: torch.randn(*s, dtype=torch.bfloat16) * 0.05)(D, F)),
            "w_down": _w((lambda *s: torch.randn(*s, dtype=torch.bfloat16) * 0.05)(F, D)),
        }
    _B_in = _B_setup()

    return {
        "A_x": _A_in["x"],
        "A_wqkv": _A_in["wqkv"],
        "A_wo": _A_in["wo"],
        "B_x": _B_in["x"],
        "B_w_gate": _B_in["w_gate"],
        "B_w_up": _B_in["w_up"],
        "B_w_down": _B_in["w_down"],
    }

def reference(A_x, A_wqkv, A_wo, B_x, B_w_gate, B_w_up, B_w_down):
    def _A_ref(x, wqkv, wo):
        B, S, D = x.shape
        H = 32; Dh = D // H
        W, dil = 8, 2
        qkv = (lambda x, *d: x.permute(*d))((x @ wqkv).reshape(B, S, 3, H, Dh), 2, 0, 3, 1, 4)
        q, k, v = qkv[0], qkv[1], qkv[2]
        scale = Dh ** -0.5
        pos = torch.arange(S)
        off = torch.arange(W) * dil
        idx = pos[:, None] - off[None, :]
        mask = idx >= 0
        idx_c = torch.where(mask, idx, 0).reshape(-1)
        kg = k[:, :, idx_c, :].reshape(B, H, S, W, Dh)
        vg = v[:, :, idx_c, :].reshape(B, H, S, W, Dh)
        logits = torch.einsum("bhsd,bhswd->bhsw", q, kg) * scale
        logits = torch.where(mask[None, None, :, :], logits, -1e9)
        attn = _softmax(logits, axis=-1)
        o = torch.einsum("bhsw,bhswd->bhsd", attn, vg)
        return (lambda x, *d: x.permute(*d))(o, 0, 2, 1, 3).reshape(B, S, D) @ wo

    def _B_ref(x, w_gate, w_up, w_down):
        return (_gelu(x @ w_gate) * (x @ w_up)) @ w_down

    x = A_x
    xn = _layernorm(x, axis=-1)
    s = _A_ref(xn, A_wqkv, A_wo)
    g = _silu(_B_ref(xn, B_w_gate, B_w_up, B_w_down))
    return x + s * g
```

```asm
; @launch kernel=gemm1_kernel grid=(256,1,1) block=(256,1,1) lds=163840
.amdgcn_target "amdgcn-amd-amdhsa--gfx950"
.text
.p2align 12
.globl gemm1_kernel
.p2align 8
.type gemm1_kernel,@function
gemm1_kernel:
    s_cmp_ge_u32 s2, 256
    s_cbranch_scc1 K1_done
    s_mov_b32 s4, s2
    s_mov_b32 s90, 0
K1_task:
    s_load_dwordx2 s[92:93], s[0:1], 0
    s_load_dwordx2 s[16:17], s[0:1], 8
    s_load_dwordx2 s[6:7], s[0:1], 32
    s_load_dwordx2 s[8:9], s[0:1], 40
    s_load_dwordx2 s[10:11], s[0:1], 72
    s_load_dwordx2 s[80:81], s[0:1], 48
    s_load_dwordx2 s[96:97], s[0:1], 64
    s_load_dwordx2 s[100:101], s[0:1], 16
    v_and_b32 v208, 63, v0
    s_getpc_b64 s[72:73]
CT1:
    s_add_u32 s72, s72, CT0E-CT1
    s_addc_u32 s73, s73, 0
    s_mov_b32 s74, K1_polled-CT0E
    s_mov_b32 s75, 0x00020000
    v_lshlrev_b32 v124, 7, v208
    buffer_load_dword v125, v124, s[72:75], 0 offen
CT0E:
    v_lshrrev_b32 v219, 6, v0
    s_nop 0
    v_readfirstlane_b32 s36, v219
    s_and_b32 s51, s2, 7
    s_bfe_u32 s37, s2, 0x30003
    s_lshr_b32 s52, s2, 6
    s_lshl_b32 s38, s51, 2
    s_add_u32 s38, s38, s52
    s_lshr_b32 s5, s4, 8
    s_or_b32 s5, s5, s38
    s_lshl_b32 s3, s37, 8
    s_lshl_b32 s51, s38, 3
    s_add_u32 s3, s3, s51
    s_lshl_b32 s51, s36, 2
    s_add_u32 s51, s51, s3
    v_lshrrev_b32 v4, 4, v208
    v_add_u32 v3, s51, v4
    v_and_b32 v4, 15, v208
    v_mul_u32_u24 v7, 1152, v3
    v_lshl_add_u32 v5, v4, 4, v7
    v_lshl_add_u32 v7, v4, 3, v7
    s_mov_b32 s94, 2359296
    s_mov_b32 s95, 0x00020000
    s_waitcnt lgkmcnt(0)
    s_bitcmp1_b32 s5, 0
    s_cbranch_scc1 K1_nox
    buffer_load_dwordx4 v[12:15], v5, s[92:95], 0 offen offset:0
    buffer_load_dwordx4 v[16:19], v5, s[92:95], 0 offen offset:256
    buffer_load_dwordx4 v[20:23], v5, s[92:95], 0 offen offset:512
    buffer_load_dwordx4 v[24:27], v5, s[92:95], 0 offen offset:768
    buffer_load_dwordx2 v[28:29], v7, s[92:95], 0 offen offset:1024
K1_nox:
    s_mov_b32 s98, 256
    s_mov_b32 s99, 0x00020000
    s_add_u32 s76, s10, 3145728
    s_addc_u32 s77, s11, 0
    s_mov_b32 s78, 557056
    s_mov_b32 s79, 0x00020000
    s_lshl_b32 s85, s37, 5
    s_add_u32 s84, s85, s38
    s_lshl_b32 s84, s84, 8
    s_lshl_b32 s85, s85, 8
    s_and_b32 s51, s4, 0x100
    s_or_b32 s51, s51, s36
    s_lshl_b32 s52, s37, 12
    s_lshl_b32 s53, s38, 5
    s_add_u32 s52, s52, s53
    s_add_u32 s52, s52, 524288
    s_cmp_eq_u32 s51, 0
    s_cselect_b32 s52, s52, 1048576
    s_cselect_b32 s51, s84, 1048576
    v_mov_b32 v8, 0
    v_lshlrev_b32 v118, 2, v208
    s_mov_b64 exec, 0x1ff
    buffer_store_dword v8, v118, s[76:79], s51 offen sc0 sc1
    v_lshlrev_b32 v9, 10, v208
    s_mov_b64 exec, 0xf
    buffer_store_dword v8, v9, s[76:79], s52 offen sc0 sc1
    s_mov_b64 exec, -1
    s_lshr_b32 s51, s38, 1
    s_and_b32 s52, s38, 1
    s_lshr_b32 s53, s38, 2
    s_mul_i32 s68, s53, 18
    s_and_b32 s53, s51, 1
    s_add_u32 s40, s68, s53
    s_add_u32 s40, s40, 12
    s_and_b32 s53, s38, 3
    s_lshl_b32 s53, s53, 1
    s_add_u32 s68, s68, s53
    s_sub_u32 s69, s40, s68
    s_sub_u32 s69, s69, 5
    s_lshl_b32 s69, s69, 10
    s_sub_u32 s39, 5, s52
    s_bfm_b32 s53, s51, 0
    s_and_b32 s53, s53, 65365
    s_bcnt1_i32_b32 s53, s53
    s_min_u32 s53, s53, 11
    s_lshl_b32 s53, s53, 5
    s_add_u32 s53, s53, 3072
    s_mul_i32 s41, s51, 192
    s_mov_b32 s47, 65365
    s_bitcmp1_b32 s47, s51
    s_cselect_b32 s47, 1, 0
    s_cselect_b32 s53, s53, 1073741824
    s_cmp_eq_u32 s52, 1
    s_cselect_b32 s47, 3, s47
    s_cselect_b32 s41, s41, s53
    s_cselect_b32 s53, 64, 0
    s_add_u32 s43, s41, 128
    s_and_b32 s44, s41, s53
    s_cselect_b32 s43, s41, s43
    s_add_u32 s41, s41, s44
    s_add_u32 s42, s41, s53
    s_add_u32 s44, s43, 32
    s_lshr_b32 s55, s36, 1
    s_cmp_eq_u32 s55, 1
    s_cselect_b32 s45, s42, s41
    s_cselect_b32 s46, s44, s43
    s_cselect_b32 s12, s8, s6
    s_cselect_b32 s13, s9, s7
    s_mov_b32 s14, 5308416
    s_mov_b32 s15, 0x00020000
    s_mov_b32 s18, 1990656
    s_mov_b32 s19, 0x00020000
    s_mov_b32 s32, s16
    s_mov_b32 s33, s17
    s_mov_b32 s34, 1990656
    s_mov_b32 s35, 0x00020000
    s_mov_b32 s82, 5308416
    s_mov_b32 s83, 0x00020000
    s_bfe_u32 s51, s2, 0x20001
    s_mul_i32 s65, s51, 1327104
    s_lshr_b32 s51, s2, 3
    s_lshl_b32 s51, s51, 2
    s_add_u32 s51, s51, s36
    s_bitcmp1_b32 s51, 6
    s_cselect_b32 s52, 512, 0
    s_add_u32 s51, s51, s52
    s_mul_i32 s51, s51, 1152
    s_add_u32 s65, s65, s51
    s_add_u32 s20, s10, 67108864
    s_addc_u32 s21, s11, 0
    s_mov_b32 s22, 18874368
    s_mov_b32 s23, 0x00020000
    s_add_u32 s24, s10, 20971520
    s_addc_u32 s25, s11, 0
    s_mov_b32 s26, 18874368
    s_mov_b32 s27, 0x00020000
    s_add_u32 s28, s10, 8388608
    s_addc_u32 s29, s11, 0
    s_mov_b32 s30, 7077888
    s_mov_b32 s31, 0x00020000
    s_and_b32 s64, s36, 1
    v_lshrrev_b32 v219, 3, v208
    v_and_b32 v220, 2, v219
    v_xor_b32 v220, v220, v208
    v_and_b32 v220, 7, v220
    v_mul_u32_u24 v215, 9216, v219
    v_lshl_add_u32 v215, v220, 4, v215
    s_lshl_b32 s51, s64, 6
    v_xor_b32 v248, s51, v215
    s_mul_i32 s54, s55, 12288
    s_lshl_b32 s52, s64, 10
    s_add_u32 s89, s54, s54
    s_add_u32 s54, s54, s52
    s_add_u32 s89, s89, s52
    s_mov_b32 s60, 3
    s_mul_i32 s61, s64, 73728
    s_lshl_b32 s51, s68, 6
    s_add_u32 s61, s61, s51
    s_bitcmp1_b32 s5, 0
    s_cbranch_scc1 K1_odd
    s_add_u32 m0, s89, 0
    s_nop 0
    buffer_load_dwordx4 v248, s[12:15], s61 offen lds
    s_add_u32 s61, s61, 0x24000
    s_add_u32 m0, s89, 2048
    s_nop 0
    buffer_load_dwordx4 v248, s[12:15], s61 offen lds
    s_add_u32 s61, s61, 0x24000
    s_add_u32 m0, s89, 4096
    s_nop 0
    buffer_load_dwordx4 v248, s[12:15], s61 offen lds
    s_add_u32 s61, s61, 0x24000
    s_add_u32 m0, s89, 6144
    s_nop 0
    buffer_load_dwordx4 v248, s[12:15], s61 offen lds
    s_add_u32 s61, s61, 0x24000
    s_add_u32 m0, s89, 8192
    s_nop 0
    buffer_load_dwordx4 v248, s[12:15], s61 offen lds
    s_add_u32 s61, s61, 0x24000
    s_add_u32 m0, s89, 10240
    s_nop 0
    buffer_load_dwordx4 v248, s[12:15], s61 offen lds
    s_add_u32 s61, s61, 0x24000
    s_add_u32 m0, s89, 12288
    s_nop 0
    buffer_load_dwordx4 v248, s[12:15], s61 offen lds
    s_add_u32 s61, s61, 0x24000
    s_add_u32 m0, s89, 14336
    s_nop 0
    buffer_load_dwordx4 v248, s[12:15], s61 offen lds
    s_add_u32 s61, s61, 0x24000
    s_add_u32 m0, s89, 16384
    s_nop 0
    buffer_load_dwordx4 v248, s[12:15], s61 offen lds
    s_add_u32 s61, s61, 0x24000
    s_add_u32 m0, s89, 18432
    s_nop 0
    buffer_load_dwordx4 v248, s[12:15], s61 offen lds
    s_add_u32 s61, s61, 0x24000
    s_add_u32 m0, s89, 20480
    s_nop 0
    buffer_load_dwordx4 v248, s[12:15], s61 offen lds
    s_add_u32 s61, s61, 0x24000
    s_add_u32 m0, s89, 22528
    s_nop 0
    buffer_load_dwordx4 v248, s[12:15], s61 offen lds
    s_add_u32 s61, s61, 0x24000
    v_lshrrev_b32 v219, 2, v208
    v_and_b32 v220, 3, v208
    v_lshrrev_b32 v213, 5, v208
    v_lshlrev_b32 v213, 1, v213
    v_xor_b32 v220, v213, v220
    v_lshlrev_b32 v220, 4, v220
    v_mul_u32_u24 v213, 9216, v219
    v_add_u32 v213, v213, v220
    v_mul_u32_u24 v214, 3456, v219
    s_bitcmp1_b32 s38, 0
    s_cselect_b32 s52, 48, 16
    v_and_b32 v220, s52, v220
    v_add_u32 v214, v214, v220
    s_lshl_b32 s53, s37, 3
    s_lshl_b32 s52, s36, 1
    s_add_u32 s53, s53, s52
    s_mul_i32 s53, s53, 36864
    s_add_u32 s63, s53, 36864
    v_lshlrev_b32 v219, 4, v208
    v_add_u32 v246, 18432, v219
    v_lshrrev_b32 v220, 4, v208
    v_lshlrev_b32 v209, 9, v220
    v_and_b32 v220, 1, v220
    v_lshlrev_b32 v250, 6, v220
    v_bfe_u32 v251, v208, 2, 2
    v_lshl_add_u32 v209, v251, 6, v209
    v_lshl_add_u32 v249, v209, 1, v250
    v_lshl_add_u32 v209, v220, 5, v209
    v_and_b32 v220, 3, v208
    v_lshl_add_u32 v209, v220, 3, v209
    v_lshl_add_u32 v249, v220, 3, v249
    v_bfe_u32 v220, v208, 3, 1
    v_lshl_add_u32 v249, v220, 5, v249
    v_xor_b32 v250, 32, v249
    v_xor_b32 v251, 64, v249
    v_xor_b32 v252, 96, v249
    v_xor_b32 v210, 32, v209
    v_add_u32 v211, 49152, v209
    v_add_u32 v212, 49152, v210
    v_add_u32 v244, 98304, v209
    v_add_u32 v245, 98304, v210
    v_add_u32 v216, 147456, v219
    v_and_b32 v220, 15, v208
    v_mul_u32_u24 v217, 3456, v220
    v_bfe_u32 v220, v208, 4, 1
    v_lshl_add_u32 v217, v220, 5, v217
    v_lshrrev_b32 v220, 5, v208
    v_lshl_add_u32 v217, v220, 4, v217
    v_add_u32 v247, 55296, v217
    v_mov_b32 v218, 0xbdd2d3e8
    v_lshlrev_b32 v222, 4, v208
    s_lshl_b32 s51, s37, 4
    s_lshl_b32 s52, s36, 2
    s_add_u32 s51, s51, s52
    s_mul_i32 s48, s51, 147456
    s_lshl_b32 s52, s68, 10
    s_add_u32 s48, s48, s52
    s_add_u32 s49, s48, 294912
    s_lshl_b32 s51, s37, 8
    s_lshl_b32 s52, s36, 6
    s_add_u32 s51, s51, s52
    s_mul_i32 s50, s51, 3456
    s_lshr_b32 s52, s3, 4
    s_mul_i32 s3, s52, 18432
    v_mov_b32 v119, 1
    v_mov_b32 v120, 0x0101
    v_lshlrev_b32 v121, 8, v208
    v_mov_b32 v122, 0x01010101
    v_cmp_gt_u32 vcc, 8, v208
    v_mov_b32 v123, 1
    v_cndmask_b32 v122, v119, v122, vcc
    s_and_b32 s51, s2, 7
    s_lshl_b32 s51, s51, 1
    s_bfm_b32 s52, s51, 0
    s_and_b32 s52, s52, 65365
    s_bcnt1_i32_b32 s52, s52
    s_lshl_b32 s52, s52, 5
    s_mul_i32 s51, s51, 192
    s_sub_u32 s55, s52, s51
    s_add_u32 s55, s55, 2688
    v_and_b32 v6, 15, v3
    v_lshlrev_b32 v6, 4, v6
    v_add_u32 v6, 122880, v6
    v_lshrrev_b32 v7, 1, v4
    v_mul_u32_u24 v7, 272, v7
    v_add_u32 v7, v7, v6
    v_and_b32 v5, 1, v4
    v_lshl_add_u32 v7, v5, 3, v7
    v_mul_u32_u24 v5, 272, v4
    v_add_u32 v6, v6, v5
    v_lshrrev_b32 v116, 4, v208
    v_mul_u32_u24 v116, 272, v116
    v_lshl_add_u32 v116, v4, 4, v116
    s_mul_i32 s86, s36, 1088
    s_add_u32 s86, s86, 122880
    v_add_u32 v116, s86, v116
    s_lshl_b32 s86, s36, 10
    v_add_u32 v117, s86, v219
    s_mov_b32 s51, 0x3f803f80
    s_mov_b32 s52, 0x3f80
    s_mov_b32 s62, 0x3f800000
    s_waitcnt vmcnt(18)
    v_dot2_f32_bf16 v8, v12, s51, 0
    v_dot2_f32_bf16 v10, v12, v12, 0
    v_dot2_f32_bf16 v9, v13, s51, 0
    v_dot2_f32_bf16 v11, v13, v13, 0
    v_dot2_f32_bf16 v8, v14, s51, v8
    v_dot2_f32_bf16 v10, v14, v14, v10
    v_dot2_f32_bf16 v9, v15, s51, v9
    v_dot2_f32_bf16 v11, v15, v15, v11
    s_waitcnt vmcnt(17)
    v_dot2_f32_bf16 v8, v16, s51, v8
    v_dot2_f32_bf16 v10, v16, v16, v10
    v_dot2_f32_bf16 v9, v17, s51, v9
    v_dot2_f32_bf16 v11, v17, v17, v11
    v_dot2_f32_bf16 v8, v18, s51, v8
    v_dot2_f32_bf16 v10, v18, v18, v10
    v_dot2_f32_bf16 v9, v19, s51, v9
    v_dot2_f32_bf16 v11, v19, v19, v11
    s_waitcnt vmcnt(16)
    v_dot2_f32_bf16 v8, v20, s51, v8
    v_dot2_f32_bf16 v10, v20, v20, v10
    v_dot2_f32_bf16 v9, v21, s51, v9
    v_dot2_f32_bf16 v11, v21, v21, v11
    v_dot2_f32_bf16 v8, v22, s51, v8
    v_dot2_f32_bf16 v10, v22, v22, v10
    v_dot2_f32_bf16 v9, v23, s51, v9
    v_dot2_f32_bf16 v11, v23, v23, v11
    s_waitcnt vmcnt(15)
    v_dot2_f32_bf16 v8, v24, s51, v8
    v_dot2_f32_bf16 v10, v24, v24, v10
    v_dot2_f32_bf16 v9, v25, s51, v9
    v_dot2_f32_bf16 v11, v25, v25, v11
    v_dot2_f32_bf16 v8, v26, s51, v8
    v_dot2_f32_bf16 v10, v26, v26, v10
    v_dot2_f32_bf16 v9, v27, s51, v9
    v_dot2_f32_bf16 v11, v27, v27, v11
    s_waitcnt vmcnt(14)
    v_dot2_f32_bf16 v8, v28, s51, v8
    v_dot2_f32_bf16 v10, v28, v28, v10
    v_dot2_f32_bf16 v9, v29, s51, v9
    v_dot2_f32_bf16 v11, v29, v29, v11
    s_nop 1
    v_add_f32 v8, v8, v9
    v_add_f32 v10, v10, v11
    s_nop 0
    v_add_f32_dpp v8, v8, v8 quad_perm:[1,0,3,2] row_mask:0xf bank_mask:0xf
    v_add_f32_dpp v10, v10, v10 quad_perm:[1,0,3,2] row_mask:0xf bank_mask:0xf
    s_nop 0
    v_add_f32_dpp v8, v8, v8 quad_perm:[2,3,0,1] row_mask:0xf bank_mask:0xf
    v_add_f32_dpp v10, v10, v10 quad_perm:[2,3,0,1] row_mask:0xf bank_mask:0xf
    s_nop 0
    v_add_f32_dpp v8, v8, v8 row_half_mirror row_mask:0xf bank_mask:0xf
    v_add_f32_dpp v10, v10, v10 row_half_mirror row_mask:0xf bank_mask:0xf
    s_nop 0
    v_add_f32_dpp v8, v8, v8 row_mirror row_mask:0xf bank_mask:0xf
    v_add_f32_dpp v10, v10, v10 row_mirror row_mask:0xf bank_mask:0xf
    v_mul_f32 v8, 0x3ae38e39, v8
    v_mul_f32 v10, 0x3ae38e39, v10
    v_fma_f32 v10, -v8, v8, v10
    v_max_f32 v10, 0, v10
    v_cvt_pk_bf16_f32 v9, v8, v10
    v_and_b32 v10, 0xffff0000, v9
    v_lshlrev_b32 v8, 16, v9
    v_add_f32 v10, 0x3727c5ac, v10
    v_xor_b32 v8, 0x80000000, v8
    v_cvt_pk_bf16_f32 v10, v10, v10
    v_lshlrev_b32 v10, 16, v10
    v_sqrt_f32 v10, v10
    v_dot2_f32_bf16 v32, v12, s52, v8
    v_dot2_f32_bf16 v33, v12, s62, v8
    v_dot2_f32_bf16 v34, v13, s52, v8
    v_dot2_f32_bf16 v35, v13, s62, v8
    v_cvt_pk_bf16_f32 v10, v10, v10
    v_lshlrev_b32 v10, 16, v10
    v_rcp_f32 v10, v10
    v_dot2_f32_bf16 v36, v14, s52, v8
    v_dot2_f32_bf16 v37, v14, s62, v8
    v_dot2_f32_bf16 v38, v15, s52, v8
    v_dot2_f32_bf16 v39, v15, s62, v8
    v_dot2_f32_bf16 v40, v16, s52, v8
    v_dot2_f32_bf16 v41, v16, s62, v8
    v_dot2_f32_bf16 v42, v17, s52, v8
    v_dot2_f32_bf16 v43, v17, s62, v8
    v_dot2_f32_bf16 v44, v18, s52, v8
    v_dot2_f32_bf16 v45, v18, s62, v8
    v_dot2_f32_bf16 v46, v19, s52, v8
    v_dot2_f32_bf16 v47, v19, s62, v8
    v_dot2_f32_bf16 v48, v20, s52, v8
    v_dot2_f32_bf16 v49, v20, s62, v8
    v_dot2_f32_bf16 v50, v21, s52, v8
    v_dot2_f32_bf16 v51, v21, s62, v8
    v_dot2_f32_bf16 v52, v22, s52, v8
    v_dot2_f32_bf16 v53, v22, s62, v8
    v_dot2_f32_bf16 v54, v23, s52, v8
    v_dot2_f32_bf16 v55, v23, s62, v8
    v_dot2_f32_bf16 v56, v24, s52, v8
    v_dot2_f32_bf16 v57, v24, s62, v8
    v_dot2_f32_bf16 v58, v25, s52, v8
    v_dot2_f32_bf16 v59, v25, s62, v8
    v_dot2_f32_bf16 v60, v26, s52, v8
    v_dot2_f32_bf16 v61, v26, s62, v8
    v_dot2_f32_bf16 v62, v27, s52, v8
    v_dot2_f32_bf16 v63, v27, s62, v8
    v_dot2_f32_bf16 v64, v28, s52, v8
    v_dot2_f32_bf16 v65, v28, s62, v8
    v_dot2_f32_bf16 v66, v29, s52, v8
    v_dot2_f32_bf16 v67, v29, s62, v8
    v_cvt_pk_bf16_f32 v12, v32, v33
    v_cvt_pk_bf16_f32 v13, v34, v35
    v_cvt_pk_bf16_f32 v14, v36, v37
    v_cvt_pk_bf16_f32 v15, v38, v39
    v_cvt_pk_bf16_f32 v16, v40, v41
    v_cvt_pk_bf16_f32 v17, v42, v43
    v_cvt_pk_bf16_f32 v18, v44, v45
    v_cvt_pk_bf16_f32 v19, v46, v47
    v_cvt_pk_bf16_f32 v20, v48, v49
    v_cvt_pk_bf16_f32 v21, v50, v51
    v_cvt_pk_bf16_f32 v22, v52, v53
    v_cvt_pk_bf16_f32 v23, v54, v55
    v_cvt_pk_bf16_f32 v24, v56, v57
    v_cvt_pk_bf16_f32 v25, v58, v59
    v_cvt_pk_bf16_f32 v26, v60, v61
    v_cvt_pk_bf16_f32 v27, v62, v63
    v_cvt_pk_bf16_f32 v28, v64, v65
    v_cvt_pk_bf16_f32 v29, v66, v67
    v_lshlrev_b32 v32, 16, v12
    v_and_b32 v33, 0xffff0000, v12
    v_lshlrev_b32 v34, 16, v13
    v_and_b32 v35, 0xffff0000, v13
    v_lshlrev_b32 v36, 16, v14
    v_and_b32 v37, 0xffff0000, v14
    v_lshlrev_b32 v38, 16, v15
    v_and_b32 v39, 0xffff0000, v15
    v_lshlrev_b32 v40, 16, v16
    v_and_b32 v41, 0xffff0000, v16
    v_lshlrev_b32 v42, 16, v17
    v_and_b32 v43, 0xffff0000, v17
    v_lshlrev_b32 v44, 16, v18
    v_and_b32 v45, 0xffff0000, v18
    v_lshlrev_b32 v46, 16, v19
    v_and_b32 v47, 0xffff0000, v19
    v_lshlrev_b32 v48, 16, v20
    v_and_b32 v49, 0xffff0000, v20
    v_lshlrev_b32 v50, 16, v21
    v_and_b32 v51, 0xffff0000, v21
    v_lshlrev_b32 v52, 16, v22
    v_and_b32 v53, 0xffff0000, v22
    v_lshlrev_b32 v54, 16, v23
    v_and_b32 v55, 0xffff0000, v23
    v_lshlrev_b32 v56, 16, v24
    v_and_b32 v57, 0xffff0000, v24
    v_lshlrev_b32 v58, 16, v25
    v_and_b32 v59, 0xffff0000, v25
    v_lshlrev_b32 v60, 16, v26
    v_and_b32 v61, 0xffff0000, v26
    v_lshlrev_b32 v62, 16, v27
    v_and_b32 v63, 0xffff0000, v27
    v_lshlrev_b32 v64, 16, v28
    v_and_b32 v65, 0xffff0000, v28
    v_lshlrev_b32 v66, 16, v29
    v_and_b32 v67, 0xffff0000, v29
    v_pk_mul_f32 v[32:33], v[32:33], v[10:11] op_sel_hi:[1,0]
    v_pk_mul_f32 v[34:35], v[34:35], v[10:11] op_sel_hi:[1,0]
    v_pk_mul_f32 v[36:37], v[36:37], v[10:11] op_sel_hi:[1,0]
    v_pk_mul_f32 v[38:39], v[38:39], v[10:11] op_sel_hi:[1,0]
    v_pk_mul_f32 v[40:41], v[40:41], v[10:11] op_sel_hi:[1,0]
    v_pk_mul_f32 v[42:43], v[42:43], v[10:11] op_sel_hi:[1,0]
    v_pk_mul_f32 v[44:45], v[44:45], v[10:11] op_sel_hi:[1,0]
    v_pk_mul_f32 v[46:47], v[46:47], v[10:11] op_sel_hi:[1,0]
    v_pk_mul_f32 v[48:49], v[48:49], v[10:11] op_sel_hi:[1,0]
    v_pk_mul_f32 v[50:51], v[50:51], v[10:11] op_sel_hi:[1,0]
    v_pk_mul_f32 v[52:53], v[52:53], v[10:11] op_sel_hi:[1,0]
    v_pk_mul_f32 v[54:55], v[54:55], v[10:11] op_sel_hi:[1,0]
    v_pk_mul_f32 v[56:57], v[56:57], v[10:11] op_sel_hi:[1,0]
    v_pk_mul_f32 v[58:59], v[58:59], v[10:11] op_sel_hi:[1,0]
    v_pk_mul_f32 v[60:61], v[60:61], v[10:11] op_sel_hi:[1,0]
    v_pk_mul_f32 v[62:63], v[62:63], v[10:11] op_sel_hi:[1,0]
    v_pk_mul_f32 v[64:65], v[64:65], v[10:11] op_sel_hi:[1,0]
    v_pk_mul_f32 v[66:67], v[66:67], v[10:11] op_sel_hi:[1,0]
    v_cvt_pk_bf16_f32 v12, v32, v33
    v_cvt_pk_bf16_f32 v13, v34, v35
    v_cvt_pk_bf16_f32 v14, v36, v37
    v_cvt_pk_bf16_f32 v15, v38, v39
    v_cvt_pk_bf16_f32 v16, v40, v41
    v_cvt_pk_bf16_f32 v17, v42, v43
    v_cvt_pk_bf16_f32 v18, v44, v45
    v_cvt_pk_bf16_f32 v19, v46, v47
    v_cvt_pk_bf16_f32 v20, v48, v49
    v_cvt_pk_bf16_f32 v21, v50, v51
    v_cvt_pk_bf16_f32 v22, v52, v53
    v_cvt_pk_bf16_f32 v23, v54, v55
    v_cvt_pk_bf16_f32 v24, v56, v57
    v_cvt_pk_bf16_f32 v25, v58, v59
    v_cvt_pk_bf16_f32 v26, v60, v61
    v_cvt_pk_bf16_f32 v27, v62, v63
    v_cvt_pk_bf16_f32 v28, v64, v65
    v_cvt_pk_bf16_f32 v29, v66, v67
    ds_write_b128 v6, v[12:15] offset:0
    ds_write_b128 v6, v[16:19] offset:4352
    ds_write_b128 v6, v[20:23] offset:8704
    ds_write_b128 v6, v[24:27] offset:13056
    ds_write_b64 v7, v[28:29] offset:17408
    s_cmp_lt_u32 s36, 2
    s_cselect_b32 s52, 16384, 1073741824
    s_add_u32 s52, s52, s3
    s_waitcnt lgkmcnt(0)
    s_barrier
    ds_read_b128 v[32:35], v116 offset:0
    ds_read_b128 v[36:39], v116 offset:4352
    ds_read_b128 v[40:43], v116 offset:8704
    ds_read_b128 v[44:47], v116 offset:13056
    ds_read_b128 v[48:51], v116 offset:17408
    s_waitcnt lgkmcnt(4)
    buffer_store_dwordx4 v[32:35], v117, s[20:23], s3 offen sc0 sc1
    s_add_u32 s3, s3, 4096
    s_waitcnt lgkmcnt(3)
    buffer_store_dwordx4 v[36:39], v117, s[20:23], s3 offen sc0 sc1
    s_add_u32 s3, s3, 4096
    s_waitcnt lgkmcnt(2)
    buffer_store_dwordx4 v[40:43], v117, s[20:23], s3 offen sc0 sc1
    s_add_u32 s3, s3, 4096
    s_waitcnt lgkmcnt(1)
    buffer_store_dwordx4 v[44:47], v117, s[20:23], s3 offen sc0 sc1
    s_waitcnt lgkmcnt(0)
    buffer_store_dwordx4 v[48:51], v117, s[20:23], s52 offen sc0 sc1
    s_cmp_eq_u32 s36, 0
    s_cbranch_scc0 K1_ev123
    s_waitcnt vmcnt(0)
    s_barrier
    s_add_u32 s3, s85, s38
    s_mov_b32 exec_hi, 0
    buffer_store_short v120, v121, s[76:79], s3 offen sc0 sc1
    s_movk_i32 s52, 3000
    s_mov_b64 exec, 0x1ff
    buffer_load_dword v192, v118, s[76:79], s84 offen sc1
    s_sleep 2
    buffer_load_dword v193, v118, s[76:79], s84 offen sc1
    s_sleep 2
    s_branch K1_poll
K1_ev123:
    s_waitcnt vmcnt(0)
    s_barrier
    s_cmp_eq_u32 s36, 1
    s_cbranch_scc0 K1_w123
    s_lshl_b32 s51, s37, 5
    s_mov_b64 exec, 1
    buffer_atomic_add v123, off, s[96:99], s51 sc0 sc1
    s_waitcnt vmcnt(0)
    v_cmp_eq_u32 vcc, 31, v123
    s_mov_b64 exec, 0
    s_nop 3
    s_sub_u32 exec_lo, 0, vcc_lo
    buffer_store_dword v119, v121, s[76:79], s85 offen offset:32 sc0 sc1
    s_mov_b64 exec, -1
    s_branch K1_w123
K1_odd:
    s_cmp_eq_u32 s36, 0
    s_cbranch_scc1 K1_odd0
    s_bfe_u32 s51, s38, 0x10001
    s_lshl_b32 s51, s51, 3
    s_add_u32 s51, s51, s37
    s_mul_i32 s51, s51, 110592
    s_lshr_b32 s52, s38, 2
    s_mul_i32 s52, s52, 1152
    s_add_u32 s51, s51, s52
    s_cmp_eq_u32 s36, 2
    s_cselect_b32 s56, s6, s8
    s_cselect_b32 s57, s7, s9
    s_cmp_lt_u32 s36, 2
    s_cselect_b32 s58, 0, 5308416
    s_mov_b32 s59, 0x00020000
    v_add_u32 v100, 0, v208
    v_lshrrev_b32 v101, 2, v100
    v_mul_u32_u24 v102, 5462, v101
    v_lshrrev_b32 v102, 16, v102
    v_mul_u32_u24 v102, 1658880, v102
    v_mul_u32_u24 v101, 8704, v101
    v_lshl_add_u32 v100, v100, 7, v101
    v_add_u32 v100, v100, v102
    buffer_load_dword v224, v100, s[56:59], s51 offen
    v_add_u32 v103, 64, v208
    v_lshrrev_b32 v104, 2, v103
    v_mul_u32_u24 v105, 5462, v104
    v_lshrrev_b32 v105, 16, v105
    v_mul_u32_u24 v105, 1658880, v105
    v_mul_u32_u24 v104, 8704, v104
    v_lshl_add_u32 v103, v103, 7, v104
    v_add_u32 v103, v103, v105
    buffer_load_dword v224, v103, s[56:59], s51 offen
    v_add_u32 v106, 128, v208
    v_min_u32 v106, 143, v106
    v_lshrrev_b32 v107, 2, v106
    v_mul_u32_u24 v108, 5462, v107
    v_lshrrev_b32 v108, 16, v108
    v_mul_u32_u24 v108, 1658880, v108
    v_mul_u32_u24 v107, 8704, v107
    v_lshl_add_u32 v106, v106, 7, v107
    v_add_u32 v106, v106, v108
    buffer_load_dword v224, v106, s[56:59], s51 offen
    s_cmp_eq_u32 s36, 1
    s_cbranch_scc0 K1_noct1
    s_getpc_b64 s[72:73]
CT2:
    s_add_u32 s72, s72, K1_polled-CT2
    s_addc_u32 s73, s73, 0
    s_mov_b32 s74, K1_done-K1_polled
    s_mov_b32 s75, 0x00020000
    v_lshlrev_b32 v100, 7, v208
    buffer_load_dword v101, v100, s[72:75], 0 offen
    v_add_u32 v100, 8192, v100
    buffer_load_dword v101, v100, s[72:75], 0 offen
    v_add_u32 v100, 8192, v100
    buffer_load_dword v101, v100, s[72:75], 0 offen
    v_add_u32 v100, 8192, v100
    buffer_load_dword v101, v100, s[72:75], 0 offen
    v_add_u32 v100, 8192, v100
    buffer_load_dword v101, v100, s[72:75], 0 offen
K1_noct1:
    s_sub_u32 s86, s36, 1
    s_lshl_b32 s87, s86, 13
    s_mul_i32 s86, s86, 589824
    s_lshl_b32 s88, s68, 6
    s_add_u32 s86, s86, s88
    s_mov_b32 s56, s6
    s_mov_b32 s57, s7
    s_mov_b32 s58, 5308416
    s_mov_b32 s59, 0x00020000
    s_add_u32 m0, s89, 0
    s_nop 0
    buffer_load_dwordx4 v248, s[12:15], s61 offen lds
    s_add_u32 s61, s61, 0x24000
    s_add_u32 m0, s89, 2048
    s_nop 0
    buffer_load_dwordx4 v248, s[12:15], s61 offen lds
    s_add_u32 s61, s61, 0x24000
    s_add_u32 m0, s89, 4096
    s_nop 0
    buffer_load_dwordx4 v248, s[12:15], s61 offen lds
    s_add_u32 s61, s61, 0x24000
    s_add_u32 m0, s89, 6144
    s_nop 0
    buffer_load_dwordx4 v248, s[12:15], s61 offen lds
    s_add_u32 s61, s61, 0x24000
    s_add_u32 m0, s89, 8192
    s_nop 0
    buffer_load_dwordx4 v248, s[12:15], s61 offen lds
    s_add_u32 s61, s61, 0x24000
    s_add_u32 m0, s89, 10240
    s_nop 0
    buffer_load_dwordx4 v248, s[12:15], s61 offen lds
    s_add_u32 s61, s61, 0x24000
    s_add_u32 m0, s89, 12288
    s_nop 0
    buffer_load_dwordx4 v248, s[12:15], s61 offen lds
    s_add_u32 s61, s61, 0x24000
    s_add_u32 m0, s89, 14336
    s_nop 0
    buffer_load_dwordx4 v248, s[12:15], s61 offen lds
    s_add_u32 s61, s61, 0x24000
    s_add_u32 m0, s89, 16384
    s_nop 0
    buffer_load_dwordx4 v248, s[12:15], s61 offen lds
    s_add_u32 s61, s61, 0x24000
    s_add_u32 m0, s89, 18432
    s_nop 0
    buffer_load_dwordx4 v248, s[12:15], s61 offen lds
    s_add_u32 s61, s61, 0x24000
    s_add_u32 m0, s89, 20480
    s_nop 0
    buffer_load_dwordx4 v248, s[12:15], s61 offen lds
    s_add_u32 s61, s61, 0x24000
    s_add_u32 m0, s89, 22528
    s_nop 0
    buffer_load_dwordx4 v248, s[12:15], s61 offen lds
    s_add_u32 s61, s61, 0x24000
    s_add_u32 m0, s87, 0
    s_nop 0
    buffer_load_dwordx4 v215, s[56:59], s86 offen lds
    s_add_u32 s86, s86, 147456
    s_add_u32 m0, s87, 2048
    s_nop 0
    buffer_load_dwordx4 v215, s[56:59], s86 offen lds
    s_add_u32 s86, s86, 147456
    s_add_u32 m0, s87, 4096
    s_nop 0
    buffer_load_dwordx4 v215, s[56:59], s86 offen lds
    s_add_u32 s86, s86, 147456
    s_add_u32 m0, s87, 6144
    s_nop 0
    buffer_load_dwordx4 v215, s[56:59], s86 offen lds
    s_bfe_u32 s51, s38, 0x10001
    s_lshl_b32 s51, s51, 3
    s_add_u32 s51, s51, s37
    s_mul_i32 s51, s51, 110592
    s_lshr_b32 s52, s38, 2
    s_mul_i32 s52, s52, 1152
    s_add_u32 s51, s51, s52
    s_add_u32 s51, s51, 512
    s_cmp_eq_u32 s36, 2
    s_cselect_b32 s56, s6, s8
    s_cselect_b32 s57, s7, s9
    s_cmp_lt_u32 s36, 2
    s_cselect_b32 s58, 0, 5308416
    s_mov_b32 s59, 0x00020000
    v_add_u32 v100, 0, v208
    v_min_u32 v100, 47, v100
    v_lshrrev_b32 v101, 2, v100
    v_mul_u32_u24 v102, 5462, v101
    v_lshrrev_b32 v102, 16, v102
    v_mul_u32_u24 v102, 1658880, v102
    v_mul_u32_u24 v101, 8704, v101
    v_lshl_add_u32 v100, v100, 7, v101
    v_add_u32 v100, v100, v102
    buffer_load_dword v224, v100, s[56:59], s51 offen
    v_lshrrev_b32 v219, 2, v208
    v_and_b32 v220, 3, v208
    v_lshrrev_b32 v213, 5, v208
    v_lshlrev_b32 v213, 1, v213
    v_xor_b32 v220, v213, v220
    v_lshlrev_b32 v220, 4, v220
    v_mul_u32_u24 v213, 9216, v219
    v_add_u32 v213, v213, v220
    v_mul_u32_u24 v214, 3456, v219
    s_bitcmp1_b32 s38, 0
    s_cselect_b32 s52, 48, 16
    v_and_b32 v220, s52, v220
    v_add_u32 v214, v214, v220
    s_lshl_b32 s53, s37, 3
    s_lshl_b32 s52, s36, 1
    s_add_u32 s53, s53, s52
    s_mul_i32 s53, s53, 36864
    s_add_u32 s63, s53, 36864
    v_lshlrev_b32 v219, 4, v208
    v_add_u32 v246, 18432, v219
    v_lshrrev_b32 v220, 4, v208
    v_lshlrev_b32 v209, 9, v220
    v_and_b32 v220, 1, v220
    v_lshlrev_b32 v250, 6, v220
    v_bfe_u32 v251, v208, 2, 2
    v_lshl_add_u32 v209, v251, 6, v209
    v_lshl_add_u32 v249, v209, 1, v250
    v_lshl_add_u32 v209, v220, 5, v209
    v_and_b32 v220, 3, v208
    v_lshl_add_u32 v209, v220, 3, v209
    v_lshl_add_u32 v249, v220, 3, v249
    v_bfe_u32 v220, v208, 3, 1
    v_lshl_add_u32 v249, v220, 5, v249
    v_xor_b32 v250, 32, v249
    v_xor_b32 v251, 64, v249
    v_xor_b32 v252, 96, v249
    v_xor_b32 v210, 32, v209
    v_add_u32 v211, 49152, v209
    v_add_u32 v212, 49152, v210
    v_add_u32 v244, 98304, v209
    v_add_u32 v245, 98304, v210
    v_add_u32 v216, 147456, v219
    v_and_b32 v220, 15, v208
    v_mul_u32_u24 v217, 3456, v220
    v_bfe_u32 v220, v208, 4, 1
    v_lshl_add_u32 v217, v220, 5, v217
    v_lshrrev_b32 v220, 5, v208
    v_lshl_add_u32 v217, v220, 4, v217
    v_add_u32 v247, 55296, v217
    v_mov_b32 v218, 0xbdd2d3e8
    v_lshlrev_b32 v222, 4, v208
    s_lshl_b32 s51, s37, 4
    s_lshl_b32 s52, s36, 2
    s_add_u32 s51, s51, s52
    s_mul_i32 s48, s51, 147456
    s_lshl_b32 s52, s68, 10
    s_add_u32 s48, s48, s52
    s_add_u32 s49, s48, 294912
    s_lshl_b32 s51, s37, 8
    s_lshl_b32 s52, s36, 6
    s_add_u32 s51, s51, s52
    s_mul_i32 s50, s51, 3456
    s_lshr_b32 s52, s3, 4
    s_mul_i32 s3, s52, 18432
    v_mov_b32 v119, 1
    v_mov_b32 v120, 0x0101
    v_lshlrev_b32 v121, 8, v208
    v_mov_b32 v122, 0x01010101
    v_cmp_gt_u32 vcc, 8, v208
    v_mov_b32 v123, 1
    v_cndmask_b32 v122, v119, v122, vcc
    s_and_b32 s51, s2, 7
    s_lshl_b32 s51, s51, 1
    s_bfm_b32 s52, s51, 0
    s_and_b32 s52, s52, 65365
    s_bcnt1_i32_b32 s52, s52
    s_lshl_b32 s52, s52, 5
    s_mul_i32 s51, s51, 192
    s_sub_u32 s55, s52, s51
    s_add_u32 s55, s55, 2688
K1_w123:
    s_mul_i32 s51, s37, 3
    s_add_u32 s51, s51, s36
    s_sub_u32 s51, s51, 1
    s_lshl_b32 s51, s51, 5
    s_add_u32 s51, s51, s38
    s_cmp_lt_u32 s51, 648
    s_cselect_b32 s74, 663552, 0
    s_mov_b32 s72, s100
    s_mov_b32 s73, s101
    s_mov_b32 s75, 0x00020000
    s_add_u32 s76, s10, 4194304
    s_addc_u32 s77, s11, 0
    s_mov_b32 s78, s74
    s_mov_b32 s79, 0x00020000
    s_mul_hi_u32 s84, s51, 0x0E38E38F
    s_mul_i32 s85, s84, 18
    s_sub_u32 s85, s51, s85
    s_lshl_b32 s84, s84, 5
    s_and_b32 s52, s85, 7
    s_cmp_lt_u32 s85, 16
    s_cselect_b32 s86, 1, 4
    s_cselect_b32 s87, 1, 9
    s_mul_i32 s86, s86, 20736
    s_mul_i32 s87, s87, 2304
    s_mul_i32 s52, s52, s86
    s_lshl_b32 s52, s52, 2
    s_add_u32 s84, s84, s52
    s_lshr_b32 s85, s85, 3
    s_lshl_b32 s85, s85, 3
    s_lshr_b32 s85, 0x080a00, s85
    s_and_b32 s85, s85, 255
    s_mul_i32 s85, s85, 1152
    s_add_u32 s85, s85, s84
    s_lshl_b32 s84, s51, 10
    v_lshrrev_b32 v240, 4, v208
    v_mul_lo_u32 v240, s86, v240
    v_and_b32 v241, 15, v208
    v_lshl_add_u32 v240, v241, 1, v240
    buffer_load_ushort v232, v240, s[72:75], s85 offen offset:0
    buffer_load_ushort v233, v240, s[72:75], s85 offen offset:1152
    s_add_u32 s85, s85, s87
    buffer_load_ushort v234, v240, s[72:75], s85 offen offset:0
    buffer_load_ushort v235, v240, s[72:75], s85 offen offset:1152
    s_add_u32 s85, s85, s87
    buffer_load_ushort v236, v240, s[72:75], s85 offen offset:0
    buffer_load_ushort v237, v240, s[72:75], s85 offen offset:1152
    s_add_u32 s85, s85, s87
    buffer_load_ushort v238, v240, s[72:75], s85 offen offset:0
    buffer_load_ushort v239, v240, s[72:75], s85 offen offset:1152
    s_mov_b64 exec, 0
    s_cmp_eq_u32 s36, 1
    s_cbranch_scc1 H1_S2_0
    s_cmp_eq_u32 s36, 2
    s_cbranch_scc1 H1_S3_0
    s_branch H1_S4_0
H1_ret:
    s_mov_b64 exec, -1
    s_waitcnt vmcnt(8)
    s_branch K1_polled
K1_odd0:
    v_lshrrev_b32 v219, 2, v208
    v_and_b32 v220, 3, v208
    v_lshrrev_b32 v213, 5, v208
    v_lshlrev_b32 v213, 1, v213
    v_xor_b32 v220, v213, v220
    v_lshlrev_b32 v220, 4, v220
    v_mul_u32_u24 v213, 9216, v219
    v_add_u32 v213, v213, v220
    v_mul_u32_u24 v214, 3456, v219
    s_bitcmp1_b32 s38, 0
    s_cselect_b32 s52, 48, 16
    v_and_b32 v220, s52, v220
    v_add_u32 v214, v214, v220
    s_lshl_b32 s53, s37, 3
    s_lshl_b32 s52, s36, 1
    s_add_u32 s53, s53, s52
    s_mul_i32 s53, s53, 36864
    s_add_u32 s63, s53, 36864
    v_lshlrev_b32 v219, 4, v208
    v_add_u32 v246, 18432, v219
    v_lshrrev_b32 v220, 4, v208
    v_lshlrev_b32 v209, 9, v220
    v_and_b32 v220, 1, v220
    v_lshlrev_b32 v250, 6, v220
    v_bfe_u32 v251, v208, 2, 2
    v_lshl_add_u32 v209, v251, 6, v209
    v_lshl_add_u32 v249, v209, 1, v250
    v_lshl_add_u32 v209, v220, 5, v209
    v_and_b32 v220, 3, v208
    v_lshl_add_u32 v209, v220, 3, v209
    v_lshl_add_u32 v249, v220, 3, v249
    v_bfe_u32 v220, v208, 3, 1
    v_lshl_add_u32 v249, v220, 5, v249
    v_xor_b32 v250, 32, v249
    v_xor_b32 v251, 64, v249
    v_xor_b32 v252, 96, v249
    v_xor_b32 v210, 32, v209
    v_add_u32 v211, 49152, v209
    v_add_u32 v212, 49152, v210
    v_add_u32 v244, 98304, v209
    v_add_u32 v245, 98304, v210
    v_add_u32 v216, 147456, v219
    v_and_b32 v220, 15, v208
    v_mul_u32_u24 v217, 3456, v220
    v_bfe_u32 v220, v208, 4, 1
    v_lshl_add_u32 v217, v220, 5, v217
    v_lshrrev_b32 v220, 5, v208
    v_lshl_add_u32 v217, v220, 4, v217
    v_add_u32 v247, 55296, v217
    v_mov_b32 v218, 0xbdd2d3e8
    v_lshlrev_b32 v222, 4, v208
    s_lshl_b32 s51, s37, 4
    s_lshl_b32 s52, s36, 2
    s_add_u32 s51, s51, s52
    s_mul_i32 s48, s51, 147456
    s_lshl_b32 s52, s68, 10
    s_add_u32 s48, s48, s52
    s_add_u32 s49, s48, 294912
    s_lshl_b32 s51, s37, 8
    s_lshl_b32 s52, s36, 6
    s_add_u32 s51, s51, s52
    s_mul_i32 s50, s51, 3456
    s_lshr_b32 s52, s3, 4
    s_mul_i32 s3, s52, 18432
    v_mov_b32 v119, 1
    v_mov_b32 v120, 0x0101
    v_lshlrev_b32 v121, 8, v208
    v_mov_b32 v122, 0x01010101
    v_cmp_gt_u32 vcc, 8, v208
    v_mov_b32 v123, 1
    v_cndmask_b32 v122, v119, v122, vcc
    s_and_b32 s51, s2, 7
    s_lshl_b32 s51, s51, 1
    s_bfm_b32 s52, s51, 0
    s_and_b32 s52, s52, 65365
    s_bcnt1_i32_b32 s52, s52
    s_lshl_b32 s52, s52, 5
    s_mul_i32 s51, s51, 192
    s_sub_u32 s55, s52, s51
    s_add_u32 s55, s55, 2688
    s_waitcnt vmcnt(0)
K1_arrive:
    s_add_u32 s61, s61, 1769472
    s_bitcmp1_b32 s4, 8
    s_cbranch_scc1 K1_solo0
K1_arrive2:
    s_lshl_b32 s51, s37, 5
    s_movk_i32 s52, 3000
    s_mov_b64 exec, 1
    buffer_atomic_add v123, off, s[96:99], s51 sc0 sc1
    s_mov_b64 exec, 0x1ff
    buffer_load_dword v192, v118, s[76:79], s84 offen sc1
    s_sleep 2
    buffer_load_dword v193, v118, s[76:79], s84 offen sc1
    s_sleep 2
    s_waitcnt vmcnt(2)
    v_cmp_ne_u32 vcc, 31, v123
    s_nop 4
    s_bitcmp1_b32 vcc_lo, 0
    s_cbranch_scc1 K1_poll
    s_mov_b32 exec_lo, -1
    buffer_store_dword v119, v121, s[76:79], s85 offen offset:32 sc0 sc1
    s_branch K1_polled0
K1_poll:
    buffer_load_dword v194, v118, s[76:79], s84 offen sc1
    s_waitcnt vmcnt(2)
    v_cmp_eq_u32 vcc, v192, v122
    s_nop 4
    s_cmp_ge_u32 vcc_lo, 0xff
    s_cbranch_scc1 K1_polled0
    s_sleep 2
    buffer_load_dword v192, v118, s[76:79], s84 offen sc1
    s_waitcnt vmcnt(2)
    v_cmp_eq_u32 vcc, v193, v122
    s_nop 4
    s_cmp_ge_u32 vcc_lo, 0xff
    s_cbranch_scc1 K1_polled0
    s_sleep 2
    buffer_load_dword v193, v118, s[76:79], s84 offen sc1
    s_waitcnt vmcnt(2)
    v_cmp_eq_u32 vcc, v194, v122
    s_nop 4
    s_cmp_ge_u32 vcc_lo, 0xff
    s_cbranch_scc1 K1_polled0
    s_sleep 2
    s_sub_u32 s52, s52, 1
    s_cmp_eq_u32 s52, 0
    s_cbranch_scc0 K1_poll
    s_branch K1_fallback
K1_polled0:
    s_mov_b32 s78, 0
K1_polled:
    s_mov_b64 exec, -1
    s_barrier
    buffer_load_dwordx4 a[0:3], v219, s[20:23], s53 offen offset:0 sc1
    buffer_load_dwordx4 a[72:75], v246, s[20:23], s53 offen offset:0 sc1
    buffer_load_dwordx4 a[144:147], v219, s[20:23], s63 offen offset:0 sc1
    buffer_load_dwordx4 a[216:219], v246, s[20:23], s63 offen offset:0 sc1
    buffer_load_dwordx4 a[4:7], v219, s[20:23], s53 offen offset:1024 sc1
    buffer_load_dwordx4 a[76:79], v246, s[20:23], s53 offen offset:1024 sc1
    buffer_load_dwordx4 a[148:151], v219, s[20:23], s63 offen offset:1024 sc1
    buffer_load_dwordx4 a[220:223], v246, s[20:23], s63 offen offset:1024 sc1
    s_add_u32 s92, s10, 3670016
    s_addc_u32 s93, s11, 0
    s_mov_b32 s94, 32768
    s_mov_b32 s95, 0x00020000
    s_lshl_b32 s5, s37, 2
    s_add_u32 s5, s5, s36
    s_lshl_b32 s5, s5, 5
    s_add_u32 s5, s5, s38
    s_lshl_b32 s5, s5, 5
    s_bitcmp1_b32 s4, 8
    s_cselect_b32 s5, 1048576, s5
    buffer_load_dwordx4 a[8:11], v219, s[20:23], s53 offen offset:2048 sc1
    buffer_load_dwordx4 a[80:83], v246, s[20:23], s53 offen offset:2048 sc1
    buffer_load_dwordx4 a[152:155], v219, s[20:23], s63 offen offset:2048 sc1
    buffer_load_dwordx4 a[224:227], v246, s[20:23], s63 offen offset:2048 sc1
    ds_read_b64_tr_b16 v[160:161], v249 offset:0
    ds_read_b64_tr_b16 v[162:163], v249 offset:512
    ds_read_b64_tr_b16 v[164:165], v249 offset:24576
    ds_read_b64_tr_b16 v[166:167], v249 offset:25088
    ds_read_b64_tr_b16 v[168:169], v250 offset:0
    ds_read_b64_tr_b16 v[170:171], v250 offset:512
    ds_read_b64_tr_b16 v[172:173], v250 offset:24576
    ds_read_b64_tr_b16 v[174:175], v250 offset:25088
    ds_read_b64_tr_b16 v[176:177], v251 offset:0
    ds_read_b64_tr_b16 v[178:179], v251 offset:512
    ds_read_b64_tr_b16 v[180:181], v251 offset:24576
    ds_read_b64_tr_b16 v[182:183], v251 offset:25088
    ds_read_b64_tr_b16 v[184:185], v252 offset:0
    ds_read_b64_tr_b16 v[186:187], v252 offset:512
    s_waitcnt vmcnt(8)
    s_waitcnt lgkmcnt(10)
    v_mfma_f32_16x16x32_bf16 v[0:3], v[160:163], a[0:3], 0
    ds_read_b64_tr_b16 v[188:189], v252 offset:24576
    ds_read_b64_tr_b16 v[190:191], v252 offset:25088
    v_mfma_f32_16x16x32_bf16 v[8:11], v[160:163], a[72:75], 0
    buffer_load_dwordx4 a[12:15], v219, s[20:23], s53 offen offset:3072 sc1
    v_mfma_f32_16x16x32_bf16 v[16:19], v[160:163], a[144:147], 0
    v_mfma_f32_16x16x32_bf16 v[24:27], v[160:163], a[216:219], 0
    v_mfma_f32_16x16x32_bf16 v[28:31], v[164:167], a[216:219], 0
    ds_read_b64_tr_b16 v[160:161], v249 offset:4096
    ds_read_b64_tr_b16 v[162:163], v249 offset:4608
    v_mfma_f32_16x16x32_bf16 v[20:23], v[164:167], a[144:147], 0
    buffer_load_dwordx4 a[84:87], v246, s[20:23], s53 offen offset:3072 sc1
    v_mfma_f32_16x16x32_bf16 v[12:15], v[164:167], a[72:75], 0
    v_mfma_f32_16x16x32_bf16 v[4:7], v[164:167], a[0:3], 0
    s_waitcnt lgkmcnt(10)
    v_mfma_f32_16x16x32_bf16 v[32:35], v[168:171], a[0:3], 0
    ds_read_b64_tr_b16 v[164:165], v249 offset:28672
    ds_read_b64_tr_b16 v[166:167], v249 offset:29184
    v_mfma_f32_16x16x32_bf16 v[40:43], v[168:171], a[72:75], 0
    buffer_load_dwordx4 a[156:159], v219, s[20:23], s63 offen offset:3072 sc1
    v_mfma_f32_16x16x32_bf16 v[48:51], v[168:171], a[144:147], 0
    v_mfma_f32_16x16x32_bf16 v[56:59], v[168:171], a[216:219], 0
    v_mfma_f32_16x16x32_bf16 v[60:63], v[172:175], a[216:219], 0
    ds_read_b64_tr_b16 v[168:169], v250 offset:4096
    ds_read_b64_tr_b16 v[170:171], v250 offset:4608
    v_mfma_f32_16x16x32_bf16 v[52:55], v[172:175], a[144:147], 0
    buffer_load_dwordx4 a[228:231], v246, s[20:23], s63 offen offset:3072 sc1
    s_add_u32 s53, s53, 4096
    v_mfma_f32_16x16x32_bf16 v[44:47], v[172:175], a[72:75], 0
    s_add_u32 s63, s63, 4096
    s_add_u32 m0, s89, 49152
    v_mfma_f32_16x16x32_bf16 v[36:39], v[172:175], a[0:3], 0
    s_waitcnt lgkmcnt(10)
    buffer_load_dwordx4 v248, s[12:15], s61 offen lds
    s_add_u32 s61, s61, 0x24000
    v_mfma_f32_16x16x32_bf16 v[64:67], v[176:179], a[0:3], 0
    s_add_u32 m0, s89, 51200
    ds_read_b64_tr_b16 v[172:173], v250 offset:28672
    ds_read_b64_tr_b16 v[174:175], v250 offset:29184
    v_mfma_f32_16x16x32_bf16 v[72:75], v[176:179], a[72:75], 0
    buffer_load_dwordx4 v248, s[12:15], s61 offen lds
    s_add_u32 s61, s61, 0x24000
    v_mfma_f32_16x16x32_bf16 v[80:83], v[176:179], a[144:147], 0
    s_add_u32 m0, s89, 53248
    v_mfma_f32_16x16x32_bf16 v[88:91], v[176:179], a[216:219], 0
    v_mfma_f32_16x16x32_bf16 v[92:95], v[180:183], a[216:219], 0
    ds_read_b64_tr_b16 v[176:177], v251 offset:4096
    ds_read_b64_tr_b16 v[178:179], v251 offset:4608
    v_mfma_f32_16x16x32_bf16 v[84:87], v[180:183], a[144:147], 0
    buffer_load_dwordx4 v248, s[12:15], s61 offen lds
    s_add_u32 s61, s61, 0x24000
    v_mfma_f32_16x16x32_bf16 v[76:79], v[180:183], a[72:75], 0
    s_add_u32 m0, s89, 55296
    v_mfma_f32_16x16x32_bf16 v[68:71], v[180:183], a[0:3], 0
    s_waitcnt lgkmcnt(10)
    v_mfma_f32_16x16x32_bf16 v[96:99], v[184:187], a[0:3], 0
    ds_read_b64_tr_b16 v[180:181], v251 offset:28672
    ds_read_b64_tr_b16 v[182:183], v251 offset:29184
    v_mfma_f32_16x16x32_bf16 v[104:107], v[184:187], a[72:75], 0
    buffer_load_dwordx4 v248, s[12:15], s61 offen lds
    s_add_u32 s61, s61, 0x24000
    v_mfma_f32_16x16x32_bf16 v[112:115], v[184:187], a[144:147], 0
    v_mfma_f32_16x16x32_bf16 v[120:123], v[184:187], a[216:219], 0
    v_mfma_f32_16x16x32_bf16 v[124:127], v[188:191], a[216:219], 0
    ds_read_b64_tr_b16 v[184:185], v252 offset:4096
    ds_read_b64_tr_b16 v[186:187], v252 offset:4608
    v_mfma_f32_16x16x32_bf16 v[116:119], v[188:191], a[144:147], 0
    v_mfma_f32_16x16x32_bf16 v[108:111], v[188:191], a[72:75], 0
    v_mfma_f32_16x16x32_bf16 v[100:103], v[188:191], a[0:3], 0
    s_waitcnt vmcnt(12)
    s_waitcnt lgkmcnt(10)
    v_mfma_f32_16x16x32_bf16 v[0:3], v[160:163], a[4:7], v[0:3]
    ds_read_b64_tr_b16 v[188:189], v252 offset:28672
    ds_read_b64_tr_b16 v[190:191], v252 offset:29184
    v_mfma_f32_16x16x32_bf16 v[8:11], v[160:163], a[76:79], v[8:11]
    buffer_load_dwordx4 a[16:19], v219, s[20:23], s53 offen offset:0 sc1
    v_mfma_f32_16x16x32_bf16 v[16:19], v[160:163], a[148:151], v[16:19]
    buffer_load_dwordx4 a[88:91], v246, s[20:23], s53 offen offset:0 sc1
    v_mfma_f32_16x16x32_bf16 v[24:27], v[160:163], a[220:223], v[24:27]
    v_mfma_f32_16x16x32_bf16 v[28:31], v[164:167], a[220:223], v[28:31]
    ds_read_b64_tr_b16 v[160:161], v249 offset:8192
    ds_read_b64_tr_b16 v[162:163], v249 offset:8704
    v_mfma_f32_16x16x32_bf16 v[20:23], v[164:167], a[148:151], v[20:23]
    buffer_load_dwordx4 a[160:163], v219, s[20:23], s63 offen offset:0 sc1
    v_mfma_f32_16x16x32_bf16 v[12:15], v[164:167], a[76:79], v[12:15]
    v_mfma_f32_16x16x32_bf16 v[4:7], v[164:167], a[4:7], v[4:7]
    s_waitcnt lgkmcnt(10)
    v_mfma_f32_16x16x32_bf16 v[32:35], v[168:171], a[4:7], v[32:35]
    ds_read_b64_tr_b16 v[164:165], v249 offset:32768
    ds_read_b64_tr_b16 v[166:167], v249 offset:33280
    v_mfma_f32_16x16x32_bf16 v[40:43], v[168:171], a[76:79], v[40:43]
    buffer_load_dwordx4 a[232:235], v246, s[20:23], s63 offen offset:0 sc1
    v_mfma_f32_16x16x32_bf16 v[48:51], v[168:171], a[148:151], v[48:51]
    s_add_u32 m0, s89, 57344
    v_mfma_f32_16x16x32_bf16 v[56:59], v[168:171], a[220:223], v[56:59]
    v_mfma_f32_16x16x32_bf16 v[60:63], v[172:175], a[220:223], v[60:63]
    ds_read_b64_tr_b16 v[168:169], v250 offset:8192
    ds_read_b64_tr_b16 v[170:171], v250 offset:8704
    v_mfma_f32_16x16x32_bf16 v[52:55], v[172:175], a[148:151], v[52:55]
    buffer_load_dwordx4 v248, s[12:15], s61 offen lds
    s_add_u32 s61, s61, 0x24000
    v_mfma_f32_16x16x32_bf16 v[44:47], v[172:175], a[76:79], v[44:47]
    s_add_u32 m0, s89, 59392
    v_mfma_f32_16x16x32_bf16 v[36:39], v[172:175], a[4:7], v[36:39]
    s_waitcnt lgkmcnt(10)
    v_mfma_f32_16x16x32_bf16 v[64:67], v[176:179], a[4:7], v[64:67]
    ds_read_b64_tr_b16 v[172:173], v250 offset:32768
    ds_read_b64_tr_b16 v[174:175], v250 offset:33280
    v_mfma_f32_16x16x32_bf16 v[72:75], v[176:179], a[76:79], v[72:75]
    buffer_load_dwordx4 v248, s[12:15], s61 offen lds
    s_add_u32 s61, s61, 0x24000
    v_mfma_f32_16x16x32_bf16 v[80:83], v[176:179], a[148:151], v[80:83]
    s_add_u32 m0, s89, 61440
    v_mfma_f32_16x16x32_bf16 v[88:91], v[176:179], a[220:223], v[88:91]
    buffer_load_dwordx4 v248, s[12:15], s61 offen lds
    s_add_u32 s61, s61, 0x24000
    v_mfma_f32_16x16x32_bf16 v[92:95], v[180:183], a[220:223], v[92:95]
    s_add_u32 m0, s89, 63488
    ds_read_b64_tr_b16 v[176:177], v251 offset:8192
    ds_read_b64_tr_b16 v[178:179], v251 offset:8704
    v_mfma_f32_16x16x32_bf16 v[84:87], v[180:183], a[148:151], v[84:87]
    buffer_load_dwordx4 v248, s[12:15], s61 offen lds
    s_add_u32 s61, s61, 0x24000
    v_mfma_f32_16x16x32_bf16 v[76:79], v[180:183], a[76:79], v[76:79]
    v_mfma_f32_16x16x32_bf16 v[68:71], v[180:183], a[4:7], v[68:71]
    s_waitcnt lgkmcnt(10)
    v_mfma_f32_16x16x32_bf16 v[96:99], v[184:187], a[4:7], v[96:99]
    ds_read_b64_tr_b16 v[180:181], v251 offset:32768
    ds_read_b64_tr_b16 v[182:183], v251 offset:33280
    v_mfma_f32_16x16x32_bf16 v[104:107], v[184:187], a[76:79], v[104:107]
    v_mfma_f32_16x16x32_bf16 v[112:115], v[184:187], a[148:151], v[112:115]
    v_mfma_f32_16x16x32_bf16 v[120:123], v[184:187], a[220:223], v[120:123]
    v_mfma_f32_16x16x32_bf16 v[124:127], v[188:191], a[220:223], v[124:127]
    ds_read_b64_tr_b16 v[184:185], v252 offset:8192
    ds_read_b64_tr_b16 v[186:187], v252 offset:8704
    v_mfma_f32_16x16x32_bf16 v[116:119], v[188:191], a[148:151], v[116:119]
    v_mfma_f32_16x16x32_bf16 v[108:111], v[188:191], a[76:79], v[108:111]
    v_mfma_f32_16x16x32_bf16 v[100:103], v[188:191], a[4:7], v[100:103]
    s_waitcnt vmcnt(16)
    s_waitcnt lgkmcnt(10)
    v_mfma_f32_16x16x32_bf16 v[0:3], v[160:163], a[8:11], v[0:3]
    ds_read_b64_tr_b16 v[188:189], v252 offset:32768
    ds_read_b64_tr_b16 v[190:191], v252 offset:33280
    v_mfma_f32_16x16x32_bf16 v[8:11], v[160:163], a[80:83], v[8:11]
    buffer_load_dwordx4 a[20:23], v219, s[20:23], s53 offen offset:1024 sc1
    v_mfma_f32_16x16x32_bf16 v[16:19], v[160:163], a[152:155], v[16:19]
    buffer_load_dwordx4 a[92:95], v246, s[20:23], s53 offen offset:1024 sc1
    v_mfma_f32_16x16x32_bf16 v[24:27], v[160:163], a[224:227], v[24:27]
    v_mfma_f32_16x16x32_bf16 v[28:31], v[164:167], a[224:227], v[28:31]
    ds_read_b64_tr_b16 v[160:161], v249 offset:12288
    ds_read_b64_tr_b16 v[162:163], v249 offset:12800
    v_mfma_f32_16x16x32_bf16 v[20:23], v[164:167], a[152:155], v[20:23]
    buffer_load_dwordx4 a[164:167], v219, s[20:23], s63 offen offset:1024 sc1
    v_mfma_f32_16x16x32_bf16 v[12:15], v[164:167], a[80:83], v[12:15]
    v_mfma_f32_16x16x32_bf16 v[4:7], v[164:167], a[8:11], v[4:7]
    s_waitcnt lgkmcnt(10)
    v_mfma_f32_16x16x32_bf16 v[32:35], v[168:171], a[8:11], v[32:35]
    ds_read_b64_tr_b16 v[164:165], v249 offset:36864
    ds_read_b64_tr_b16 v[166:167], v249 offset:37376
    v_mfma_f32_16x16x32_bf16 v[40:43], v[168:171], a[80:83], v[40:43]
    buffer_load_dwordx4 a[236:239], v246, s[20:23], s63 offen offset:1024 sc1
    v_mfma_f32_16x16x32_bf16 v[48:51], v[168:171], a[152:155], v[48:51]
    s_add_u32 m0, s89, 65536
    v_mfma_f32_16x16x32_bf16 v[56:59], v[168:171], a[224:227], v[56:59]
    v_mfma_f32_16x16x32_bf16 v[60:63], v[172:175], a[224:227], v[60:63]
    ds_read_b64_tr_b16 v[168:169], v250 offset:12288
    ds_read_b64_tr_b16 v[170:171], v250 offset:12800
    v_mfma_f32_16x16x32_bf16 v[52:55], v[172:175], a[152:155], v[52:55]
    buffer_load_dwordx4 v248, s[12:15], s61 offen lds
    s_add_u32 s61, s61, 0x24000
    v_mfma_f32_16x16x32_bf16 v[44:47], v[172:175], a[80:83], v[44:47]
    s_add_u32 m0, s89, 67584
    v_mfma_f32_16x16x32_bf16 v[36:39], v[172:175], a[8:11], v[36:39]
    s_waitcnt lgkmcnt(10)
    v_mfma_f32_16x16x32_bf16 v[64:67], v[176:179], a[8:11], v[64:67]
    ds_read_b64_tr_b16 v[172:173], v250 offset:36864
    ds_read_b64_tr_b16 v[174:175], v250 offset:37376
    v_mfma_f32_16x16x32_bf16 v[72:75], v[176:179], a[80:83], v[72:75]
    buffer_load_dwordx4 v248, s[12:15], s61 offen lds
    s_add_u32 s61, s61, 0x24000
    v_mfma_f32_16x16x32_bf16 v[80:83], v[176:179], a[152:155], v[80:83]
    s_add_u32 m0, s89, 69632
    v_mfma_f32_16x16x32_bf16 v[88:91], v[176:179], a[224:227], v[88:91]
    buffer_load_dwordx4 v248, s[12:15], s61 offen lds
    s_add_u32 s61, s61, 0x24000
    v_mfma_f32_16x16x32_bf16 v[92:95], v[180:183], a[224:227], v[92:95]
    s_add_u32 m0, s89, 71680
    ds_read_b64_tr_b16 v[176:177], v251 offset:12288
    ds_read_b64_tr_b16 v[178:179], v251 offset:12800
    v_mfma_f32_16x16x32_bf16 v[84:87], v[180:183], a[152:155], v[84:87]
    buffer_load_dwordx4 v248, s[12:15], s61 offen lds
    s_add_u32 s61, s61, 0x24000
    v_mfma_f32_16x16x32_bf16 v[76:79], v[180:183], a[80:83], v[76:79]
    v_mfma_f32_16x16x32_bf16 v[68:71], v[180:183], a[8:11], v[68:71]
    s_waitcnt lgkmcnt(10)
    v_mfma_f32_16x16x32_bf16 v[96:99], v[184:187], a[8:11], v[96:99]
    ds_read_b64_tr_b16 v[180:181], v251 offset:36864
    ds_read_b64_tr_b16 v[182:183], v251 offset:37376
    v_mfma_f32_16x16x32_bf16 v[104:107], v[184:187], a[80:83], v[104:107]
    v_mfma_f32_16x16x32_bf16 v[112:115], v[184:187], a[152:155], v[112:115]
    v_mfma_f32_16x16x32_bf16 v[120:123], v[184:187], a[224:227], v[120:123]
    v_mfma_f32_16x16x32_bf16 v[124:127], v[188:191], a[224:227], v[124:127]
    ds_read_b64_tr_b16 v[184:185], v252 offset:12288
    ds_read_b64_tr_b16 v[186:187], v252 offset:12800
    v_mfma_f32_16x16x32_bf16 v[116:119], v[188:191], a[152:155], v[116:119]
    v_mfma_f32_16x16x32_bf16 v[108:111], v[188:191], a[80:83], v[108:111]
    v_mfma_f32_16x16x32_bf16 v[100:103], v[188:191], a[8:11], v[100:103]
    s_waitcnt vmcnt(20)
    s_waitcnt lgkmcnt(10)
    v_mfma_f32_16x16x32_bf16 v[0:3], v[160:163], a[12:15], v[0:3]
    ds_read_b64_tr_b16 v[188:189], v252 offset:36864
    ds_read_b64_tr_b16 v[190:191], v252 offset:37376
    v_mfma_f32_16x16x32_bf16 v[8:11], v[160:163], a[84:87], v[8:11]
    buffer_load_dwordx4 a[24:27], v219, s[20:23], s53 offen offset:2048 sc1
    v_mfma_f32_16x16x32_bf16 v[16:19], v[160:163], a[156:159], v[16:19]
    buffer_load_dwordx4 a[96:99], v246, s[20:23], s53 offen offset:2048 sc1
    v_mfma_f32_16x16x32_bf16 v[24:27], v[160:163], a[228:231], v[24:27]
    v_mfma_f32_16x16x32_bf16 v[28:31], v[164:167], a[228:231], v[28:31]
    ds_read_b64_tr_b16 v[160:161], v249 offset:16384
    ds_read_b64_tr_b16 v[162:163], v249 offset:16896
    v_mfma_f32_16x16x32_bf16 v[20:23], v[164:167], a[156:159], v[20:23]
    buffer_load_dwordx4 a[168:171], v219, s[20:23], s63 offen offset:2048 sc1
    v_mfma_f32_16x16x32_bf16 v[12:15], v[164:167], a[84:87], v[12:15]
    v_mfma_f32_16x16x32_bf16 v[4:7], v[164:167], a[12:15], v[4:7]
    s_waitcnt lgkmcnt(10)
    v_mfma_f32_16x16x32_bf16 v[32:35], v[168:171], a[12:15], v[32:35]
    ds_read_b64_tr_b16 v[164:165], v249 offset:40960
    ds_read_b64_tr_b16 v[166:167], v249 offset:41472
    v_mfma_f32_16x16x32_bf16 v[40:43], v[168:171], a[84:87], v[40:43]
    buffer_load_dwordx4 a[240:243], v246, s[20:23], s63 offen offset:2048 sc1
    v_mfma_f32_16x16x32_bf16 v[48:51], v[168:171], a[156:159], v[48:51]
    v_mfma_f32_16x16x32_bf16 v[56:59], v[168:171], a[228:231], v[56:59]
    v_mfma_f32_16x16x32_bf16 v[60:63], v[172:175], a[228:231], v[60:63]
    ds_read_b64_tr_b16 v[168:169], v250 offset:16384
    ds_read_b64_tr_b16 v[170:171], v250 offset:16896
    v_mfma_f32_16x16x32_bf16 v[52:55], v[172:175], a[156:159], v[52:55]
    v_mfma_f32_16x16x32_bf16 v[44:47], v[172:175], a[84:87], v[44:47]
H1_S2_0:
    s_cbranch_execz H1_S5_0
    v_mfma_f32_16x16x32_bf16 v[36:39], v[172:175], a[12:15], v[36:39]
    s_waitcnt lgkmcnt(10)
    v_mfma_f32_16x16x32_bf16 v[64:67], v[176:179], a[12:15], v[64:67]
    ds_read_b64_tr_b16 v[172:173], v250 offset:40960
    ds_read_b64_tr_b16 v[174:175], v250 offset:41472
    v_mfma_f32_16x16x32_bf16 v[72:75], v[176:179], a[84:87], v[72:75]
    v_mfma_f32_16x16x32_bf16 v[80:83], v[176:179], a[156:159], v[80:83]
    v_mfma_f32_16x16x32_bf16 v[88:91], v[176:179], a[228:231], v[88:91]
    v_mfma_f32_16x16x32_bf16 v[92:95], v[180:183], a[228:231], v[92:95]
    ds_read_b64_tr_b16 v[176:177], v251 offset:16384
    ds_read_b64_tr_b16 v[178:179], v251 offset:16896
    v_mfma_f32_16x16x32_bf16 v[84:87], v[180:183], a[156:159], v[84:87]
    v_mfma_f32_16x16x32_bf16 v[76:79], v[180:183], a[84:87], v[76:79]
    v_mfma_f32_16x16x32_bf16 v[68:71], v[180:183], a[12:15], v[68:71]
    s_waitcnt lgkmcnt(10)
    v_mfma_f32_16x16x32_bf16 v[96:99], v[184:187], a[12:15], v[96:99]
    ds_read_b64_tr_b16 v[180:181], v251 offset:40960
    ds_read_b64_tr_b16 v[182:183], v251 offset:41472
    v_mfma_f32_16x16x32_bf16 v[104:107], v[184:187], a[84:87], v[104:107]
    v_mfma_f32_16x16x32_bf16 v[112:115], v[184:187], a[156:159], v[112:115]
    v_mfma_f32_16x16x32_bf16 v[120:123], v[184:187], a[228:231], v[120:123]
    v_mfma_f32_16x16x32_bf16 v[124:127], v[188:191], a[228:231], v[124:127]
    ds_read_b64_tr_b16 v[184:185], v252 offset:16384
    ds_read_b64_tr_b16 v[186:187], v252 offset:16896
    v_mfma_f32_16x16x32_bf16 v[116:119], v[188:191], a[156:159], v[116:119]
    v_mfma_f32_16x16x32_bf16 v[108:111], v[188:191], a[84:87], v[108:111]
    v_mfma_f32_16x16x32_bf16 v[100:103], v[188:191], a[12:15], v[100:103]
    s_waitcnt vmcnt(16)
    s_waitcnt lgkmcnt(10)
    v_mfma_f32_16x16x32_bf16 v[0:3], v[160:163], a[16:19], v[0:3]
    ds_read_b64_tr_b16 v[188:189], v252 offset:40960
    ds_read_b64_tr_b16 v[190:191], v252 offset:41472
    v_mfma_f32_16x16x32_bf16 v[8:11], v[160:163], a[88:91], v[8:11]
    buffer_load_dwordx4 a[28:31], v219, s[20:23], s53 offen offset:3072 sc1
    v_mfma_f32_16x16x32_bf16 v[16:19], v[160:163], a[160:163], v[16:19]
    buffer_load_dwordx4 a[100:103], v246, s[20:23], s53 offen offset:3072 sc1
    v_mfma_f32_16x16x32_bf16 v[24:27], v[160:163], a[232:235], v[24:27]
    v_mfma_f32_16x16x32_bf16 v[28:31], v[164:167], a[232:235], v[28:31]
    ds_read_b64_tr_b16 v[160:161], v249 offset:20480
    ds_read_b64_tr_b16 v[162:163], v249 offset:20992
    v_mfma_f32_16x16x32_bf16 v[20:23], v[164:167], a[160:163], v[20:23]
    buffer_load_dwordx4 a[172:175], v219, s[20:23], s63 offen offset:3072 sc1
    v_mfma_f32_16x16x32_bf16 v[12:15], v[164:167], a[88:91], v[12:15]
    v_mfma_f32_16x16x32_bf16 v[4:7], v[164:167], a[16:19], v[4:7]
    s_waitcnt lgkmcnt(10)
    v_mfma_f32_16x16x32_bf16 v[32:35], v[168:171], a[16:19], v[32:35]
    ds_read_b64_tr_b16 v[164:165], v249 offset:45056
    ds_read_b64_tr_b16 v[166:167], v249 offset:45568
    v_mfma_f32_16x16x32_bf16 v[40:43], v[168:171], a[88:91], v[40:43]
    buffer_load_dwordx4 a[244:247], v246, s[20:23], s63 offen offset:3072 sc1
    s_add_u32 s53, s53, 4096
    v_mfma_f32_16x16x32_bf16 v[48:51], v[168:171], a[160:163], v[48:51]
    s_add_u32 s63, s63, 4096
    v_mfma_f32_16x16x32_bf16 v[56:59], v[168:171], a[232:235], v[56:59]
    v_mfma_f32_16x16x32_bf16 v[60:63], v[172:175], a[232:235], v[60:63]
    ds_read_b64_tr_b16 v[168:169], v250 offset:20480
    ds_read_b64_tr_b16 v[170:171], v250 offset:20992
    v_mfma_f32_16x16x32_bf16 v[52:55], v[172:175], a[160:163], v[52:55]
    v_mfma_f32_16x16x32_bf16 v[44:47], v[172:175], a[88:91], v[44:47]
    v_mfma_f32_16x16x32_bf16 v[36:39], v[172:175], a[16:19], v[36:39]
    s_waitcnt lgkmcnt(10)
    v_mfma_f32_16x16x32_bf16 v[64:67], v[176:179], a[16:19], v[64:67]
    ds_read_b64_tr_b16 v[172:173], v250 offset:45056
    ds_read_b64_tr_b16 v[174:175], v250 offset:45568
    v_mfma_f32_16x16x32_bf16 v[72:75], v[176:179], a[88:91], v[72:75]
    v_mfma_f32_16x16x32_bf16 v[80:83], v[176:179], a[160:163], v[80:83]
    v_mfma_f32_16x16x32_bf16 v[88:91], v[176:179], a[232:235], v[88:91]
    v_mfma_f32_16x16x32_bf16 v[92:95], v[180:183], a[232:235], v[92:95]
    ds_read_b64_tr_b16 v[176:177], v251 offset:20480
    ds_read_b64_tr_b16 v[178:179], v251 offset:20992
    v_mfma_f32_16x16x32_bf16 v[84:87], v[180:183], a[160:163], v[84:87]
    v_mfma_f32_16x16x32_bf16 v[76:79], v[180:183], a[88:91], v[76:79]
    v_mfma_f32_16x16x32_bf16 v[68:71], v[180:183], a[16:19], v[68:71]
    s_waitcnt lgkmcnt(10)
    v_mfma_f32_16x16x32_bf16 v[96:99], v[184:187], a[16:19], v[96:99]
    ds_read_b64_tr_b16 v[180:181], v251 offset:45056
    ds_read_b64_tr_b16 v[182:183], v251 offset:45568
    v_mfma_f32_16x16x32_bf16 v[104:107], v[184:187], a[88:91], v[104:107]
    v_mfma_f32_16x16x32_bf16 v[112:115], v[184:187], a[160:163], v[112:115]
    v_mfma_f32_16x16x32_bf16 v[120:123], v[184:187], a[232:235], v[120:123]
    v_mfma_f32_16x16x32_bf16 v[124:127], v[188:191], a[232:235], v[124:127]
    ds_read_b64_tr_b16 v[184:185], v252 offset:20480
    ds_read_b64_tr_b16 v[186:187], v252 offset:20992
    v_mfma_f32_16x16x32_bf16 v[116:119], v[188:191], a[160:163], v[116:119]
    v_mfma_f32_16x16x32_bf16 v[108:111], v[188:191], a[88:91], v[108:111]
    v_mfma_f32_16x16x32_bf16 v[100:103], v[188:191], a[16:19], v[100:103]
    s_waitcnt vmcnt(12)
    s_waitcnt lgkmcnt(10)
    s_waitcnt vmcnt(8)
    s_barrier
    v_mfma_f32_16x16x32_bf16 v[0:3], v[160:163], a[20:23], v[0:3]
    ds_read_b64_tr_b16 v[188:189], v252 offset:45056
    ds_read_b64_tr_b16 v[190:191], v252 offset:45568
    v_mfma_f32_16x16x32_bf16 v[8:11], v[160:163], a[92:95], v[8:11]
    buffer_load_dwordx4 a[32:35], v219, s[20:23], s53 offen offset:0 sc1
    v_mfma_f32_16x16x32_bf16 v[16:19], v[160:163], a[164:167], v[16:19]
    buffer_load_dwordx4 a[104:107], v246, s[20:23], s53 offen offset:0 sc1
    v_mfma_f32_16x16x32_bf16 v[24:27], v[160:163], a[236:239], v[24:27]
    v_add_u32 v249, 0xc000, v249
    v_mfma_f32_16x16x32_bf16 v[28:31], v[164:167], a[236:239], v[28:31]
    ds_read_b64_tr_b16 v[160:161], v249 offset:0
    ds_read_b64_tr_b16 v[162:163], v249 offset:512
    v_mfma_f32_16x16x32_bf16 v[20:23], v[164:167], a[164:167], v[20:23]
    buffer_load_dwordx4 a[176:179], v219, s[20:23], s63 offen offset:0 sc1
    v_mfma_f32_16x16x32_bf16 v[12:15], v[164:167], a[92:95], v[12:15]
    v_mfma_f32_16x16x32_bf16 v[4:7], v[164:167], a[20:23], v[4:7]
    s_waitcnt lgkmcnt(10)
    v_mfma_f32_16x16x32_bf16 v[32:35], v[168:171], a[20:23], v[32:35]
    ds_read_b64_tr_b16 v[164:165], v249 offset:24576
    ds_read_b64_tr_b16 v[166:167], v249 offset:25088
    v_mfma_f32_16x16x32_bf16 v[40:43], v[168:171], a[92:95], v[40:43]
    buffer_load_dwordx4 a[248:251], v246, s[20:23], s63 offen offset:0 sc1
    v_mfma_f32_16x16x32_bf16 v[48:51], v[168:171], a[164:167], v[48:51]
    s_add_u32 m0, s89, 98304
    v_mfma_f32_16x16x32_bf16 v[56:59], v[168:171], a[236:239], v[56:59]
    v_add_u32 v250, 0xc000, v250
    v_mfma_f32_16x16x32_bf16 v[60:63], v[172:175], a[236:239], v[60:63]
    ds_read_b64_tr_b16 v[168:169], v250 offset:0
    ds_read_b64_tr_b16 v[170:171], v250 offset:512
    v_mfma_f32_16x16x32_bf16 v[52:55], v[172:175], a[164:167], v[52:55]
    buffer_load_dwordx4 v248, s[12:15], s61 offen lds
    s_add_u32 s61, s61, 0x24000
    v_mfma_f32_16x16x32_bf16 v[44:47], v[172:175], a[92:95], v[44:47]
    s_add_u32 m0, s89, 100352
    v_mfma_f32_16x16x32_bf16 v[36:39], v[172:175], a[20:23], v[36:39]
    s_waitcnt lgkmcnt(10)
    v_mfma_f32_16x16x32_bf16 v[64:67], v[176:179], a[20:23], v[64:67]
    ds_read_b64_tr_b16 v[172:173], v250 offset:24576
    ds_read_b64_tr_b16 v[174:175], v250 offset:25088
    v_mfma_f32_16x16x32_bf16 v[72:75], v[176:179], a[92:95], v[72:75]
    buffer_load_dwordx4 v248, s[12:15], s61 offen lds
    s_add_u32 s61, s61, 0x24000
    v_mfma_f32_16x16x32_bf16 v[80:83], v[176:179], a[164:167], v[80:83]
    s_add_u32 m0, s89, 102400
    v_mfma_f32_16x16x32_bf16 v[88:91], v[176:179], a[236:239], v[88:91]
    buffer_load_dwordx4 v248, s[12:15], s61 offen lds
    v_add_u32 v251, 0xc000, v251
    v_mfma_f32_16x16x32_bf16 v[92:95], v[180:183], a[236:239], v[92:95]
    s_add_u32 s61, s61, 0x24000
    ds_read_b64_tr_b16 v[176:177], v251 offset:0
    ds_read_b64_tr_b16 v[178:179], v251 offset:512
    v_mfma_f32_16x16x32_bf16 v[84:87], v[180:183], a[164:167], v[84:87]
    s_add_u32 m0, s89, 104448
    v_mfma_f32_16x16x32_bf16 v[76:79], v[180:183], a[92:95], v[76:79]
    buffer_load_dwordx4 v248, s[12:15], s61 offen lds
    s_add_u32 s61, s61, 0x24000
    v_mfma_f32_16x16x32_bf16 v[68:71], v[180:183], a[20:23], v[68:71]
    s_waitcnt lgkmcnt(10)
    v_mfma_f32_16x16x32_bf16 v[96:99], v[184:187], a[20:23], v[96:99]
    ds_read_b64_tr_b16 v[180:181], v251 offset:24576
    ds_read_b64_tr_b16 v[182:183], v251 offset:25088
    v_mfma_f32_16x16x32_bf16 v[104:107], v[184:187], a[92:95], v[104:107]
    v_mfma_f32_16x16x32_bf16 v[112:115], v[184:187], a[164:167], v[112:115]
    v_mfma_f32_16x16x32_bf16 v[120:123], v[184:187], a[236:239], v[120:123]
    v_add_u32 v252, 0xc000, v252
    v_mfma_f32_16x16x32_bf16 v[124:127], v[188:191], a[236:239], v[124:127]
    ds_read_b64_tr_b16 v[184:185], v252 offset:0
    ds_read_b64_tr_b16 v[186:187], v252 offset:512
    v_mfma_f32_16x16x32_bf16 v[116:119], v[188:191], a[164:167], v[116:119]
    v_mfma_f32_16x16x32_bf16 v[108:111], v[188:191], a[92:95], v[108:111]
    v_mfma_f32_16x16x32_bf16 v[100:103], v[188:191], a[20:23], v[100:103]
    s_waitcnt vmcnt(12)
    s_waitcnt lgkmcnt(10)
    v_mfma_f32_16x16x32_bf16 v[0:3], v[160:163], a[24:27], v[0:3]
    ds_read_b64_tr_b16 v[188:189], v252 offset:24576
    ds_read_b64_tr_b16 v[190:191], v252 offset:25088
    v_mfma_f32_16x16x32_bf16 v[8:11], v[160:163], a[96:99], v[8:11]
    buffer_load_dwordx4 a[36:39], v219, s[20:23], s53 offen offset:1024 sc1
    v_mfma_f32_16x16x32_bf16 v[16:19], v[160:163], a[168:171], v[16:19]
    buffer_load_dwordx4 a[108:111], v246, s[20:23], s53 offen offset:1024 sc1
    v_mfma_f32_16x16x32_bf16 v[24:27], v[160:163], a[240:243], v[24:27]
    v_mfma_f32_16x16x32_bf16 v[28:31], v[164:167], a[240:243], v[28:31]
    ds_read_b64_tr_b16 v[160:161], v249 offset:4096
    ds_read_b64_tr_b16 v[162:163], v249 offset:4608
    v_mfma_f32_16x16x32_bf16 v[20:23], v[164:167], a[168:171], v[20:23]
    buffer_load_dwordx4 a[180:183], v219, s[20:23], s63 offen offset:1024 sc1
    v_mfma_f32_16x16x32_bf16 v[12:15], v[164:167], a[96:99], v[12:15]
    v_mfma_f32_16x16x32_bf16 v[4:7], v[164:167], a[24:27], v[4:7]
    s_waitcnt lgkmcnt(10)
    v_mfma_f32_16x16x32_bf16 v[32:35], v[168:171], a[24:27], v[32:35]
    ds_read_b64_tr_b16 v[164:165], v249 offset:28672
    ds_read_b64_tr_b16 v[166:167], v249 offset:29184
    v_mfma_f32_16x16x32_bf16 v[40:43], v[168:171], a[96:99], v[40:43]
    buffer_load_dwordx4 a[252:255], v246, s[20:23], s63 offen offset:1024 sc1
    v_mfma_f32_16x16x32_bf16 v[48:51], v[168:171], a[168:171], v[48:51]
    s_add_u32 m0, s89, 106496
    v_mfma_f32_16x16x32_bf16 v[56:59], v[168:171], a[240:243], v[56:59]
    v_mfma_f32_16x16x32_bf16 v[60:63], v[172:175], a[240:243], v[60:63]
    ds_read_b64_tr_b16 v[168:169], v250 offset:4096
    ds_read_b64_tr_b16 v[170:171], v250 offset:4608
    v_mfma_f32_16x16x32_bf16 v[52:55], v[172:175], a[168:171], v[52:55]
    buffer_load_dwordx4 v248, s[12:15], s61 offen lds
    s_add_u32 s61, s61, 0x24000
    v_mfma_f32_16x16x32_bf16 v[44:47], v[172:175], a[96:99], v[44:47]
    s_add_u32 m0, s89, 108544
    v_mfma_f32_16x16x32_bf16 v[36:39], v[172:175], a[24:27], v[36:39]
    s_waitcnt lgkmcnt(10)
    v_mfma_f32_16x16x32_bf16 v[64:67], v[176:179], a[24:27], v[64:67]
    ds_read_b64_tr_b16 v[172:173], v250 offset:28672
    ds_read_b64_tr_b16 v[174:175], v250 offset:29184
    v_mfma_f32_16x16x32_bf16 v[72:75], v[176:179], a[96:99], v[72:75]
    buffer_load_dwordx4 v248, s[12:15], s61 offen lds
    s_add_u32 s61, s61, 0x24000
    v_mfma_f32_16x16x32_bf16 v[80:83], v[176:179], a[168:171], v[80:83]
    s_add_u32 m0, s89, 110592
    v_mfma_f32_16x16x32_bf16 v[88:91], v[176:179], a[240:243], v[88:91]
    buffer_load_dwordx4 v248, s[12:15], s61 offen lds
    s_add_u32 s61, s61, 0x24000
    v_mfma_f32_16x16x32_bf16 v[92:95], v[180:183], a[240:243], v[92:95]
    s_add_u32 m0, s89, 112640
    ds_read_b64_tr_b16 v[176:177], v251 offset:4096
    ds_read_b64_tr_b16 v[178:179], v251 offset:4608
    v_mfma_f32_16x16x32_bf16 v[84:87], v[180:183], a[168:171], v[84:87]
    buffer_load_dwordx4 v248, s[12:15], s61 offen lds
    s_add_u32 s61, s61, 0x24000
    v_mfma_f32_16x16x32_bf16 v[76:79], v[180:183], a[96:99], v[76:79]
    v_mfma_f32_16x16x32_bf16 v[68:71], v[180:183], a[24:27], v[68:71]
    s_waitcnt lgkmcnt(10)
    v_mfma_f32_16x16x32_bf16 v[96:99], v[184:187], a[24:27], v[96:99]
    ds_read_b64_tr_b16 v[180:181], v251 offset:28672
    ds_read_b64_tr_b16 v[182:183], v251 offset:29184
    v_mfma_f32_16x16x32_bf16 v[104:107], v[184:187], a[96:99], v[104:107]
    v_mfma_f32_16x16x32_bf16 v[112:115], v[184:187], a[168:171], v[112:115]
    v_mfma_f32_16x16x32_bf16 v[120:123], v[184:187], a[240:243], v[120:123]
    v_mfma_f32_16x16x32_bf16 v[124:127], v[188:191], a[240:243], v[124:127]
    ds_read_b64_tr_b16 v[184:185], v252 offset:4096
    ds_read_b64_tr_b16 v[186:187], v252 offset:4608
    v_mfma_f32_16x16x32_bf16 v[116:119], v[188:191], a[168:171], v[116:119]
    v_mfma_f32_16x16x32_bf16 v[108:111], v[188:191], a[96:99], v[108:111]
    v_mfma_f32_16x16x32_bf16 v[100:103], v[188:191], a[24:27], v[100:103]
    s_waitcnt vmcnt(16)
    s_waitcnt lgkmcnt(10)
    v_mfma_f32_16x16x32_bf16 v[0:3], v[160:163], a[28:31], v[0:3]
    ds_read_b64_tr_b16 v[188:189], v252 offset:28672
    ds_read_b64_tr_b16 v[190:191], v252 offset:29184
    v_mfma_f32_16x16x32_bf16 v[8:11], v[160:163], a[100:103], v[8:11]
    buffer_load_dwordx4 a[40:43], v219, s[20:23], s53 offen offset:2048 sc1
    v_mfma_f32_16x16x32_bf16 v[16:19], v[160:163], a[172:175], v[16:19]
    buffer_load_dwordx4 a[112:115], v246, s[20:23], s53 offen offset:2048 sc1
    v_mfma_f32_16x16x32_bf16 v[24:27], v[160:163], a[244:247], v[24:27]
    v_mfma_f32_16x16x32_bf16 v[28:31], v[164:167], a[244:247], v[28:31]
    ds_read_b64_tr_b16 v[160:161], v249 offset:8192
    ds_read_b64_tr_b16 v[162:163], v249 offset:8704
    v_mfma_f32_16x16x32_bf16 v[20:23], v[164:167], a[172:175], v[20:23]
    buffer_load_dwordx4 a[184:187], v219, s[20:23], s63 offen offset:2048 sc1
    v_mfma_f32_16x16x32_bf16 v[12:15], v[164:167], a[100:103], v[12:15]
    v_mfma_f32_16x16x32_bf16 v[4:7], v[164:167], a[28:31], v[4:7]
    s_waitcnt lgkmcnt(10)
    v_mfma_f32_16x16x32_bf16 v[32:35], v[168:171], a[28:31], v[32:35]
    ds_read_b64_tr_b16 v[164:165], v249 offset:32768
    ds_read_b64_tr_b16 v[166:167], v249 offset:33280
    v_mfma_f32_16x16x32_bf16 v[40:43], v[168:171], a[100:103], v[40:43]
    buffer_load_dwordx4 v[128:131], v246, s[20:23], s63 offen offset:2048 sc1
    v_mfma_f32_16x16x32_bf16 v[48:51], v[168:171], a[172:175], v[48:51]
    s_add_u32 m0, s89, 114688
    v_mfma_f32_16x16x32_bf16 v[56:59], v[168:171], a[244:247], v[56:59]
    v_mfma_f32_16x16x32_bf16 v[60:63], v[172:175], a[244:247], v[60:63]
    ds_read_b64_tr_b16 v[168:169], v250 offset:8192
    ds_read_b64_tr_b16 v[170:171], v250 offset:8704
    v_mfma_f32_16x16x32_bf16 v[52:55], v[172:175], a[172:175], v[52:55]
    buffer_load_dwordx4 v248, s[12:15], s61 offen lds
    s_add_u32 s61, s61, 0x24000
    v_mfma_f32_16x16x32_bf16 v[44:47], v[172:175], a[100:103], v[44:47]
    s_add_u32 m0, s89, 116736
    v_mfma_f32_16x16x32_bf16 v[36:39], v[172:175], a[28:31], v[36:39]
    s_waitcnt lgkmcnt(10)
    v_mfma_f32_16x16x32_bf16 v[64:67], v[176:179], a[28:31], v[64:67]
    ds_read_b64_tr_b16 v[172:173], v250 offset:32768
    ds_read_b64_tr_b16 v[174:175], v250 offset:33280
    v_mfma_f32_16x16x32_bf16 v[72:75], v[176:179], a[100:103], v[72:75]
    buffer_load_dwordx4 v248, s[12:15], s61 offen lds
    s_add_u32 s61, s61, 0x24000
    v_mfma_f32_16x16x32_bf16 v[80:83], v[176:179], a[172:175], v[80:83]
    s_add_u32 m0, s89, 118784
    v_mfma_f32_16x16x32_bf16 v[88:91], v[176:179], a[244:247], v[88:91]
    buffer_load_dwordx4 v248, s[12:15], s61 offen lds
    s_add_u32 s61, s61, 0x24000
    v_mfma_f32_16x16x32_bf16 v[92:95], v[180:183], a[244:247], v[92:95]
    s_add_u32 m0, s89, 120832
    ds_read_b64_tr_b16 v[176:177], v251 offset:8192
    ds_read_b64_tr_b16 v[178:179], v251 offset:8704
    v_mfma_f32_16x16x32_bf16 v[84:87], v[180:183], a[172:175], v[84:87]
    buffer_load_dwordx4 v248, s[12:15], s61 offen lds
    s_add_u32 s61, s61, 0xffb14200
    v_mfma_f32_16x16x32_bf16 v[76:79], v[180:183], a[100:103], v[76:79]
    v_mfma_f32_16x16x32_bf16 v[68:71], v[180:183], a[28:31], v[68:71]
    s_waitcnt lgkmcnt(10)
    v_mfma_f32_16x16x32_bf16 v[96:99], v[184:187], a[28:31], v[96:99]
    ds_read_b64_tr_b16 v[180:181], v251 offset:32768
    ds_read_b64_tr_b16 v[182:183], v251 offset:33280
    v_mfma_f32_16x16x32_bf16 v[104:107], v[184:187], a[100:103], v[104:107]
    v_mfma_f32_16x16x32_bf16 v[112:115], v[184:187], a[172:175], v[112:115]
    v_mfma_f32_16x16x32_bf16 v[120:123], v[184:187], a[244:247], v[120:123]
    v_mfma_f32_16x16x32_bf16 v[124:127], v[188:191], a[244:247], v[124:127]
    ds_read_b64_tr_b16 v[184:185], v252 offset:8192
    ds_read_b64_tr_b16 v[186:187], v252 offset:8704
    v_mfma_f32_16x16x32_bf16 v[116:119], v[188:191], a[172:175], v[116:119]
    v_mfma_f32_16x16x32_bf16 v[108:111], v[188:191], a[100:103], v[108:111]
    v_mfma_f32_16x16x32_bf16 v[100:103], v[188:191], a[28:31], v[100:103]
    s_waitcnt vmcnt(20)
    s_waitcnt lgkmcnt(10)
    v_mfma_f32_16x16x32_bf16 v[0:3], v[160:163], a[32:35], v[0:3]
    ds_read_b64_tr_b16 v[188:189], v252 offset:32768
    ds_read_b64_tr_b16 v[190:191], v252 offset:33280
    v_mfma_f32_16x16x32_bf16 v[8:11], v[160:163], a[104:107], v[8:11]
    buffer_load_dwordx4 a[44:47], v219, s[20:23], s53 offen offset:3072 sc1
    v_mfma_f32_16x16x32_bf16 v[16:19], v[160:163], a[176:179], v[16:19]
    buffer_load_dwordx4 a[116:119], v246, s[20:23], s53 offen offset:3072 sc1
    v_mfma_f32_16x16x32_bf16 v[24:27], v[160:163], a[248:251], v[24:27]
    v_mfma_f32_16x16x32_bf16 v[28:31], v[164:167], a[248:251], v[28:31]
    ds_read_b64_tr_b16 v[160:161], v249 offset:12288
    ds_read_b64_tr_b16 v[162:163], v249 offset:12800
    v_mfma_f32_16x16x32_bf16 v[20:23], v[164:167], a[176:179], v[20:23]
    buffer_load_dwordx4 a[188:191], v219, s[20:23], s63 offen offset:3072 sc1
    v_mfma_f32_16x16x32_bf16 v[12:15], v[164:167], a[104:107], v[12:15]
    v_mfma_f32_16x16x32_bf16 v[4:7], v[164:167], a[32:35], v[4:7]
    s_waitcnt lgkmcnt(10)
    v_mfma_f32_16x16x32_bf16 v[32:35], v[168:171], a[32:35], v[32:35]
    ds_read_b64_tr_b16 v[164:165], v249 offset:36864
    ds_read_b64_tr_b16 v[166:167], v249 offset:37376
    v_mfma_f32_16x16x32_bf16 v[40:43], v[168:171], a[104:107], v[40:43]
    buffer_load_dwordx4 v[132:135], v246, s[20:23], s63 offen offset:3072 sc1
    s_add_u32 s53, s53, 4096
    v_mfma_f32_16x16x32_bf16 v[48:51], v[168:171], a[176:179], v[48:51]
    s_add_u32 s63, s63, 4096
    v_mfma_f32_16x16x32_bf16 v[56:59], v[168:171], a[248:251], v[56:59]
    v_mfma_f32_16x16x32_bf16 v[60:63], v[172:175], a[248:251], v[60:63]
    ds_read_b64_tr_b16 v[168:169], v250 offset:12288
    ds_read_b64_tr_b16 v[170:171], v250 offset:12800
    v_mfma_f32_16x16x32_bf16 v[52:55], v[172:175], a[176:179], v[52:55]
    v_mfma_f32_16x16x32_bf16 v[44:47], v[172:175], a[104:107], v[44:47]
    v_mfma_f32_16x16x32_bf16 v[36:39], v[172:175], a[32:35], v[36:39]
    s_waitcnt lgkmcnt(10)
    v_mfma_f32_16x16x32_bf16 v[64:67], v[176:179], a[32:35], v[64:67]
    ds_read_b64_tr_b16 v[172:173], v250 offset:36864
    ds_read_b64_tr_b16 v[174:175], v250 offset:37376
    v_mfma_f32_16x16x32_bf16 v[72:75], v[176:179], a[104:107], v[72:75]
    v_mfma_f32_16x16x32_bf16 v[80:83], v[176:179], a[176:179], v[80:83]
    v_mfma_f32_16x16x32_bf16 v[88:91], v[176:179], a[248:251], v[88:91]
    v_mfma_f32_16x16x32_bf16 v[92:95], v[180:183], a[248:251], v[92:95]
    ds_read_b64_tr_b16 v[176:177], v251 offset:12288
    ds_read_b64_tr_b16 v[178:179], v251 offset:12800
    v_mfma_f32_16x16x32_bf16 v[84:87], v[180:183], a[176:179], v[84:87]
    v_mfma_f32_16x16x32_bf16 v[76:79], v[180:183], a[104:107], v[76:79]
    v_mfma_f32_16x16x32_bf16 v[68:71], v[180:183], a[32:35], v[68:71]
    s_waitcnt lgkmcnt(10)
    v_mfma_f32_16x16x32_bf16 v[96:99], v[184:187], a[32:35], v[96:99]
    ds_read_b64_tr_b16 v[180:181], v251 offset:36864
    ds_read_b64_tr_b16 v[182:183], v251 offset:37376
    v_mfma_f32_16x16x32_bf16 v[104:107], v[184:187], a[104:107], v[104:107]
    v_mfma_f32_16x16x32_bf16 v[112:115], v[184:187], a[176:179], v[112:115]
    v_mfma_f32_16x16x32_bf16 v[120:123], v[184:187], a[248:251], v[120:123]
    v_mfma_f32_16x16x32_bf16 v[124:127], v[188:191], a[248:251], v[124:127]
    ds_read_b64_tr_b16 v[184:185], v252 offset:12288
    ds_read_b64_tr_b16 v[186:187], v252 offset:12800
    v_mfma_f32_16x16x32_bf16 v[116:119], v[188:191], a[176:179], v[116:119]
    v_mfma_f32_16x16x32_bf16 v[108:111], v[188:191], a[104:107], v[108:111]
    v_mfma_f32_16x16x32_bf16 v[100:103], v[188:191], a[32:35], v[100:103]
    s_waitcnt vmcnt(16)
    s_waitcnt lgkmcnt(10)
    v_mfma_f32_16x16x32_bf16 v[0:3], v[160:163], a[36:39], v[0:3]
    ds_read_b64_tr_b16 v[188:189], v252 offset:36864
    ds_read_b64_tr_b16 v[190:191], v252 offset:37376
    v_mfma_f32_16x16x32_bf16 v[8:11], v[160:163], a[108:111], v[8:11]
    buffer_load_dwordx4 a[48:51], v219, s[20:23], s53 offen offset:0 sc1
    v_mfma_f32_16x16x32_bf16 v[16:19], v[160:163], a[180:183], v[16:19]
    buffer_load_dwordx4 a[120:123], v246, s[20:23], s53 offen offset:0 sc1
    v_mfma_f32_16x16x32_bf16 v[24:27], v[160:163], a[252:255], v[24:27]
    v_mfma_f32_16x16x32_bf16 v[28:31], v[164:167], a[252:255], v[28:31]
    ds_read_b64_tr_b16 v[160:161], v249 offset:16384
    ds_read_b64_tr_b16 v[162:163], v249 offset:16896
    v_mfma_f32_16x16x32_bf16 v[20:23], v[164:167], a[180:183], v[20:23]
    buffer_load_dwordx4 a[192:195], v219, s[20:23], s63 offen offset:0 sc1
    v_mfma_f32_16x16x32_bf16 v[12:15], v[164:167], a[108:111], v[12:15]
    v_mfma_f32_16x16x32_bf16 v[4:7], v[164:167], a[36:39], v[4:7]
    s_waitcnt lgkmcnt(10)
    v_mfma_f32_16x16x32_bf16 v[32:35], v[168:171], a[36:39], v[32:35]
    ds_read_b64_tr_b16 v[164:165], v249 offset:40960
    ds_read_b64_tr_b16 v[166:167], v249 offset:41472
    v_mfma_f32_16x16x32_bf16 v[40:43], v[168:171], a[108:111], v[40:43]
    buffer_load_dwordx4 v[136:139], v246, s[20:23], s63 offen offset:0 sc1
    v_mfma_f32_16x16x32_bf16 v[48:51], v[168:171], a[180:183], v[48:51]
    v_mfma_f32_16x16x32_bf16 v[56:59], v[168:171], a[252:255], v[56:59]
    v_mfma_f32_16x16x32_bf16 v[60:63], v[172:175], a[252:255], v[60:63]
    ds_read_b64_tr_b16 v[168:169], v250 offset:16384
    ds_read_b64_tr_b16 v[170:171], v250 offset:16896
    v_mfma_f32_16x16x32_bf16 v[52:55], v[172:175], a[180:183], v[52:55]
    buffer_load_dwordx4 a[52:55], v219, s[20:23], s53 offen offset:1024 sc1
    v_mfma_f32_16x16x32_bf16 v[44:47], v[172:175], a[108:111], v[44:47]
    v_mfma_f32_16x16x32_bf16 v[36:39], v[172:175], a[36:39], v[36:39]
    s_waitcnt lgkmcnt(10)
    v_mfma_f32_16x16x32_bf16 v[64:67], v[176:179], a[36:39], v[64:67]
    ds_read_b64_tr_b16 v[172:173], v250 offset:40960
    ds_read_b64_tr_b16 v[174:175], v250 offset:41472
    v_mfma_f32_16x16x32_bf16 v[72:75], v[176:179], a[108:111], v[72:75]
    buffer_load_dwordx4 a[124:127], v246, s[20:23], s53 offen offset:1024 sc1
    v_mfma_f32_16x16x32_bf16 v[80:83], v[176:179], a[180:183], v[80:83]
    buffer_load_dwordx4 a[196:199], v219, s[20:23], s63 offen offset:1024 sc1
    v_mfma_f32_16x16x32_bf16 v[88:91], v[176:179], a[252:255], v[88:91]
    v_mfma_f32_16x16x32_bf16 v[92:95], v[180:183], a[252:255], v[92:95]
    ds_read_b64_tr_b16 v[176:177], v251 offset:16384
    ds_read_b64_tr_b16 v[178:179], v251 offset:16896
    v_mfma_f32_16x16x32_bf16 v[84:87], v[180:183], a[180:183], v[84:87]
    buffer_load_dwordx4 v[140:143], v246, s[20:23], s63 offen offset:1024 sc1
    v_mfma_f32_16x16x32_bf16 v[76:79], v[180:183], a[108:111], v[76:79]
    v_mfma_f32_16x16x32_bf16 v[68:71], v[180:183], a[36:39], v[68:71]
    s_waitcnt lgkmcnt(10)
    v_mfma_f32_16x16x32_bf16 v[96:99], v[184:187], a[36:39], v[96:99]
    ds_read_b64_tr_b16 v[180:181], v251 offset:40960
    ds_read_b64_tr_b16 v[182:183], v251 offset:41472
    v_mfma_f32_16x16x32_bf16 v[104:107], v[184:187], a[108:111], v[104:107]
    v_mfma_f32_16x16x32_bf16 v[112:115], v[184:187], a[180:183], v[112:115]
    v_mfma_f32_16x16x32_bf16 v[120:123], v[184:187], a[252:255], v[120:123]
    v_mfma_f32_16x16x32_bf16 v[124:127], v[188:191], a[252:255], v[124:127]
    ds_read_b64_tr_b16 v[184:185], v252 offset:16384
    ds_read_b64_tr_b16 v[186:187], v252 offset:16896
    v_mfma_f32_16x16x32_bf16 v[116:119], v[188:191], a[180:183], v[116:119]
    v_mfma_f32_16x16x32_bf16 v[108:111], v[188:191], a[108:111], v[108:111]
    v_mfma_f32_16x16x32_bf16 v[100:103], v[188:191], a[36:39], v[100:103]
    s_waitcnt vmcnt(16)
    s_waitcnt lgkmcnt(10)
    v_mfma_f32_16x16x32_bf16 v[0:3], v[160:163], a[40:43], v[0:3]
    ds_read_b64_tr_b16 v[188:189], v252 offset:40960
    ds_read_b64_tr_b16 v[190:191], v252 offset:41472
    v_mfma_f32_16x16x32_bf16 v[8:11], v[160:163], a[112:115], v[8:11]
    buffer_load_dwordx4 a[56:59], v219, s[20:23], s53 offen offset:2048 sc1
    v_mfma_f32_16x16x32_bf16 v[16:19], v[160:163], a[184:187], v[16:19]
    buffer_load_dwordx4 a[128:131], v246, s[20:23], s53 offen offset:2048 sc1
    v_mfma_f32_16x16x32_bf16 v[24:27], v[160:163], v[128:131], v[24:27]
    v_mfma_f32_16x16x32_bf16 v[28:31], v[164:167], v[128:131], v[28:31]
    ds_read_b64_tr_b16 v[160:161], v249 offset:20480
    ds_read_b64_tr_b16 v[162:163], v249 offset:20992
    v_mfma_f32_16x16x32_bf16 v[20:23], v[164:167], a[184:187], v[20:23]
    buffer_load_dwordx4 a[200:203], v219, s[20:23], s63 offen offset:2048 sc1
    v_mfma_f32_16x16x32_bf16 v[12:15], v[164:167], a[112:115], v[12:15]
    v_mfma_f32_16x16x32_bf16 v[4:7], v[164:167], a[40:43], v[4:7]
    s_waitcnt lgkmcnt(10)
    v_mfma_f32_16x16x32_bf16 v[32:35], v[168:171], a[40:43], v[32:35]
    ds_read_b64_tr_b16 v[164:165], v249 offset:45056
    ds_read_b64_tr_b16 v[166:167], v249 offset:45568
    v_mfma_f32_16x16x32_bf16 v[40:43], v[168:171], a[112:115], v[40:43]
    buffer_load_dwordx4 v[144:147], v246, s[20:23], s63 offen offset:2048 sc1
    v_mfma_f32_16x16x32_bf16 v[48:51], v[168:171], a[184:187], v[48:51]
    v_mfma_f32_16x16x32_bf16 v[56:59], v[168:171], v[128:131], v[56:59]
    v_mfma_f32_16x16x32_bf16 v[60:63], v[172:175], v[128:131], v[60:63]
    ds_read_b64_tr_b16 v[168:169], v250 offset:20480
    ds_read_b64_tr_b16 v[170:171], v250 offset:20992
    v_mfma_f32_16x16x32_bf16 v[52:55], v[172:175], a[184:187], v[52:55]
    buffer_load_dwordx4 a[60:63], v219, s[20:23], s53 offen offset:3072 sc1
    v_mfma_f32_16x16x32_bf16 v[44:47], v[172:175], a[112:115], v[44:47]
    v_mfma_f32_16x16x32_bf16 v[36:39], v[172:175], a[40:43], v[36:39]
    s_waitcnt lgkmcnt(10)
    v_mfma_f32_16x16x32_bf16 v[64:67], v[176:179], a[40:43], v[64:67]
    ds_read_b64_tr_b16 v[172:173], v250 offset:45056
    ds_read_b64_tr_b16 v[174:175], v250 offset:45568
    v_mfma_f32_16x16x32_bf16 v[72:75], v[176:179], a[112:115], v[72:75]
    buffer_load_dwordx4 a[132:135], v246, s[20:23], s53 offen offset:3072 sc1
    v_mfma_f32_16x16x32_bf16 v[80:83], v[176:179], a[184:187], v[80:83]
    buffer_load_dwordx4 a[204:207], v219, s[20:23], s63 offen offset:3072 sc1
    v_mfma_f32_16x16x32_bf16 v[88:91], v[176:179], v[128:131], v[88:91]
    v_mfma_f32_16x16x32_bf16 v[92:95], v[180:183], v[128:131], v[92:95]
    ds_read_b64_tr_b16 v[176:177], v251 offset:20480
    ds_read_b64_tr_b16 v[178:179], v251 offset:20992
    v_mfma_f32_16x16x32_bf16 v[84:87], v[180:183], a[184:187], v[84:87]
    buffer_load_dwordx4 v[148:151], v246, s[20:23], s63 offen offset:3072 sc1
    s_add_u32 s53, s53, 4096
    v_mfma_f32_16x16x32_bf16 v[76:79], v[180:183], a[112:115], v[76:79]
    s_add_u32 s63, s63, 4096
    v_mfma_f32_16x16x32_bf16 v[68:71], v[180:183], a[40:43], v[68:71]
    s_waitcnt lgkmcnt(10)
    v_mfma_f32_16x16x32_bf16 v[96:99], v[184:187], a[40:43], v[96:99]
    ds_read_b64_tr_b16 v[180:181], v251 offset:45056
    ds_read_b64_tr_b16 v[182:183], v251 offset:45568
    v_mfma_f32_16x16x32_bf16 v[104:107], v[184:187], a[112:115], v[104:107]
    v_mfma_f32_16x16x32_bf16 v[112:115], v[184:187], a[184:187], v[112:115]
    v_mfma_f32_16x16x32_bf16 v[120:123], v[184:187], v[128:131], v[120:123]
    v_mfma_f32_16x16x32_bf16 v[124:127], v[188:191], v[128:131], v[124:127]
    ds_read_b64_tr_b16 v[184:185], v252 offset:20480
    ds_read_b64_tr_b16 v[186:187], v252 offset:20992
    v_mfma_f32_16x16x32_bf16 v[116:119], v[188:191], a[184:187], v[116:119]
    v_mfma_f32_16x16x32_bf16 v[108:111], v[188:191], a[112:115], v[108:111]
    v_mfma_f32_16x16x32_bf16 v[100:103], v[188:191], a[40:43], v[100:103]
    s_waitcnt vmcnt(16)
    s_waitcnt lgkmcnt(10)
    s_barrier
    v_mfma_f32_16x16x32_bf16 v[0:3], v[160:163], a[44:47], v[0:3]
    ds_read_b64_tr_b16 v[188:189], v252 offset:45056
    ds_read_b64_tr_b16 v[190:191], v252 offset:45568
    v_mfma_f32_16x16x32_bf16 v[8:11], v[160:163], a[116:119], v[8:11]
    buffer_load_dwordx4 a[64:67], v219, s[20:23], s53 offen offset:0 sc1
    v_mfma_f32_16x16x32_bf16 v[16:19], v[160:163], a[188:191], v[16:19]
    buffer_load_dwordx4 a[136:139], v246, s[20:23], s53 offen offset:0 sc1
    v_mfma_f32_16x16x32_bf16 v[24:27], v[160:163], v[132:135], v[24:27]
    v_add_u32 v249, 0xc000, v249
    v_mfma_f32_16x16x32_bf16 v[28:31], v[164:167], v[132:135], v[28:31]
    ds_read_b64_tr_b16 v[160:161], v249 offset:0
    ds_read_b64_tr_b16 v[162:163], v249 offset:512
    v_mfma_f32_16x16x32_bf16 v[20:23], v[164:167], a[188:191], v[20:23]
    buffer_load_dwordx4 a[208:211], v219, s[20:23], s63 offen offset:0 sc1
    v_mfma_f32_16x16x32_bf16 v[12:15], v[164:167], a[116:119], v[12:15]
    v_mfma_f32_16x16x32_bf16 v[4:7], v[164:167], a[44:47], v[4:7]
    s_waitcnt lgkmcnt(10)
    v_mfma_f32_16x16x32_bf16 v[32:35], v[168:171], a[44:47], v[32:35]
    ds_read_b64_tr_b16 v[164:165], v249 offset:24576
    ds_read_b64_tr_b16 v[166:167], v249 offset:25088
    v_mfma_f32_16x16x32_bf16 v[40:43], v[168:171], a[116:119], v[40:43]
    buffer_load_dwordx4 v[152:155], v246, s[20:23], s63 offen offset:0 sc1
    v_mfma_f32_16x16x32_bf16 v[48:51], v[168:171], a[188:191], v[48:51]
    v_mfma_f32_16x16x32_bf16 v[56:59], v[168:171], v[132:135], v[56:59]
    v_add_u32 v250, 0xc000, v250
    v_mfma_f32_16x16x32_bf16 v[60:63], v[172:175], v[132:135], v[60:63]
    ds_read_b64_tr_b16 v[168:169], v250 offset:0
    ds_read_b64_tr_b16 v[170:171], v250 offset:512
    v_mfma_f32_16x16x32_bf16 v[52:55], v[172:175], a[188:191], v[52:55]
    buffer_load_dwordx4 a[68:71], v219, s[20:23], s53 offen offset:1024 sc1
    v_mfma_f32_16x16x32_bf16 v[44:47], v[172:175], a[116:119], v[44:47]
    v_mfma_f32_16x16x32_bf16 v[36:39], v[172:175], a[44:47], v[36:39]
    s_waitcnt lgkmcnt(10)
    v_mfma_f32_16x16x32_bf16 v[64:67], v[176:179], a[44:47], v[64:67]
    ds_read_b64_tr_b16 v[172:173], v250 offset:24576
    ds_read_b64_tr_b16 v[174:175], v250 offset:25088
    v_mfma_f32_16x16x32_bf16 v[72:75], v[176:179], a[116:119], v[72:75]
    buffer_load_dwordx4 a[140:143], v246, s[20:23], s53 offen offset:1024 sc1
    v_mfma_f32_16x16x32_bf16 v[80:83], v[176:179], a[188:191], v[80:83]
    buffer_load_dwordx4 a[212:215], v219, s[20:23], s63 offen offset:1024 sc1
    v_mfma_f32_16x16x32_bf16 v[88:91], v[176:179], v[132:135], v[88:91]
    v_mfma_f32_16x16x32_bf16 v[92:95], v[180:183], v[132:135], v[92:95]
    ds_read_b64_tr_b16 v[176:177], v249 offset:4096
    ds_read_b64_tr_b16 v[178:179], v249 offset:4608
    v_mfma_f32_16x16x32_bf16 v[84:87], v[180:183], a[188:191], v[84:87]
    buffer_load_dwordx4 v[156:159], v246, s[20:23], s63 offen offset:1024 sc1
    v_mfma_f32_16x16x32_bf16 v[76:79], v[180:183], a[116:119], v[76:79]
    s_add_u32 m0, s89, 0
    v_mfma_f32_16x16x32_bf16 v[68:71], v[180:183], a[44:47], v[68:71]
H1_S3_0:
    s_cbranch_execz H1_S6_0
    s_waitcnt lgkmcnt(10)
    v_mfma_f32_16x16x32_bf16 v[96:99], v[184:187], a[44:47], v[96:99]
    ds_read_b64_tr_b16 v[180:181], v249 offset:28672
    ds_read_b64_tr_b16 v[182:183], v249 offset:29184
    v_mfma_f32_16x16x32_bf16 v[104:107], v[184:187], a[116:119], v[104:107]
    buffer_load_dwordx4 v248, s[12:15], s61 offen lds
    s_add_u32 s61, s61, 0x24000
    v_mfma_f32_16x16x32_bf16 v[112:115], v[184:187], a[188:191], v[112:115]
    s_add_u32 m0, s89, 2048
    v_mfma_f32_16x16x32_bf16 v[120:123], v[184:187], v[132:135], v[120:123]
    v_mfma_f32_16x16x32_bf16 v[124:127], v[188:191], v[132:135], v[124:127]
    ds_read_b64_tr_b16 v[184:185], v250 offset:4096
    ds_read_b64_tr_b16 v[186:187], v250 offset:4608
    v_mfma_f32_16x16x32_bf16 v[116:119], v[188:191], a[188:191], v[116:119]
    buffer_load_dwordx4 v248, s[12:15], s61 offen lds
    s_add_u32 s61, s61, 0x24000
    v_mfma_f32_16x16x32_bf16 v[108:111], v[188:191], a[116:119], v[108:111]
    s_add_u32 m0, s89, 4096
    v_mfma_f32_16x16x32_bf16 v[100:103], v[188:191], a[44:47], v[100:103]
    s_waitcnt vmcnt(22)
    s_waitcnt lgkmcnt(10)
    v_mfma_f32_16x16x32_bf16 v[0:3], v[160:163], a[48:51], v[0:3]
    ds_read_b64_tr_b16 v[188:189], v250 offset:28672
    ds_read_b64_tr_b16 v[190:191], v250 offset:29184
    v_mfma_f32_16x16x32_bf16 v[8:11], v[160:163], a[120:123], v[8:11]
    buffer_load_dwordx4 v248, s[12:15], s61 offen lds
    s_add_u32 s61, s61, 0x24000
    v_mfma_f32_16x16x32_bf16 v[16:19], v[160:163], a[192:195], v[16:19]
    s_add_u32 m0, s89, 6144
    v_mfma_f32_16x16x32_bf16 v[24:27], v[160:163], v[136:139], v[24:27]
    buffer_load_dwordx4 v248, s[12:15], s61 offen lds
    s_add_u32 s61, s61, 0x24000
    v_mfma_f32_16x16x32_bf16 v[28:31], v[164:167], v[136:139], v[28:31]
    s_add_u32 m0, s89, 8192
    ds_read_b64_tr_b16 v[160:161], v249 offset:8192
    ds_read_b64_tr_b16 v[162:163], v249 offset:8704
    v_mfma_f32_16x16x32_bf16 v[20:23], v[164:167], a[192:195], v[20:23]
    buffer_load_dwordx4 v248, s[12:15], s61 offen lds
    s_add_u32 s61, s61, 0x24000
    v_mfma_f32_16x16x32_bf16 v[12:15], v[164:167], a[120:123], v[12:15]
    s_add_u32 m0, s89, 10240
    v_mfma_f32_16x16x32_bf16 v[4:7], v[164:167], a[48:51], v[4:7]
    s_waitcnt lgkmcnt(10)
    v_mfma_f32_16x16x32_bf16 v[32:35], v[168:171], a[48:51], v[32:35]
    ds_read_b64_tr_b16 v[164:165], v249 offset:32768
    ds_read_b64_tr_b16 v[166:167], v249 offset:33280
    v_mfma_f32_16x16x32_bf16 v[40:43], v[168:171], a[120:123], v[40:43]
    buffer_load_dwordx4 v248, s[12:15], s61 offen lds
    s_add_u32 s61, s61, 0x24000
    v_mfma_f32_16x16x32_bf16 v[48:51], v[168:171], a[192:195], v[48:51]
    s_add_u32 m0, s89, 12288
    v_mfma_f32_16x16x32_bf16 v[56:59], v[168:171], v[136:139], v[56:59]
    v_mfma_f32_16x16x32_bf16 v[60:63], v[172:175], v[136:139], v[60:63]
    ds_read_b64_tr_b16 v[168:169], v250 offset:8192
    ds_read_b64_tr_b16 v[170:171], v250 offset:8704
    v_mfma_f32_16x16x32_bf16 v[52:55], v[172:175], a[192:195], v[52:55]
    buffer_load_dwordx4 v248, s[12:15], s61 offen lds
    s_add_u32 s61, s61, 0x24000
    v_mfma_f32_16x16x32_bf16 v[44:47], v[172:175], a[120:123], v[44:47]
    s_add_u32 m0, s89, 14336
    v_mfma_f32_16x16x32_bf16 v[36:39], v[172:175], a[48:51], v[36:39]
    s_waitcnt vmcnt(23)
    s_waitcnt lgkmcnt(10)
    v_mfma_f32_16x16x32_bf16 v[0:3], v[176:179], a[52:55], v[0:3]
    ds_read_b64_tr_b16 v[172:173], v250 offset:32768
    ds_read_b64_tr_b16 v[174:175], v250 offset:33280
    v_mfma_f32_16x16x32_bf16 v[8:11], v[176:179], a[124:127], v[8:11]
    buffer_load_dwordx4 v248, s[12:15], s61 offen lds
    s_add_u32 s61, s61, 0x24000
    v_mfma_f32_16x16x32_bf16 v[16:19], v[176:179], a[196:199], v[16:19]
    s_add_u32 m0, s89, 16384
    v_mfma_f32_16x16x32_bf16 v[24:27], v[176:179], v[140:143], v[24:27]
    buffer_load_dwordx4 v248, s[12:15], s61 offen lds
    s_add_u32 s61, s61, 0x24000
    v_mfma_f32_16x16x32_bf16 v[28:31], v[180:183], v[140:143], v[28:31]
    s_add_u32 m0, s89, 18432
    ds_read_b64_tr_b16 v[176:177], v249 offset:12288
    ds_read_b64_tr_b16 v[178:179], v249 offset:12800
    v_mfma_f32_16x16x32_bf16 v[20:23], v[180:183], a[196:199], v[20:23]
    buffer_load_dwordx4 v248, s[12:15], s61 offen lds
    s_add_u32 s61, s61, 0x24000
    v_mfma_f32_16x16x32_bf16 v[12:15], v[180:183], a[124:127], v[12:15]
    s_add_u32 m0, s89, 20480
    v_mfma_f32_16x16x32_bf16 v[4:7], v[180:183], a[52:55], v[4:7]
    s_waitcnt lgkmcnt(10)
    v_mfma_f32_16x16x32_bf16 v[32:35], v[184:187], a[52:55], v[32:35]
    ds_read_b64_tr_b16 v[180:181], v249 offset:36864
    ds_read_b64_tr_b16 v[182:183], v249 offset:37376
    v_mfma_f32_16x16x32_bf16 v[40:43], v[184:187], a[124:127], v[40:43]
    buffer_load_dwordx4 v248, s[12:15], s61 offen lds
    s_add_u32 s61, s61, 0x24000
    v_mfma_f32_16x16x32_bf16 v[48:51], v[184:187], a[196:199], v[48:51]
    s_add_u32 m0, s89, 22528
    v_mfma_f32_16x16x32_bf16 v[56:59], v[184:187], v[140:143], v[56:59]
    v_mfma_f32_16x16x32_bf16 v[60:63], v[188:191], v[140:143], v[60:63]
    ds_read_b64_tr_b16 v[184:185], v250 offset:12288
    ds_read_b64_tr_b16 v[186:187], v250 offset:12800
    v_mfma_f32_16x16x32_bf16 v[52:55], v[188:191], a[196:199], v[52:55]
    buffer_load_dwordx4 v248, s[12:15], s61 offen lds
    s_add_u32 s61, s61, 0x24000
    v_mfma_f32_16x16x32_bf16 v[44:47], v[188:191], a[124:127], v[44:47]
    v_mfma_f32_16x16x32_bf16 v[36:39], v[188:191], a[52:55], v[36:39]
    s_waitcnt vmcnt(24)
    s_waitcnt lgkmcnt(10)
    s_barrier
    v_mfma_f32_16x16x32_bf16 v[0:3], v[160:163], a[56:59], v[0:3]
    s_add_u32 m0, s89, 49152
    ds_read_b64_tr_b16 v[188:189], v250 offset:36864
    ds_read_b64_tr_b16 v[190:191], v250 offset:37376
    v_mfma_f32_16x16x32_bf16 v[8:11], v[160:163], a[128:131], v[8:11]
    buffer_load_dwordx4 v248, s[12:15], s61 offen lds
    s_add_u32 s61, s61, 0x24000
    v_mfma_f32_16x16x32_bf16 v[16:19], v[160:163], a[200:203], v[16:19]
    s_add_u32 m0, s89, 51200
    v_mfma_f32_16x16x32_bf16 v[24:27], v[160:163], v[144:147], v[24:27]
    buffer_load_dwordx4 v248, s[12:15], s61 offen lds
    s_add_u32 s61, s61, 0x24000
    v_mfma_f32_16x16x32_bf16 v[28:31], v[164:167], v[144:147], v[28:31]
    s_add_u32 m0, s89, 53248
    ds_read_b64_tr_b16 v[160:161], v249 offset:16384
    ds_read_b64_tr_b16 v[162:163], v249 offset:16896
    v_mfma_f32_16x16x32_bf16 v[20:23], v[164:167], a[200:203], v[20:23]
    buffer_load_dwordx4 v248, s[12:15], s61 offen lds
    s_add_u32 s61, s61, 0x24000
    v_mfma_f32_16x16x32_bf16 v[12:15], v[164:167], a[128:131], v[12:15]
    s_add_u32 m0, s89, 55296
    v_mfma_f32_16x16x32_bf16 v[4:7], v[164:167], a[56:59], v[4:7]
    s_waitcnt lgkmcnt(10)
    v_mfma_f32_16x16x32_bf16 v[32:35], v[168:171], a[56:59], v[32:35]
    ds_read_b64_tr_b16 v[164:165], v249 offset:40960
    ds_read_b64_tr_b16 v[166:167], v249 offset:41472
    v_mfma_f32_16x16x32_bf16 v[40:43], v[168:171], a[128:131], v[40:43]
    buffer_load_dwordx4 v248, s[12:15], s61 offen lds
    s_add_u32 s61, s61, 0x24000
    v_mfma_f32_16x16x32_bf16 v[48:51], v[168:171], a[200:203], v[48:51]
    s_add_u32 m0, s89, 57344
    v_mfma_f32_16x16x32_bf16 v[56:59], v[168:171], v[144:147], v[56:59]
    v_mfma_f32_16x16x32_bf16 v[60:63], v[172:175], v[144:147], v[60:63]
    ds_read_b64_tr_b16 v[168:169], v250 offset:16384
    ds_read_b64_tr_b16 v[170:171], v250 offset:16896
    v_mfma_f32_16x16x32_bf16 v[52:55], v[172:175], a[200:203], v[52:55]
    buffer_load_dwordx4 v248, s[12:15], s61 offen lds
    s_add_u32 s61, s61, 0x24000
    v_mfma_f32_16x16x32_bf16 v[44:47], v[172:175], a[128:131], v[44:47]
    s_add_u32 m0, s89, 59392
    v_mfma_f32_16x16x32_bf16 v[36:39], v[172:175], a[56:59], v[36:39]
    s_waitcnt vmcnt(25)
    s_waitcnt lgkmcnt(10)
    v_mfma_f32_16x16x32_bf16 v[0:3], v[176:179], a[60:63], v[0:3]
    ds_read_b64_tr_b16 v[172:173], v250 offset:40960
    ds_read_b64_tr_b16 v[174:175], v250 offset:41472
    v_mfma_f32_16x16x32_bf16 v[8:11], v[176:179], a[132:135], v[8:11]
    buffer_load_dwordx4 v248, s[12:15], s61 offen lds
    s_add_u32 s61, s61, 0x24000
    v_mfma_f32_16x16x32_bf16 v[16:19], v[176:179], a[204:207], v[16:19]
    s_add_u32 m0, s89, 61440
    v_mfma_f32_16x16x32_bf16 v[24:27], v[176:179], v[148:151], v[24:27]
    buffer_load_dwordx4 v248, s[12:15], s61 offen lds
    s_add_u32 s61, s61, 0x24000
    v_mfma_f32_16x16x32_bf16 v[28:31], v[180:183], v[148:151], v[28:31]
    s_add_u32 m0, s89, 63488
    ds_read_b64_tr_b16 v[176:177], v249 offset:20480
    ds_read_b64_tr_b16 v[178:179], v249 offset:20992
    v_mfma_f32_16x16x32_bf16 v[20:23], v[180:183], a[204:207], v[20:23]
    buffer_load_dwordx4 v248, s[12:15], s61 offen lds
    s_add_u32 s61, s61, 0x24000
    v_mfma_f32_16x16x32_bf16 v[12:15], v[180:183], a[132:135], v[12:15]
    v_mfma_f32_16x16x32_bf16 v[4:7], v[180:183], a[60:63], v[4:7]
    s_waitcnt lgkmcnt(10)
    v_mfma_f32_16x16x32_bf16 v[32:35], v[184:187], a[60:63], v[32:35]
    ds_read_b64_tr_b16 v[180:181], v249 offset:45056
    ds_read_b64_tr_b16 v[182:183], v249 offset:45568
    v_mfma_f32_16x16x32_bf16 v[40:43], v[184:187], a[132:135], v[40:43]
    v_mfma_f32_16x16x32_bf16 v[48:51], v[184:187], a[204:207], v[48:51]
    v_mfma_f32_16x16x32_bf16 v[56:59], v[184:187], v[148:151], v[56:59]
    v_mfma_f32_16x16x32_bf16 v[60:63], v[188:191], v[148:151], v[60:63]
    ds_read_b64_tr_b16 v[184:185], v250 offset:20480
    ds_read_b64_tr_b16 v[186:187], v250 offset:20992
    v_mfma_f32_16x16x32_bf16 v[52:55], v[188:191], a[204:207], v[52:55]
    v_mfma_f32_16x16x32_bf16 v[44:47], v[188:191], a[132:135], v[44:47]
    v_mfma_f32_16x16x32_bf16 v[36:39], v[188:191], a[60:63], v[36:39]
    s_waitcnt vmcnt(24)
    s_waitcnt lgkmcnt(10)
    v_mfma_f32_16x16x32_bf16 v[0:3], v[160:163], a[64:67], v[0:3]
    s_add_u32 m0, s89, 65536
    ds_read_b64_tr_b16 v[188:189], v250 offset:45056
    ds_read_b64_tr_b16 v[190:191], v250 offset:45568
    v_mfma_f32_16x16x32_bf16 v[8:11], v[160:163], a[136:139], v[8:11]
    buffer_load_dwordx4 v248, s[12:15], s61 offen lds
    s_add_u32 s61, s61, 0x24000
    v_mfma_f32_16x16x32_bf16 v[16:19], v[160:163], a[208:211], v[16:19]
    s_add_u32 m0, s89, 67584
    v_mfma_f32_16x16x32_bf16 v[24:27], v[160:163], v[152:155], v[24:27]
    buffer_load_dwordx4 v248, s[12:15], s61 offen lds
    v_add_u32 v251, 0xc000, v251
    v_mfma_f32_16x16x32_bf16 v[28:31], v[164:167], v[152:155], v[28:31]
    s_add_u32 s61, s61, 0x24000
    ds_read_b64_tr_b16 v[160:161], v251 offset:0
    ds_read_b64_tr_b16 v[162:163], v251 offset:512
    v_mfma_f32_16x16x32_bf16 v[20:23], v[164:167], a[208:211], v[20:23]
    s_add_u32 m0, s89, 69632
    v_mfma_f32_16x16x32_bf16 v[12:15], v[164:167], a[136:139], v[12:15]
    buffer_load_dwordx4 v248, s[12:15], s61 offen lds
    s_add_u32 s61, s61, 0x24000
    v_mfma_f32_16x16x32_bf16 v[4:7], v[164:167], a[64:67], v[4:7]
    s_waitcnt lgkmcnt(10)
    s_add_u32 m0, s89, 71680
    v_mfma_f32_16x16x32_bf16 v[32:35], v[168:171], a[64:67], v[32:35]
    ds_read_b64_tr_b16 v[164:165], v251 offset:24576
    ds_read_b64_tr_b16 v[166:167], v251 offset:25088
    v_mfma_f32_16x16x32_bf16 v[40:43], v[168:171], a[136:139], v[40:43]
    buffer_load_dwordx4 v248, s[12:15], s61 offen lds
    s_add_u32 s61, s61, 0x24000
    v_mfma_f32_16x16x32_bf16 v[48:51], v[168:171], a[208:211], v[48:51]
    s_lshl_b32 s3, s37, 1
    s_add_u32 s3, s3, s64
    v_mfma_f32_16x16x32_bf16 v[56:59], v[168:171], v[152:155], v[56:59]
    v_add_u32 v252, 0xc000, v252
    v_mfma_f32_16x16x32_bf16 v[60:63], v[172:175], v[152:155], v[60:63]
    ds_read_b64_tr_b16 v[168:169], v252 offset:0
    ds_read_b64_tr_b16 v[170:171], v252 offset:512
    v_mfma_f32_16x16x32_bf16 v[52:55], v[172:175], a[208:211], v[52:55]
    s_mul_i32 s3, s3, 110592
    s_lshl_b32 s86, s68, 6
    v_mfma_f32_16x16x32_bf16 v[44:47], v[172:175], a[136:139], v[44:47]
    s_add_u32 s3, s3, s86
    s_add_u32 s3, s3, 3539456
    v_mfma_f32_16x16x32_bf16 v[36:39], v[172:175], a[64:67], v[36:39]
    s_waitcnt vmcnt(24)
    s_waitcnt lgkmcnt(10)
    v_mfma_f32_16x16x32_bf16 v[0:3], v[176:179], a[68:71], v[0:3]
    ds_read_b64_tr_b16 v[172:173], v252 offset:24576
    ds_read_b64_tr_b16 v[174:175], v252 offset:25088
    v_mfma_f32_16x16x32_bf16 v[8:11], v[176:179], a[140:143], v[8:11]
    s_lshr_b32 s86, s2, 3
    s_lshl_b32 s86, s86, 1
    v_mfma_f32_16x16x32_bf16 v[16:19], v[176:179], a[212:215], v[16:19]
    s_add_u32 s86, s86, s64
    s_mul_i32 s86, s86, 82944
    v_mfma_f32_16x16x32_bf16 v[24:27], v[176:179], v[156:159], v[24:27]
    s_and_b32 s87, s2, 7
    s_mul_i32 s87, s87, 1152
    v_mfma_f32_16x16x32_bf16 v[28:31], v[180:183], v[156:159], v[28:31]
    ds_read_b64_tr_b16 v[176:177], v251 offset:4096
    ds_read_b64_tr_b16 v[178:179], v251 offset:4608
    v_mfma_f32_16x16x32_bf16 v[20:23], v[180:183], a[212:215], v[20:23]
    s_add_u32 s86, s86, s87
    s_add_u32 s86, s86, 0xfffe5400
    v_mfma_f32_16x16x32_bf16 v[12:15], v[180:183], a[140:143], v[12:15]
    v_min_u32 v240, 20, v208
    v_cmp_gt_u32 vcc, 12, v208
    v_mfma_f32_16x16x32_bf16 v[4:7], v[180:183], a[68:71], v[4:7]
    s_waitcnt lgkmcnt(10)
    v_mfma_f32_16x16x32_bf16 v[32:35], v[184:187], a[68:71], v[32:35]
    ds_read_b64_tr_b16 v[180:181], v251 offset:28672
    ds_read_b64_tr_b16 v[182:183], v251 offset:29184
    v_mfma_f32_16x16x32_bf16 v[40:43], v[184:187], a[140:143], v[40:43]
    v_mfma_f32_16x16x32_bf16 v[48:51], v[184:187], a[212:215], v[48:51]
    v_mfma_f32_16x16x32_bf16 v[56:59], v[184:187], v[156:159], v[56:59]
    v_mfma_f32_16x16x32_bf16 v[60:63], v[188:191], v[156:159], v[60:63]
    ds_read_b64_tr_b16 v[184:185], v252 offset:4096
    ds_read_b64_tr_b16 v[186:187], v252 offset:4608
    v_mfma_f32_16x16x32_bf16 v[52:55], v[188:191], a[212:215], v[52:55]
    v_mfma_f32_16x16x32_bf16 v[44:47], v[188:191], a[140:143], v[44:47]
    v_mfma_f32_16x16x32_bf16 v[36:39], v[188:191], a[68:71], v[36:39]
    s_waitcnt lgkmcnt(10)
    v_mfma_f32_16x16x32_bf16 v[64:67], v[160:163], a[48:51], v[64:67]
    ds_read_b64_tr_b16 v[188:189], v252 offset:28672
    ds_read_b64_tr_b16 v[190:191], v252 offset:29184
    v_mfma_f32_16x16x32_bf16 v[72:75], v[160:163], a[120:123], v[72:75]
    v_mul_u32_u24 v240, 9216, v240
    v_mov_b32 v241, s86
    v_mfma_f32_16x16x32_bf16 v[80:83], v[160:163], a[192:195], v[80:83]
    v_mov_b32 v242, s3
    v_cndmask_b32 v241, v241, v242, vcc
    v_mfma_f32_16x16x32_bf16 v[88:91], v[160:163], v[136:139], v[88:91]
    v_add_u32 v240, v240, v241
    v_mfma_f32_16x16x32_bf16 v[92:95], v[164:167], v[136:139], v[92:95]
    ds_read_b64_tr_b16 v[160:161], v251 offset:8192
    ds_read_b64_tr_b16 v[162:163], v251 offset:8704
    v_mfma_f32_16x16x32_bf16 v[84:87], v[164:167], a[192:195], v[84:87]
    buffer_load_dword v224, v240, s[12:15], 0 offen
    v_mfma_f32_16x16x32_bf16 v[76:79], v[164:167], a[120:123], v[76:79]
    s_lshr_b32 s3, s2, 3
    s_lshl_b32 s3, s3, 2
    v_mul_f32 v192, v0, v0
    v_mfma_f32_16x16x32_bf16 v[68:71], v[164:167], a[48:51], v[68:71]
    s_waitcnt lgkmcnt(10)
    s_add_u32 s3, s3, s36
    s_mul_i32 s3, s3, 17280
    v_mul_f32 v193, v1, v1
    v_mfma_f32_16x16x32_bf16 v[96:99], v[168:171], a[48:51], v[96:99]
    ds_read_b64_tr_b16 v[164:165], v251 offset:32768
    ds_read_b64_tr_b16 v[166:167], v251 offset:33280
    v_mfma_f32_16x16x32_bf16 v[104:107], v[168:171], a[120:123], v[104:107]
    s_and_b32 s86, s2, 7
    s_mul_i32 s86, s86, 384
    v_mul_f32 v194, v2, v2
    v_mul_f32 v195, v3, v3
    v_mul_f32 v196, v32, v32
    v_mul_f32 v197, v33, v33
    v_mul_f32 v198, v34, v34
    v_mul_f32 v199, v35, v35
    v_mul_f32 v4, v0, v4
    v_mul_f32 v5, v1, v5
    v_mfma_f32_16x16x32_bf16 v[112:115], v[168:171], a[192:195], v[112:115]
    s_add_u32 s3, s3, s86
    v_min_u32 v241, 19, v208
    v_mul_f32 v6, v2, v6
    v_mul_f32 v7, v3, v7
    v_mul_f32 v36, v32, v36
    v_mfma_f32_16x16x32_bf16 v[120:123], v[168:171], v[136:139], v[120:123]
    v_lshrrev_b32 v242, 2, v241
    v_mul_u32_u24 v242, 2944, v242
    v_mul_f32 v37, v33, v37
    v_mul_f32 v38, v34, v38
    v_mul_f32 v39, v35, v39
    v_fmaak_f32 v192, v218, v192, 0xc0135761
    v_mfma_f32_16x16x32_bf16 v[124:127], v[172:175], v[136:139], v[124:127]
    ds_read_b64_tr_b16 v[168:169], v252 offset:8192
    ds_read_b64_tr_b16 v[170:171], v252 offset:8704
    v_mfma_f32_16x16x32_bf16 v[116:119], v[172:175], a[192:195], v[116:119]
    v_lshl_add_u32 v242, v241, 7, v242
    v_and_b32 v241, 3, v241
    v_fmaak_f32 v193, v218, v193, 0xc0135761
    v_fmaak_f32 v194, v218, v194, 0xc0135761
    v_fmaak_f32 v195, v218, v195, 0xc0135761
    v_fmaak_f32 v196, v218, v196, 0xc0135761
    v_fmaak_f32 v197, v218, v197, 0xc0135761
    v_fmaak_f32 v198, v218, v198, 0xc0135761
    v_fmaak_f32 v199, v218, v199, 0xc0135761
    v_mul_f32 v192, v192, v0
    v_mfma_f32_16x16x32_bf16 v[108:111], v[172:175], a[120:123], v[108:111]
    v_cmp_eq_u32 vcc, 3, v241
    v_add_u32 v241, s55, v242
    v_mul_f32 v193, v193, v1
    v_mul_f32 v194, v194, v2
    v_mul_f32 v195, v195, v3
    v_mfma_f32_16x16x32_bf16 v[100:103], v[172:175], a[48:51], v[100:103]
    s_waitcnt lgkmcnt(10)
    v_cndmask_b32 v241, v242, v241, vcc
    v_mul_f32 v196, v196, v32
    v_mul_f32 v197, v197, v33
    v_mul_f32 v198, v198, v34
    v_mul_f32 v199, v199, v35
    v_mfma_f32_16x16x32_bf16 v[64:67], v[176:179], a[52:55], v[64:67]
    ds_read_b64_tr_b16 v[172:173], v252 offset:32768
    ds_read_b64_tr_b16 v[174:175], v252 offset:33280
    v_mfma_f32_16x16x32_bf16 v[72:75], v[176:179], a[124:127], v[72:75]
    buffer_load_dword v224, v241, s[16:19], s3 offen
    v_exp_f32 v192, v192
    v_exp_f32 v193, v193
    v_exp_f32 v194, v194
    v_exp_f32 v195, v195
    v_mfma_f32_16x16x32_bf16 v[80:83], v[176:179], a[196:199], v[80:83]
    v_exp_f32 v196, v196
    v_exp_f32 v197, v197
    v_mfma_f32_16x16x32_bf16 v[88:91], v[176:179], v[140:143], v[88:91]
    v_exp_f32 v198, v198
    v_exp_f32 v199, v199
    v_mfma_f32_16x16x32_bf16 v[92:95], v[180:183], v[140:143], v[92:95]
    ds_read_b64_tr_b16 v[176:177], v251 offset:12288
    ds_read_b64_tr_b16 v[178:179], v251 offset:12800
    v_mfma_f32_16x16x32_bf16 v[84:87], v[180:183], a[196:199], v[84:87]
    v_add_f32 v192, 1.0, v192
    v_add_f32 v193, 1.0, v193
    v_add_f32 v194, 1.0, v194
    v_add_f32 v195, 1.0, v195
    v_add_f32 v196, 1.0, v196
    v_add_f32 v197, 1.0, v197
    v_add_f32 v198, 1.0, v198
    v_mfma_f32_16x16x32_bf16 v[76:79], v[180:183], a[124:127], v[76:79]
    v_add_f32 v199, 1.0, v199
    v_rcp_f32 v192, v192
    v_rcp_f32 v193, v193
    v_mfma_f32_16x16x32_bf16 v[68:71], v[180:183], a[52:55], v[68:71]
    s_waitcnt lgkmcnt(10)
    v_rcp_f32 v194, v194
    v_mfma_f32_16x16x32_bf16 v[96:99], v[184:187], a[52:55], v[96:99]
    ds_read_b64_tr_b16 v[180:181], v251 offset:36864
    ds_read_b64_tr_b16 v[182:183], v251 offset:37376
    v_mfma_f32_16x16x32_bf16 v[104:107], v[184:187], a[124:127], v[104:107]
    v_rcp_f32 v195, v195
    v_rcp_f32 v196, v196
    v_rcp_f32 v197, v197
    v_rcp_f32 v198, v198
    v_mfma_f32_16x16x32_bf16 v[112:115], v[184:187], a[196:199], v[112:115]
    v_rcp_f32 v199, v199
    v_mul_f32 v4, v4, v192
    v_mul_f32 v5, v5, v193
    v_mfma_f32_16x16x32_bf16 v[120:123], v[184:187], v[140:143], v[120:123]
    v_mul_f32 v6, v6, v194
    v_mul_f32 v7, v7, v195
    v_mul_f32 v36, v36, v196
    v_mul_f32 v37, v37, v197
    v_mfma_f32_16x16x32_bf16 v[124:127], v[188:191], v[140:143], v[124:127]
    ds_read_b64_tr_b16 v[184:185], v252 offset:12288
    ds_read_b64_tr_b16 v[186:187], v252 offset:12800
    v_mfma_f32_16x16x32_bf16 v[116:119], v[188:191], a[196:199], v[116:119]
    v_mul_f32 v38, v38, v198
    v_mul_f32 v39, v39, v199
    v_cvt_pk_bf16_f32 v192, v4, v5
    v_cvt_pk_bf16_f32 v193, v6, v7
    v_cvt_pk_bf16_f32 v194, v36, v37
    v_cvt_pk_bf16_f32 v195, v38, v39
    v_mfma_f32_16x16x32_bf16 v[108:111], v[188:191], a[124:127], v[108:111]
    buffer_store_dwordx4 v[192:195], v222, s[24:27], s48 offen sc0 sc1
    v_mul_f32 v200, v8, v8
    v_mul_f32 v201, v9, v9
    v_mul_f32 v202, v10, v10
    v_mul_f32 v203, v11, v11
    v_mfma_f32_16x16x32_bf16 v[100:103], v[188:191], a[52:55], v[100:103]
    s_waitcnt lgkmcnt(10)
    v_mul_f32 v204, v40, v40
    v_mul_f32 v205, v41, v41
    v_mul_f32 v206, v42, v42
    v_mul_f32 v207, v43, v43
    v_mfma_f32_16x16x32_bf16 v[64:67], v[160:163], a[56:59], v[64:67]
    ds_read_b64_tr_b16 v[188:189], v252 offset:36864
    ds_read_b64_tr_b16 v[190:191], v252 offset:37376
    v_mfma_f32_16x16x32_bf16 v[72:75], v[160:163], a[128:131], v[72:75]
    v_mul_f32 v12, v8, v12
    v_mul_f32 v13, v9, v13
    v_mul_f32 v14, v10, v14
    v_mul_f32 v15, v11, v15
    v_mul_f32 v44, v40, v44
    v_mul_f32 v45, v41, v45
    v_mul_f32 v46, v42, v46
    v_mfma_f32_16x16x32_bf16 v[80:83], v[160:163], a[200:203], v[80:83]
    v_mul_f32 v47, v43, v47
    v_fmaak_f32 v200, v218, v200, 0xc0135761
    v_fmaak_f32 v201, v218, v201, 0xc0135761
    v_fmaak_f32 v202, v218, v202, 0xc0135761
    v_mfma_f32_16x16x32_bf16 v[88:91], v[160:163], v[144:147], v[88:91]
    v_fmaak_f32 v203, v218, v203, 0xc0135761
    v_fmaak_f32 v204, v218, v204, 0xc0135761
    v_fmaak_f32 v205, v218, v205, 0xc0135761
    v_fmaak_f32 v206, v218, v206, 0xc0135761
    v_mfma_f32_16x16x32_bf16 v[92:95], v[164:167], v[144:147], v[92:95]
    ds_read_b64_tr_b16 v[160:161], v251 offset:16384
    ds_read_b64_tr_b16 v[162:163], v251 offset:16896
    v_mfma_f32_16x16x32_bf16 v[84:87], v[164:167], a[200:203], v[84:87]
    v_fmaak_f32 v207, v218, v207, 0xc0135761
    v_mul_f32 v200, v200, v8
    v_mul_f32 v201, v201, v9
    v_mul_f32 v202, v202, v10
    v_mul_f32 v203, v203, v11
    v_mul_f32 v204, v204, v40
    v_mul_f32 v205, v205, v41
    v_mfma_f32_16x16x32_bf16 v[76:79], v[164:167], a[128:131], v[76:79]
    v_mul_f32 v206, v206, v42
    v_mul_f32 v207, v207, v43
    v_exp_f32 v200, v200
    v_mfma_f32_16x16x32_bf16 v[68:71], v[164:167], a[56:59], v[68:71]
    s_waitcnt lgkmcnt(10)
    v_exp_f32 v201, v201
    v_exp_f32 v202, v202
    v_mfma_f32_16x16x32_bf16 v[96:99], v[168:171], a[56:59], v[96:99]
    ds_read_b64_tr_b16 v[164:165], v251 offset:40960
    ds_read_b64_tr_b16 v[166:167], v251 offset:41472
    v_mfma_f32_16x16x32_bf16 v[104:107], v[168:171], a[128:131], v[104:107]
    v_exp_f32 v203, v203
    v_exp_f32 v204, v204
    v_exp_f32 v205, v205
    v_exp_f32 v206, v206
    v_mfma_f32_16x16x32_bf16 v[112:115], v[168:171], a[200:203], v[112:115]
    v_exp_f32 v207, v207
    v_add_f32 v200, 1.0, v200
    v_mfma_f32_16x16x32_bf16 v[120:123], v[168:171], v[144:147], v[120:123]
    v_add_f32 v201, 1.0, v201
    v_add_f32 v202, 1.0, v202
    v_add_f32 v203, 1.0, v203
    v_add_f32 v204, 1.0, v204
    v_mfma_f32_16x16x32_bf16 v[124:127], v[172:175], v[144:147], v[124:127]
    ds_read_b64_tr_b16 v[168:169], v252 offset:16384
    ds_read_b64_tr_b16 v[170:171], v252 offset:16896
    v_mfma_f32_16x16x32_bf16 v[116:119], v[172:175], a[200:203], v[116:119]
    v_add_f32 v205, 1.0, v205
    v_add_f32 v206, 1.0, v206
    v_add_f32 v207, 1.0, v207
    v_rcp_f32 v200, v200
    v_rcp_f32 v201, v201
    v_rcp_f32 v202, v202
    v_mfma_f32_16x16x32_bf16 v[108:111], v[172:175], a[128:131], v[108:111]
    v_rcp_f32 v203, v203
    v_mfma_f32_16x16x32_bf16 v[100:103], v[172:175], a[56:59], v[100:103]
    s_waitcnt lgkmcnt(10)
    v_rcp_f32 v204, v204
    v_rcp_f32 v205, v205
    v_mfma_f32_16x16x32_bf16 v[64:67], v[176:179], a[60:63], v[64:67]
    ds_read_b64_tr_b16 v[172:173], v252 offset:40960
    ds_read_b64_tr_b16 v[174:175], v252 offset:41472
    v_mfma_f32_16x16x32_bf16 v[72:75], v[176:179], a[132:135], v[72:75]
    v_rcp_f32 v206, v206
    v_rcp_f32 v207, v207
    v_mul_f32 v12, v12, v200
    v_mul_f32 v13, v13, v201
    v_mul_f32 v14, v14, v202
    v_mul_f32 v15, v15, v203
    v_mfma_f32_16x16x32_bf16 v[80:83], v[176:179], a[204:207], v[80:83]
    v_mul_f32 v44, v44, v204
    v_mul_f32 v45, v45, v205
    v_mul_f32 v46, v46, v206
    v_mfma_f32_16x16x32_bf16 v[88:91], v[176:179], v[148:151], v[88:91]
    v_mul_f32 v47, v47, v207
    v_cvt_pk_bf16_f32 v200, v12, v13
    v_cvt_pk_bf16_f32 v201, v14, v15
    v_cvt_pk_bf16_f32 v202, v44, v45
    v_mfma_f32_16x16x32_bf16 v[92:95], v[180:183], v[148:151], v[92:95]
    ds_read_b64_tr_b16 v[176:177], v251 offset:20480
    ds_read_b64_tr_b16 v[178:179], v251 offset:20992
    v_mfma_f32_16x16x32_bf16 v[84:87], v[180:183], a[204:207], v[84:87]
    v_cvt_pk_bf16_f32 v203, v46, v47
    v_mfma_f32_16x16x32_bf16 v[76:79], v[180:183], a[132:135], v[76:79]
    buffer_store_dwordx4 v[200:203], v216, s[24:27], s48 offen sc0 sc1
    v_mul_f32 v192, v16, v16
    v_mul_f32 v193, v17, v17
    v_mul_f32 v194, v18, v18
    v_mul_f32 v195, v19, v19
    v_mul_f32 v196, v48, v48
    v_mul_f32 v197, v49, v49
    v_mul_f32 v198, v50, v50
    v_mul_f32 v199, v51, v51
    v_mul_f32 v20, v16, v20
    v_mul_f32 v21, v17, v21
    v_mfma_f32_16x16x32_bf16 v[68:71], v[180:183], a[60:63], v[68:71]
    s_waitcnt lgkmcnt(10)
    v_mul_f32 v22, v18, v22
    v_mul_f32 v23, v19, v23
    v_mul_f32 v52, v48, v52
    v_mfma_f32_16x16x32_bf16 v[96:99], v[184:187], a[60:63], v[96:99]
    ds_read_b64_tr_b16 v[180:181], v251 offset:45056
    ds_read_b64_tr_b16 v[182:183], v251 offset:45568
    v_mfma_f32_16x16x32_bf16 v[104:107], v[184:187], a[132:135], v[104:107]
    v_mul_f32 v53, v49, v53
    v_mul_f32 v54, v50, v54
    v_mul_f32 v55, v51, v55
    v_fmaak_f32 v192, v218, v192, 0xc0135761
    v_fmaak_f32 v193, v218, v193, 0xc0135761
    v_fmaak_f32 v194, v218, v194, 0xc0135761
    v_fmaak_f32 v195, v218, v195, 0xc0135761
    v_fmaak_f32 v196, v218, v196, 0xc0135761
    v_mfma_f32_16x16x32_bf16 v[112:115], v[184:187], a[204:207], v[112:115]
    v_fmaak_f32 v197, v218, v197, 0xc0135761
    v_fmaak_f32 v198, v218, v198, 0xc0135761
    v_fmaak_f32 v199, v218, v199, 0xc0135761
    v_mul_f32 v192, v192, v16
    v_mfma_f32_16x16x32_bf16 v[120:123], v[184:187], v[148:151], v[120:123]
    v_mul_f32 v193, v193, v17
    v_mul_f32 v194, v194, v18
    v_mul_f32 v195, v195, v19
    v_mfma_f32_16x16x32_bf16 v[124:127], v[188:191], v[148:151], v[124:127]
    ds_read_b64_tr_b16 v[184:185], v252 offset:20480
    ds_read_b64_tr_b16 v[186:187], v252 offset:20992
    v_mfma_f32_16x16x32_bf16 v[116:119], v[188:191], a[204:207], v[116:119]
    v_mul_f32 v196, v196, v48
    v_mul_f32 v197, v197, v49
    v_mul_f32 v198, v198, v50
    v_mul_f32 v199, v199, v51
    v_exp_f32 v192, v192
    v_exp_f32 v193, v193
    v_mfma_f32_16x16x32_bf16 v[108:111], v[188:191], a[132:135], v[108:111]
    v_exp_f32 v194, v194
    v_exp_f32 v195, v195
    v_mfma_f32_16x16x32_bf16 v[100:103], v[188:191], a[60:63], v[100:103]
    s_waitcnt lgkmcnt(10)
    v_exp_f32 v196, v196
    v_exp_f32 v197, v197
    s_waitcnt vmcnt(16)
    s_barrier
    v_mfma_f32_16x16x32_bf16 v[64:67], v[160:163], a[64:67], v[64:67]
    ds_read_b64_tr_b16 v[188:189], v252 offset:45056
    ds_read_b64_tr_b16 v[190:191], v252 offset:45568
    v_mfma_f32_16x16x32_bf16 v[72:75], v[160:163], a[136:139], v[72:75]
    v_exp_f32 v198, v198
    v_exp_f32 v199, v199
    v_add_f32 v192, 1.0, v192
    v_add_f32 v193, 1.0, v193
    v_add_f32 v194, 1.0, v194
    v_mfma_f32_16x16x32_bf16 v[80:83], v[160:163], a[208:211], v[80:83]
    v_add_f32 v195, 1.0, v195
    v_add_f32 v196, 1.0, v196
    v_add_f32 v197, 1.0, v197
    v_add_f32 v198, 1.0, v198
    v_mfma_f32_16x16x32_bf16 v[88:91], v[160:163], v[152:155], v[88:91]
    v_add_u32 v249, 0xfffe8000, v249
    v_add_f32 v199, 1.0, v199
    v_rcp_f32 v192, v192
    v_rcp_f32 v193, v193
    v_mfma_f32_16x16x32_bf16 v[92:95], v[164:167], v[152:155], v[92:95]
    ds_read_b64_tr_b16 v[160:161], v249 offset:0
    ds_read_b64_tr_b16 v[162:163], v249 offset:512
    v_mfma_f32_16x16x32_bf16 v[84:87], v[164:167], a[208:211], v[84:87]
    v_rcp_f32 v194, v194
    v_rcp_f32 v195, v195
    v_rcp_f32 v196, v196
    v_mfma_f32_16x16x32_bf16 v[76:79], v[164:167], a[136:139], v[76:79]
    v_rcp_f32 v197, v197
    v_rcp_f32 v198, v198
    v_mfma_f32_16x16x32_bf16 v[68:71], v[164:167], a[64:67], v[68:71]
    s_waitcnt lgkmcnt(10)
    v_rcp_f32 v199, v199
    v_mul_f32 v20, v20, v192
    v_mul_f32 v21, v21, v193
    v_mfma_f32_16x16x32_bf16 v[96:99], v[168:171], a[64:67], v[96:99]
    ds_read_b64_tr_b16 v[164:165], v249 offset:24576
    ds_read_b64_tr_b16 v[166:167], v249 offset:25088
    v_mfma_f32_16x16x32_bf16 v[104:107], v[168:171], a[136:139], v[104:107]
    v_mul_f32 v22, v22, v194
    v_mul_f32 v23, v23, v195
    v_mul_f32 v52, v52, v196
    v_mul_f32 v53, v53, v197
    v_mul_f32 v54, v54, v198
    v_mul_f32 v55, v55, v199
    v_cvt_pk_bf16_f32 v192, v20, v21
    v_mfma_f32_16x16x32_bf16 v[112:115], v[168:171], a[208:211], v[112:115]
    v_cvt_pk_bf16_f32 v193, v22, v23
    v_cvt_pk_bf16_f32 v194, v52, v53
    v_cvt_pk_bf16_f32 v195, v54, v55
    v_mfma_f32_16x16x32_bf16 v[120:123], v[168:171], v[152:155], v[120:123]
    buffer_store_dwordx4 v[192:195], v222, s[24:27], s49 offen sc0 sc1
    v_add_u32 v250, 0xfffe8000, v250
    v_mul_f32 v200, v24, v24
    v_mul_f32 v201, v25, v25
    v_mul_f32 v202, v26, v26
    v_mul_f32 v203, v27, v27
H1_S4_0:
    s_cbranch_execz H1_S7_0
    v_mfma_f32_16x16x32_bf16 v[124:127], v[172:175], v[152:155], v[124:127]
    ds_read_b64_tr_b16 v[168:169], v250 offset:0
    ds_read_b64_tr_b16 v[170:171], v250 offset:512
    v_mfma_f32_16x16x32_bf16 v[116:119], v[172:175], a[208:211], v[116:119]
    v_mul_f32 v204, v56, v56
    v_mul_f32 v205, v57, v57
    v_mul_f32 v206, v58, v58
    v_mul_f32 v207, v59, v59
    v_mul_f32 v28, v24, v28
    v_mul_f32 v29, v25, v29
    v_mul_f32 v30, v26, v30
    v_mfma_f32_16x16x32_bf16 v[108:111], v[172:175], a[136:139], v[108:111]
    v_mul_f32 v31, v27, v31
    v_mul_f32 v60, v56, v60
    v_mul_f32 v61, v57, v61
    v_mul_f32 v62, v58, v62
    v_mfma_f32_16x16x32_bf16 v[100:103], v[172:175], a[64:67], v[100:103]
    s_waitcnt lgkmcnt(10)
    v_mul_f32 v63, v59, v63
    v_fmaak_f32 v200, v218, v200, 0xc0135761
    v_fmaak_f32 v201, v218, v201, 0xc0135761
    v_fmaak_f32 v202, v218, v202, 0xc0135761
    v_mfma_f32_16x16x32_bf16 v[64:67], v[176:179], a[68:71], v[64:67]
    ds_read_b64_tr_b16 v[172:173], v250 offset:24576
    ds_read_b64_tr_b16 v[174:175], v250 offset:25088
    v_mfma_f32_16x16x32_bf16 v[72:75], v[176:179], a[140:143], v[72:75]
    v_fmaak_f32 v203, v218, v203, 0xc0135761
    v_fmaak_f32 v204, v218, v204, 0xc0135761
    v_fmaak_f32 v205, v218, v205, 0xc0135761
    v_fmaak_f32 v206, v218, v206, 0xc0135761
    v_fmaak_f32 v207, v218, v207, 0xc0135761
    v_mul_f32 v200, v200, v24
    v_mul_f32 v201, v201, v25
    v_mul_f32 v202, v202, v26
    v_mfma_f32_16x16x32_bf16 v[80:83], v[176:179], a[212:215], v[80:83]
    v_mul_f32 v203, v203, v27
    v_mul_f32 v204, v204, v56
    v_mul_f32 v205, v205, v57
    v_mfma_f32_16x16x32_bf16 v[88:91], v[176:179], v[156:159], v[88:91]
    v_mul_f32 v206, v206, v58
    v_mul_f32 v207, v207, v59
    v_exp_f32 v200, v200
    v_mfma_f32_16x16x32_bf16 v[92:95], v[180:183], v[156:159], v[92:95]
    ds_read_b64_tr_b16 v[176:177], v249 offset:4096
    ds_read_b64_tr_b16 v[178:179], v249 offset:4608
    v_mfma_f32_16x16x32_bf16 v[84:87], v[180:183], a[212:215], v[84:87]
    v_exp_f32 v201, v201
    v_exp_f32 v202, v202
    v_exp_f32 v203, v203
    v_exp_f32 v204, v204
    v_mfma_f32_16x16x32_bf16 v[76:79], v[180:183], a[140:143], v[76:79]
    v_exp_f32 v205, v205
    v_exp_f32 v206, v206
    v_mfma_f32_16x16x32_bf16 v[68:71], v[180:183], a[68:71], v[68:71]
    s_waitcnt lgkmcnt(10)
    v_exp_f32 v207, v207
    v_add_f32 v200, 1.0, v200
    v_mfma_f32_16x16x32_bf16 v[96:99], v[184:187], a[68:71], v[96:99]
    ds_read_b64_tr_b16 v[180:181], v249 offset:28672
    ds_read_b64_tr_b16 v[182:183], v249 offset:29184
    v_mfma_f32_16x16x32_bf16 v[104:107], v[184:187], a[140:143], v[104:107]
    v_add_f32 v201, 1.0, v201
    v_add_f32 v202, 1.0, v202
    v_add_f32 v203, 1.0, v203
    v_add_f32 v204, 1.0, v204
    v_add_f32 v205, 1.0, v205
    v_add_f32 v206, 1.0, v206
    v_add_f32 v207, 1.0, v207
    v_rcp_f32 v200, v200
    v_mfma_f32_16x16x32_bf16 v[112:115], v[184:187], a[212:215], v[112:115]
    v_rcp_f32 v201, v201
    v_rcp_f32 v202, v202
    v_mfma_f32_16x16x32_bf16 v[120:123], v[184:187], v[156:159], v[120:123]
    v_rcp_f32 v203, v203
    v_mfma_f32_16x16x32_bf16 v[124:127], v[188:191], v[156:159], v[124:127]
    ds_read_b64_tr_b16 v[184:185], v250 offset:4096
    ds_read_b64_tr_b16 v[186:187], v250 offset:4608
    v_mfma_f32_16x16x32_bf16 v[116:119], v[188:191], a[212:215], v[116:119]
    v_rcp_f32 v204, v204
    v_rcp_f32 v205, v205
    v_rcp_f32 v206, v206
    v_rcp_f32 v207, v207
    v_mfma_f32_16x16x32_bf16 v[108:111], v[188:191], a[140:143], v[108:111]
    v_mul_f32 v28, v28, v200
    v_mul_f32 v29, v29, v201
    v_mul_f32 v30, v30, v202
    v_mul_f32 v31, v31, v203
    v_mfma_f32_16x16x32_bf16 v[100:103], v[188:191], a[68:71], v[100:103]
    s_waitcnt lgkmcnt(12)
    v_mul_f32 v60, v60, v204
    v_mul_f32 v61, v61, v205
    v_mul_f32 v62, v62, v206
    v_mul_f32 v63, v63, v207
    v_cvt_pk_bf16_f32 v200, v28, v29
    v_cvt_pk_bf16_f32 v201, v30, v31
    v_cvt_pk_bf16_f32 v202, v60, v61
    v_cvt_pk_bf16_f32 v203, v62, v63
    buffer_store_dwordx4 v[200:203], v216, s[24:27], s49 offen sc0 sc1
    s_add_u32 s48, s48, 1024
    s_add_u32 s49, s49, 1024
    s_waitcnt lgkmcnt(10)
    v_mfma_f32_16x16x32_bf16 v[0:3], v[160:163], a[0:3], 0
    ds_read_b64_tr_b16 v[188:189], v250 offset:28672
    ds_read_b64_tr_b16 v[190:191], v250 offset:29184
    v_mfma_f32_16x16x32_bf16 v[8:11], v[160:163], a[72:75], 0
    v_mfma_f32_16x16x32_bf16 v[16:19], v[160:163], a[144:147], 0
    v_mfma_f32_16x16x32_bf16 v[24:27], v[160:163], a[216:219], 0
    v_mfma_f32_16x16x32_bf16 v[28:31], v[164:167], a[216:219], 0
    ds_read_b64_tr_b16 v[160:161], v249 offset:8192
    ds_read_b64_tr_b16 v[162:163], v249 offset:8704
    v_mfma_f32_16x16x32_bf16 v[20:23], v[164:167], a[144:147], 0
    v_mfma_f32_16x16x32_bf16 v[12:15], v[164:167], a[72:75], 0
    v_mfma_f32_16x16x32_bf16 v[4:7], v[164:167], a[0:3], 0
    s_waitcnt lgkmcnt(10)
    v_mfma_f32_16x16x32_bf16 v[32:35], v[168:171], a[0:3], 0
    ds_read_b64_tr_b16 v[164:165], v249 offset:32768
    ds_read_b64_tr_b16 v[166:167], v249 offset:33280
    v_mfma_f32_16x16x32_bf16 v[40:43], v[168:171], a[72:75], 0
    v_mul_f32 v192, v64, v64
    v_mul_f32 v193, v65, v65
    v_mfma_f32_16x16x32_bf16 v[48:51], v[168:171], a[144:147], 0
    v_mul_f32 v194, v66, v66
    v_mul_f32 v195, v67, v67
    v_mfma_f32_16x16x32_bf16 v[56:59], v[168:171], a[216:219], 0
    v_mul_f32 v196, v96, v96
    v_mul_f32 v197, v97, v97
    v_mfma_f32_16x16x32_bf16 v[60:63], v[172:175], a[216:219], 0
    ds_read_b64_tr_b16 v[168:169], v250 offset:8192
    ds_read_b64_tr_b16 v[170:171], v250 offset:8704
    v_mfma_f32_16x16x32_bf16 v[52:55], v[172:175], a[144:147], 0
    v_mul_f32 v198, v98, v98
    v_mul_f32 v199, v99, v99
    v_mfma_f32_16x16x32_bf16 v[44:47], v[172:175], a[72:75], 0
    v_mul_f32 v68, v64, v68
    v_mul_f32 v69, v65, v69
    v_mfma_f32_16x16x32_bf16 v[36:39], v[172:175], a[0:3], 0
    s_waitcnt lgkmcnt(10)
    v_mul_f32 v70, v66, v70
    v_mul_f32 v71, v67, v71
    s_waitcnt vmcnt(6)
    s_barrier
    v_mfma_f32_16x16x32_bf16 v[0:3], v[176:179], a[4:7], v[0:3]
    s_add_u32 m0, s89, 98304
    ds_read_b64_tr_b16 v[172:173], v250 offset:32768
    ds_read_b64_tr_b16 v[174:175], v250 offset:33280
    v_mfma_f32_16x16x32_bf16 v[8:11], v[176:179], a[76:79], v[8:11]
    buffer_load_dwordx4 v248, s[12:15], s61 offen lds
    s_add_u32 s61, s61, 0x24000
    v_mfma_f32_16x16x32_bf16 v[16:19], v[176:179], a[148:151], v[16:19]
    s_add_u32 m0, s89, 100352
    v_mul_f32 v100, v96, v100
    v_mul_f32 v101, v97, v101
    v_mfma_f32_16x16x32_bf16 v[24:27], v[176:179], a[220:223], v[24:27]
    buffer_load_dwordx4 v248, s[12:15], s61 offen lds
    s_add_u32 s61, s61, 0x24000
    v_mfma_f32_16x16x32_bf16 v[28:31], v[180:183], a[220:223], v[28:31]
    s_add_u32 m0, s89, 102400
    ds_read_b64_tr_b16 v[176:177], v249 offset:12288
    ds_read_b64_tr_b16 v[178:179], v249 offset:12800
    v_mfma_f32_16x16x32_bf16 v[20:23], v[180:183], a[148:151], v[20:23]
    v_mul_f32 v102, v98, v102
    v_mul_f32 v103, v99, v103
    v_mfma_f32_16x16x32_bf16 v[12:15], v[180:183], a[76:79], v[12:15]
    v_fmaak_f32 v192, v218, v192, 0xc0135761
    v_fmaak_f32 v193, v218, v193, 0xc0135761
    v_mfma_f32_16x16x32_bf16 v[4:7], v[180:183], a[4:7], v[4:7]
    s_waitcnt lgkmcnt(10)
    v_fmaak_f32 v194, v218, v194, 0xc0135761
    v_fmaak_f32 v195, v218, v195, 0xc0135761
    v_mfma_f32_16x16x32_bf16 v[32:35], v[184:187], a[4:7], v[32:35]
    ds_read_b64_tr_b16 v[180:181], v249 offset:36864
    ds_read_b64_tr_b16 v[182:183], v249 offset:37376
    v_mfma_f32_16x16x32_bf16 v[40:43], v[184:187], a[76:79], v[40:43]
    buffer_load_dwordx4 v248, s[12:15], s61 offen lds
    s_add_u32 s61, s61, 0x24000
    v_mfma_f32_16x16x32_bf16 v[48:51], v[184:187], a[148:151], v[48:51]
    s_add_u32 m0, s89, 104448
    v_fmaak_f32 v196, v218, v196, 0xc0135761
    v_fmaak_f32 v197, v218, v197, 0xc0135761
    v_mfma_f32_16x16x32_bf16 v[56:59], v[184:187], a[220:223], v[56:59]
    v_fmaak_f32 v198, v218, v198, 0xc0135761
    v_fmaak_f32 v199, v218, v199, 0xc0135761
    v_mfma_f32_16x16x32_bf16 v[60:63], v[188:191], a[220:223], v[60:63]
    ds_read_b64_tr_b16 v[184:185], v250 offset:12288
    ds_read_b64_tr_b16 v[186:187], v250 offset:12800
    v_mfma_f32_16x16x32_bf16 v[52:55], v[188:191], a[148:151], v[52:55]
    v_mul_f32 v192, v192, v64
    v_mul_f32 v193, v193, v65
    v_mfma_f32_16x16x32_bf16 v[44:47], v[188:191], a[76:79], v[44:47]
    v_mul_f32 v194, v194, v66
    v_mul_f32 v195, v195, v67
    v_mfma_f32_16x16x32_bf16 v[36:39], v[188:191], a[4:7], v[36:39]
    s_waitcnt lgkmcnt(10)
    v_mul_f32 v196, v196, v96
    v_mul_f32 v197, v197, v97
    v_mfma_f32_16x16x32_bf16 v[0:3], v[160:163], a[8:11], v[0:3]
    ds_read_b64_tr_b16 v[188:189], v250 offset:36864
    ds_read_b64_tr_b16 v[190:191], v250 offset:37376
    v_mfma_f32_16x16x32_bf16 v[8:11], v[160:163], a[80:83], v[8:11]
    buffer_load_dwordx4 v248, s[12:15], s61 offen lds
    s_add_u32 s61, s61, 0x24000
    v_mfma_f32_16x16x32_bf16 v[16:19], v[160:163], a[152:155], v[16:19]
    s_add_u32 m0, s89, 106496
    v_mul_f32 v198, v198, v98
    v_mul_f32 v199, v199, v99
    v_mfma_f32_16x16x32_bf16 v[24:27], v[160:163], a[224:227], v[24:27]
    v_exp_f32 v192, v192
    v_mfma_f32_16x16x32_bf16 v[28:31], v[164:167], a[224:227], v[28:31]
    ds_read_b64_tr_b16 v[160:161], v249 offset:16384
    ds_read_b64_tr_b16 v[162:163], v249 offset:16896
    v_mfma_f32_16x16x32_bf16 v[20:23], v[164:167], a[152:155], v[20:23]
    v_exp_f32 v193, v193
    v_mfma_f32_16x16x32_bf16 v[12:15], v[164:167], a[80:83], v[12:15]
    v_exp_f32 v194, v194
    v_mfma_f32_16x16x32_bf16 v[4:7], v[164:167], a[8:11], v[4:7]
    s_waitcnt lgkmcnt(10)
    v_exp_f32 v195, v195
    v_mfma_f32_16x16x32_bf16 v[32:35], v[168:171], a[8:11], v[32:35]
    ds_read_b64_tr_b16 v[164:165], v249 offset:40960
    ds_read_b64_tr_b16 v[166:167], v249 offset:41472
    v_mfma_f32_16x16x32_bf16 v[40:43], v[168:171], a[80:83], v[40:43]
    buffer_load_dwordx4 v248, s[12:15], s61 offen lds
    s_add_u32 s61, s61, 0x24000
    v_mfma_f32_16x16x32_bf16 v[48:51], v[168:171], a[152:155], v[48:51]
    s_add_u32 m0, s89, 108544
    v_exp_f32 v196, v196
    v_mfma_f32_16x16x32_bf16 v[56:59], v[168:171], a[224:227], v[56:59]
    v_exp_f32 v197, v197
    v_mfma_f32_16x16x32_bf16 v[60:63], v[172:175], a[224:227], v[60:63]
    ds_read_b64_tr_b16 v[168:169], v250 offset:16384
    ds_read_b64_tr_b16 v[170:171], v250 offset:16896
    v_mfma_f32_16x16x32_bf16 v[52:55], v[172:175], a[152:155], v[52:55]
    buffer_load_dwordx4 v248, s[12:15], s61 offen lds
    s_add_u32 s61, s61, 0x24000
    v_exp_f32 v198, v198
    v_mfma_f32_16x16x32_bf16 v[44:47], v[172:175], a[80:83], v[44:47]
    s_add_u32 m0, s89, 110592
    v_exp_f32 v199, v199
    v_mfma_f32_16x16x32_bf16 v[36:39], v[172:175], a[8:11], v[36:39]
    s_waitcnt lgkmcnt(10)
    v_add_f32 v192, 1.0, v192
    v_add_f32 v193, 1.0, v193
    v_mfma_f32_16x16x32_bf16 v[0:3], v[176:179], a[12:15], v[0:3]
    ds_read_b64_tr_b16 v[172:173], v250 offset:40960
    ds_read_b64_tr_b16 v[174:175], v250 offset:41472
    v_mfma_f32_16x16x32_bf16 v[8:11], v[176:179], a[84:87], v[8:11]
    v_add_f32 v194, 1.0, v194
    v_add_f32 v195, 1.0, v195
    v_mfma_f32_16x16x32_bf16 v[16:19], v[176:179], a[156:159], v[16:19]
    v_add_f32 v196, 1.0, v196
    v_add_f32 v197, 1.0, v197
    v_mfma_f32_16x16x32_bf16 v[24:27], v[176:179], a[228:231], v[24:27]
    v_add_f32 v198, 1.0, v198
    v_add_f32 v199, 1.0, v199
    v_mfma_f32_16x16x32_bf16 v[28:31], v[180:183], a[228:231], v[28:31]
    ds_read_b64_tr_b16 v[176:177], v249 offset:20480
    ds_read_b64_tr_b16 v[178:179], v249 offset:20992
    v_mfma_f32_16x16x32_bf16 v[20:23], v[180:183], a[156:159], v[20:23]
    buffer_load_dwordx4 v248, s[12:15], s61 offen lds
    s_add_u32 s61, s61, 0x24000
    v_mfma_f32_16x16x32_bf16 v[12:15], v[180:183], a[84:87], v[12:15]
    s_add_u32 m0, s89, 112640
    v_rcp_f32 v192, v192
    v_mfma_f32_16x16x32_bf16 v[4:7], v[180:183], a[12:15], v[4:7]
    s_waitcnt lgkmcnt(10)
    v_rcp_f32 v193, v193
    v_mfma_f32_16x16x32_bf16 v[32:35], v[184:187], a[12:15], v[32:35]
    ds_read_b64_tr_b16 v[180:181], v249 offset:45056
    ds_read_b64_tr_b16 v[182:183], v249 offset:45568
    v_mfma_f32_16x16x32_bf16 v[40:43], v[184:187], a[84:87], v[40:43]
    v_rcp_f32 v194, v194
    v_mfma_f32_16x16x32_bf16 v[48:51], v[184:187], a[156:159], v[48:51]
    v_rcp_f32 v195, v195
    v_mfma_f32_16x16x32_bf16 v[56:59], v[184:187], a[228:231], v[56:59]
    v_rcp_f32 v196, v196
    v_mfma_f32_16x16x32_bf16 v[60:63], v[188:191], a[228:231], v[60:63]
    ds_read_b64_tr_b16 v[184:185], v250 offset:20480
    ds_read_b64_tr_b16 v[186:187], v250 offset:20992
    v_mfma_f32_16x16x32_bf16 v[52:55], v[188:191], a[156:159], v[52:55]
    buffer_load_dwordx4 v248, s[12:15], s61 offen lds
    s_add_u32 s61, s61, 0x24000
    v_mfma_f32_16x16x32_bf16 v[44:47], v[188:191], a[84:87], v[44:47]
    s_add_u32 m0, s89, 114688
    v_rcp_f32 v197, v197
    v_mfma_f32_16x16x32_bf16 v[36:39], v[188:191], a[12:15], v[36:39]
    s_waitcnt lgkmcnt(10)
    v_rcp_f32 v198, v198
    v_mfma_f32_16x16x32_bf16 v[0:3], v[160:163], a[16:19], v[0:3]
    ds_read_b64_tr_b16 v[188:189], v250 offset:45056
    ds_read_b64_tr_b16 v[190:191], v250 offset:45568
    v_mfma_f32_16x16x32_bf16 v[8:11], v[160:163], a[88:91], v[8:11]
    buffer_load_dwordx4 v248, s[12:15], s61 offen lds
    s_add_u32 s61, s61, 0x24000
    v_rcp_f32 v199, v199
    v_mfma_f32_16x16x32_bf16 v[16:19], v[160:163], a[160:163], v[16:19]
    s_add_u32 m0, s89, 116736
    v_mul_f32 v68, v68, v192
    v_mul_f32 v69, v69, v193
    v_mfma_f32_16x16x32_bf16 v[24:27], v[160:163], a[232:235], v[24:27]
    v_add_u32 v249, 0xc000, v249
    v_mul_f32 v70, v70, v194
    v_mfma_f32_16x16x32_bf16 v[28:31], v[164:167], a[232:235], v[28:31]
    ds_read_b64_tr_b16 v[160:161], v249 offset:0
    ds_read_b64_tr_b16 v[162:163], v249 offset:512
    v_mfma_f32_16x16x32_bf16 v[20:23], v[164:167], a[160:163], v[20:23]
    v_mul_f32 v71, v71, v195
    v_mul_f32 v100, v100, v196
    v_mfma_f32_16x16x32_bf16 v[12:15], v[164:167], a[88:91], v[12:15]
    v_mul_f32 v101, v101, v197
    v_mul_f32 v102, v102, v198
    v_mfma_f32_16x16x32_bf16 v[4:7], v[164:167], a[16:19], v[4:7]
    s_waitcnt lgkmcnt(10)
    v_mul_f32 v103, v103, v199
    v_cvt_pk_bf16_f32 v192, v68, v69
    v_mfma_f32_16x16x32_bf16 v[32:35], v[168:171], a[16:19], v[32:35]
    ds_read_b64_tr_b16 v[164:165], v249 offset:24576
    ds_read_b64_tr_b16 v[166:167], v249 offset:25088
    v_mfma_f32_16x16x32_bf16 v[40:43], v[168:171], a[88:91], v[40:43]
    buffer_load_dwordx4 v248, s[12:15], s61 offen lds
    s_add_u32 s61, s61, 0x24000
    v_cvt_pk_bf16_f32 v193, v70, v71
    v_mfma_f32_16x16x32_bf16 v[48:51], v[168:171], a[160:163], v[48:51]
    s_add_u32 m0, s89, 118784
    v_cvt_pk_bf16_f32 v194, v100, v101
    v_cvt_pk_bf16_f32 v195, v102, v103
    v_mfma_f32_16x16x32_bf16 v[56:59], v[168:171], a[232:235], v[56:59]
    buffer_store_dwordx4 v[192:195], v222, s[24:27], s48 offen sc0 sc1
    v_add_u32 v250, 0xc000, v250
    v_mfma_f32_16x16x32_bf16 v[60:63], v[172:175], a[232:235], v[60:63]
    ds_read_b64_tr_b16 v[168:169], v250 offset:0
    ds_read_b64_tr_b16 v[170:171], v250 offset:512
    v_mfma_f32_16x16x32_bf16 v[52:55], v[172:175], a[160:163], v[52:55]
    v_mul_f32 v200, v72, v72
    v_mul_f32 v201, v73, v73
    v_mfma_f32_16x16x32_bf16 v[44:47], v[172:175], a[88:91], v[44:47]
    v_mul_f32 v202, v74, v74
    v_mul_f32 v203, v75, v75
    v_mfma_f32_16x16x32_bf16 v[36:39], v[172:175], a[16:19], v[36:39]
    s_waitcnt lgkmcnt(10)
    v_mul_f32 v204, v104, v104
    v_mul_f32 v205, v105, v105
    v_mfma_f32_16x16x32_bf16 v[0:3], v[176:179], a[20:23], v[0:3]
    ds_read_b64_tr_b16 v[172:173], v250 offset:24576
    ds_read_b64_tr_b16 v[174:175], v250 offset:25088
    v_mfma_f32_16x16x32_bf16 v[8:11], v[176:179], a[92:95], v[8:11]
    buffer_load_dwordx4 v248, s[12:15], s61 offen lds
    s_add_u32 s61, s61, 0x24000
    v_mul_f32 v206, v106, v106
    v_mfma_f32_16x16x32_bf16 v[16:19], v[176:179], a[164:167], v[16:19]
    s_add_u32 m0, s89, 120832
    v_mul_f32 v207, v107, v107
    v_mul_f32 v76, v72, v76
    v_mfma_f32_16x16x32_bf16 v[24:27], v[176:179], a[236:239], v[24:27]
    v_mul_f32 v77, v73, v77
    v_mul_f32 v78, v74, v78
    v_mfma_f32_16x16x32_bf16 v[28:31], v[180:183], a[236:239], v[28:31]
    ds_read_b64_tr_b16 v[176:177], v249 offset:4096
    ds_read_b64_tr_b16 v[178:179], v249 offset:4608
    v_mfma_f32_16x16x32_bf16 v[20:23], v[180:183], a[164:167], v[20:23]
    buffer_load_dwordx4 v248, s[12:15], s61 offen lds
    s_add_u32 s61, s61, 0xffb14200
    v_mul_f32 v79, v75, v79
    v_mul_f32 v108, v104, v108
    v_mfma_f32_16x16x32_bf16 v[12:15], v[180:183], a[92:95], v[12:15]
    v_min_u32 v241, 8, v208
    v_lshlrev_b32 v241, 7, v241
    v_mul_f32 v109, v105, v109
    v_mfma_f32_16x16x32_bf16 v[4:7], v[180:183], a[20:23], v[4:7]
    s_waitcnt lgkmcnt(10)
    v_mul_f32 v110, v106, v110
    v_mul_f32 v111, v107, v111
    v_mfma_f32_16x16x32_bf16 v[32:35], v[184:187], a[20:23], v[32:35]
    ds_read_b64_tr_b16 v[180:181], v249 offset:28672
    ds_read_b64_tr_b16 v[182:183], v249 offset:29184
    v_mfma_f32_16x16x32_bf16 v[40:43], v[184:187], a[92:95], v[40:43]
    v_fmaak_f32 v200, v218, v200, 0xc0135761
    v_fmaak_f32 v201, v218, v201, 0xc0135761
    v_mfma_f32_16x16x32_bf16 v[48:51], v[184:187], a[164:167], v[48:51]
    v_fmaak_f32 v202, v218, v202, 0xc0135761
    v_fmaak_f32 v203, v218, v203, 0xc0135761
    v_mfma_f32_16x16x32_bf16 v[56:59], v[184:187], a[236:239], v[56:59]
    v_fmaak_f32 v204, v218, v204, 0xc0135761
    v_mfma_f32_16x16x32_bf16 v[60:63], v[188:191], a[236:239], v[60:63]
    ds_read_b64_tr_b16 v[184:185], v250 offset:4096
    ds_read_b64_tr_b16 v[186:187], v250 offset:4608
    v_mfma_f32_16x16x32_bf16 v[52:55], v[188:191], a[164:167], v[52:55]
    buffer_load_dword v224, v241, s[80:83], s65 offen
    s_add_u32 s65, s65, 73728
    v_fmaak_f32 v205, v218, v205, 0xc0135761
    v_mfma_f32_16x16x32_bf16 v[44:47], v[188:191], a[92:95], v[44:47]
    v_fmaak_f32 v206, v218, v206, 0xc0135761
    v_fmaak_f32 v207, v218, v207, 0xc0135761
    v_mfma_f32_16x16x32_bf16 v[36:39], v[188:191], a[20:23], v[36:39]
    s_waitcnt lgkmcnt(10)
    v_mul_f32 v200, v200, v72
    v_mul_f32 v201, v201, v73
    v_mfma_f32_16x16x32_bf16 v[0:3], v[160:163], a[24:27], v[0:3]
    ds_read_b64_tr_b16 v[188:189], v250 offset:28672
    ds_read_b64_tr_b16 v[190:191], v250 offset:29184
    v_mfma_f32_16x16x32_bf16 v[8:11], v[160:163], a[96:99], v[8:11]
    v_mul_f32 v202, v202, v74
    v_mul_f32 v203, v203, v75
    v_mfma_f32_16x16x32_bf16 v[16:19], v[160:163], a[168:171], v[16:19]
    v_mul_f32 v204, v204, v104
    v_mul_f32 v205, v205, v105
    v_mfma_f32_16x16x32_bf16 v[24:27], v[160:163], a[240:243], v[24:27]
    v_mul_f32 v206, v206, v106
    v_mul_f32 v207, v207, v107
    v_mfma_f32_16x16x32_bf16 v[28:31], v[164:167], a[240:243], v[28:31]
    ds_read_b64_tr_b16 v[160:161], v249 offset:8192
    ds_read_b64_tr_b16 v[162:163], v249 offset:8704
    v_mfma_f32_16x16x32_bf16 v[20:23], v[164:167], a[168:171], v[20:23]
    v_exp_f32 v200, v200
    v_mfma_f32_16x16x32_bf16 v[12:15], v[164:167], a[96:99], v[12:15]
    v_exp_f32 v201, v201
    v_mfma_f32_16x16x32_bf16 v[4:7], v[164:167], a[24:27], v[4:7]
    s_waitcnt lgkmcnt(10)
    v_exp_f32 v202, v202
    v_mfma_f32_16x16x32_bf16 v[32:35], v[168:171], a[24:27], v[32:35]
    ds_read_b64_tr_b16 v[164:165], v249 offset:32768
    ds_read_b64_tr_b16 v[166:167], v249 offset:33280
    v_mfma_f32_16x16x32_bf16 v[40:43], v[168:171], a[96:99], v[40:43]
    v_exp_f32 v203, v203
    v_mfma_f32_16x16x32_bf16 v[48:51], v[168:171], a[168:171], v[48:51]
    v_exp_f32 v204, v204
    v_mfma_f32_16x16x32_bf16 v[56:59], v[168:171], a[240:243], v[56:59]
    v_exp_f32 v205, v205
    v_mfma_f32_16x16x32_bf16 v[60:63], v[172:175], a[240:243], v[60:63]
    ds_read_b64_tr_b16 v[168:169], v250 offset:8192
    ds_read_b64_tr_b16 v[170:171], v250 offset:8704
    v_mfma_f32_16x16x32_bf16 v[52:55], v[172:175], a[168:171], v[52:55]
    v_exp_f32 v206, v206
    v_mfma_f32_16x16x32_bf16 v[44:47], v[172:175], a[96:99], v[44:47]
    v_exp_f32 v207, v207
    v_mfma_f32_16x16x32_bf16 v[36:39], v[172:175], a[24:27], v[36:39]
    s_waitcnt lgkmcnt(10)
    v_add_f32 v200, 1.0, v200
    v_add_f32 v201, 1.0, v201
    v_mfma_f32_16x16x32_bf16 v[0:3], v[176:179], a[28:31], v[0:3]
    ds_read_b64_tr_b16 v[172:173], v250 offset:32768
    ds_read_b64_tr_b16 v[174:175], v250 offset:33280
    v_mfma_f32_16x16x32_bf16 v[8:11], v[176:179], a[100:103], v[8:11]
    v_add_f32 v202, 1.0, v202
    v_add_f32 v203, 1.0, v203
    v_mfma_f32_16x16x32_bf16 v[16:19], v[176:179], a[172:175], v[16:19]
    v_add_f32 v204, 1.0, v204
    v_add_f32 v205, 1.0, v205
    v_mfma_f32_16x16x32_bf16 v[24:27], v[176:179], a[244:247], v[24:27]
    v_add_f32 v206, 1.0, v206
    v_add_f32 v207, 1.0, v207
    v_mfma_f32_16x16x32_bf16 v[28:31], v[180:183], a[244:247], v[28:31]
    ds_read_b64_tr_b16 v[176:177], v249 offset:12288
    ds_read_b64_tr_b16 v[178:179], v249 offset:12800
    v_mfma_f32_16x16x32_bf16 v[20:23], v[180:183], a[172:175], v[20:23]
    v_rcp_f32 v200, v200
    v_mfma_f32_16x16x32_bf16 v[12:15], v[180:183], a[100:103], v[12:15]
    buffer_load_dword v224, v241, s[80:83], s65 offen
    s_add_u32 s65, s65, 73728
    v_mfma_f32_16x16x32_bf16 v[4:7], v[180:183], a[28:31], v[4:7]
    s_waitcnt lgkmcnt(10)
    v_rcp_f32 v201, v201
    v_mfma_f32_16x16x32_bf16 v[32:35], v[184:187], a[28:31], v[32:35]
    ds_read_b64_tr_b16 v[180:181], v249 offset:36864
    ds_read_b64_tr_b16 v[182:183], v249 offset:37376
    v_mfma_f32_16x16x32_bf16 v[40:43], v[184:187], a[100:103], v[40:43]
    v_rcp_f32 v202, v202
    v_mfma_f32_16x16x32_bf16 v[48:51], v[184:187], a[172:175], v[48:51]
    v_rcp_f32 v203, v203
    v_mfma_f32_16x16x32_bf16 v[56:59], v[184:187], a[244:247], v[56:59]
    v_rcp_f32 v204, v204
    v_mfma_f32_16x16x32_bf16 v[60:63], v[188:191], a[244:247], v[60:63]
    ds_read_b64_tr_b16 v[184:185], v250 offset:12288
    ds_read_b64_tr_b16 v[186:187], v250 offset:12800
    v_mfma_f32_16x16x32_bf16 v[52:55], v[188:191], a[172:175], v[52:55]
    v_rcp_f32 v205, v205
    v_mfma_f32_16x16x32_bf16 v[44:47], v[188:191], a[100:103], v[44:47]
    v_rcp_f32 v206, v206
    v_mfma_f32_16x16x32_bf16 v[36:39], v[188:191], a[28:31], v[36:39]
    s_waitcnt lgkmcnt(10)
    v_rcp_f32 v207, v207
    v_mfma_f32_16x16x32_bf16 v[0:3], v[160:163], a[32:35], v[0:3]
    ds_read_b64_tr_b16 v[188:189], v250 offset:36864
    ds_read_b64_tr_b16 v[190:191], v250 offset:37376
    v_mfma_f32_16x16x32_bf16 v[8:11], v[160:163], a[104:107], v[8:11]
    v_mul_f32 v76, v76, v200
    v_mul_f32 v77, v77, v201
    v_mfma_f32_16x16x32_bf16 v[16:19], v[160:163], a[176:179], v[16:19]
    v_mul_f32 v78, v78, v202
    v_mul_f32 v79, v79, v203
    v_mfma_f32_16x16x32_bf16 v[24:27], v[160:163], a[248:251], v[24:27]
    v_mul_f32 v108, v108, v204
    v_mul_f32 v109, v109, v205
    v_mfma_f32_16x16x32_bf16 v[28:31], v[164:167], a[248:251], v[28:31]
    ds_read_b64_tr_b16 v[160:161], v249 offset:16384
    ds_read_b64_tr_b16 v[162:163], v249 offset:16896
    v_mfma_f32_16x16x32_bf16 v[20:23], v[164:167], a[176:179], v[20:23]
    v_mul_f32 v110, v110, v206
    v_mul_f32 v111, v111, v207
    v_mfma_f32_16x16x32_bf16 v[12:15], v[164:167], a[104:107], v[12:15]
    v_cvt_pk_bf16_f32 v200, v76, v77
    v_cvt_pk_bf16_f32 v201, v78, v79
    v_mfma_f32_16x16x32_bf16 v[4:7], v[164:167], a[32:35], v[4:7]
    s_waitcnt lgkmcnt(10)
    v_cvt_pk_bf16_f32 v202, v108, v109
    v_cvt_pk_bf16_f32 v203, v110, v111
    v_mfma_f32_16x16x32_bf16 v[32:35], v[168:171], a[32:35], v[32:35]
    ds_read_b64_tr_b16 v[164:165], v249 offset:40960
    ds_read_b64_tr_b16 v[166:167], v249 offset:41472
    v_mfma_f32_16x16x32_bf16 v[40:43], v[168:171], a[104:107], v[40:43]
    buffer_store_dwordx4 v[200:203], v216, s[24:27], s48 offen sc0 sc1
    v_mul_f32 v192, v80, v80
    v_mfma_f32_16x16x32_bf16 v[48:51], v[168:171], a[176:179], v[48:51]
    v_mul_f32 v193, v81, v81
    v_lshl_or_b32 v232, v233, 16, v232
    v_mfma_f32_16x16x32_bf16 v[56:59], v[168:171], a[248:251], v[56:59]
    v_lshl_or_b32 v233, v235, 16, v234
    v_lshl_or_b32 v234, v237, 16, v236
    v_mfma_f32_16x16x32_bf16 v[60:63], v[172:175], a[248:251], v[60:63]
    ds_read_b64_tr_b16 v[168:169], v250 offset:16384
    ds_read_b64_tr_b16 v[170:171], v250 offset:16896
    v_mfma_f32_16x16x32_bf16 v[52:55], v[172:175], a[176:179], v[52:55]
    v_lshl_or_b32 v235, v239, 16, v238
    v_mfma_f32_16x16x32_bf16 v[44:47], v[172:175], a[104:107], v[44:47]
    buffer_store_dwordx4 v[232:235], v222, s[76:79], s84 offen sc0 sc1
    v_mfma_f32_16x16x32_bf16 v[36:39], v[172:175], a[32:35], v[36:39]
    s_waitcnt lgkmcnt(10)
    s_add_u32 s76, s10, 41943040
    s_addc_u32 s77, s11, 0
    v_mfma_f32_16x16x32_bf16 v[0:3], v[176:179], a[36:39], v[0:3]
    ds_read_b64_tr_b16 v[172:173], v250 offset:40960
    ds_read_b64_tr_b16 v[174:175], v250 offset:41472
    v_mfma_f32_16x16x32_bf16 v[8:11], v[176:179], a[108:111], v[8:11]
    buffer_load_dword v224, v241, s[80:83], s65 offen
    s_add_u32 s65, s65, 73728
    v_mfma_f32_16x16x32_bf16 v[16:19], v[176:179], a[180:183], v[16:19]
    s_bitcmp1_b32 s4, 8
    s_cselect_b32 s78, 0, 9437184
    v_mfma_f32_16x16x32_bf16 v[24:27], v[176:179], a[252:255], v[24:27]
    s_mov_b32 s79, 0x00020000
    s_and_b32 s3, s2, 7
    v_mfma_f32_16x16x32_bf16 v[28:31], v[180:183], a[252:255], v[28:31]
    ds_read_b64_tr_b16 v[176:177], v249 offset:20480
    ds_read_b64_tr_b16 v[178:179], v249 offset:20992
    v_mfma_f32_16x16x32_bf16 v[20:23], v[180:183], a[180:183], v[20:23]
    s_lshl_b32 s3, s3, 3
    s_lshr_b32 s51, s2, 5
    s_add_u32 s3, s3, s51
    s_lshl_b32 s3, s3, 1
    s_add_u32 s3, s3, s64
    s_lshl_b32 s3, s3, 1
    s_lshr_b32 s51, s36, 1
    s_add_u32 s3, s3, s51
    s_mul_i32 s3, s3, 36
    s_bfe_u32 s51, s2, 0x20003
    s_mul_i32 s51, s51, 9
    s_add_u32 s3, s3, s51
    s_lshl_b32 s3, s3, 10
    v_mov_b32 v236, -1
    v_mov_b32 v237, -1
    v_mfma_f32_16x16x32_bf16 v[12:15], v[180:183], a[108:111], v[12:15]
    v_mov_b32 v238, -1
    v_mov_b32 v239, -1
    v_mfma_f32_16x16x32_bf16 v[4:7], v[180:183], a[36:39], v[4:7]
    s_waitcnt lgkmcnt(10)
    v_mul_f32 v194, v82, v82
    v_mul_f32 v195, v83, v83
    v_mfma_f32_16x16x32_bf16 v[32:35], v[184:187], a[36:39], v[32:35]
    ds_read_b64_tr_b16 v[180:181], v249 offset:45056
    ds_read_b64_tr_b16 v[182:183], v249 offset:45568
    v_mfma_f32_16x16x32_bf16 v[40:43], v[184:187], a[108:111], v[40:43]
    v_mul_f32 v196, v112, v112
    v_mul_f32 v197, v113, v113
    v_mfma_f32_16x16x32_bf16 v[48:51], v[184:187], a[180:183], v[48:51]
    v_mul_f32 v198, v114, v114
    v_mul_f32 v199, v115, v115
    v_mfma_f32_16x16x32_bf16 v[56:59], v[184:187], a[252:255], v[56:59]
    v_mul_f32 v84, v80, v84
    v_mul_f32 v85, v81, v85
    v_mfma_f32_16x16x32_bf16 v[60:63], v[188:191], a[252:255], v[60:63]
    ds_read_b64_tr_b16 v[184:185], v250 offset:20480
    ds_read_b64_tr_b16 v[186:187], v250 offset:20992
    v_mfma_f32_16x16x32_bf16 v[52:55], v[188:191], a[180:183], v[52:55]
    v_mul_f32 v86, v82, v86
    v_mul_f32 v87, v83, v87
    v_mfma_f32_16x16x32_bf16 v[44:47], v[188:191], a[108:111], v[44:47]
    v_mul_f32 v116, v112, v116
    v_mul_f32 v117, v113, v117
    v_mfma_f32_16x16x32_bf16 v[36:39], v[188:191], a[36:39], v[36:39]
    s_waitcnt lgkmcnt(10)
    v_mul_f32 v118, v114, v118
    v_mul_f32 v119, v115, v119
    s_waitcnt vmcnt(5)
    s_barrier
    v_mfma_f32_16x16x32_bf16 v[0:3], v[160:163], a[40:43], v[0:3]
    ds_read_b64_tr_b16 v[188:189], v250 offset:45056
    ds_read_b64_tr_b16 v[190:191], v250 offset:45568
    v_mfma_f32_16x16x32_bf16 v[8:11], v[160:163], a[112:115], v[8:11]
    v_fmaak_f32 v192, v218, v192, 0xc0135761
    v_fmaak_f32 v193, v218, v193, 0xc0135761
    v_mfma_f32_16x16x32_bf16 v[16:19], v[160:163], a[184:187], v[16:19]
    v_fmaak_f32 v194, v218, v194, 0xc0135761
    v_fmaak_f32 v195, v218, v195, 0xc0135761
    v_mfma_f32_16x16x32_bf16 v[24:27], v[160:163], v[128:131], v[24:27]
    v_add_u32 v249, 0xc000, v249
    v_fmaak_f32 v196, v218, v196, 0xc0135761
    v_mfma_f32_16x16x32_bf16 v[28:31], v[164:167], v[128:131], v[28:31]
    ds_read_b64_tr_b16 v[160:161], v249 offset:0
    ds_read_b64_tr_b16 v[162:163], v249 offset:512
    v_mfma_f32_16x16x32_bf16 v[20:23], v[164:167], a[184:187], v[20:23]
    v_fmaak_f32 v197, v218, v197, 0xc0135761
    v_fmaak_f32 v198, v218, v198, 0xc0135761
    v_mfma_f32_16x16x32_bf16 v[12:15], v[164:167], a[112:115], v[12:15]
    v_fmaak_f32 v199, v218, v199, 0xc0135761
    v_mul_f32 v192, v192, v80
    v_mfma_f32_16x16x32_bf16 v[4:7], v[164:167], a[40:43], v[4:7]
    s_waitcnt lgkmcnt(10)
    v_mul_f32 v193, v193, v81
    v_mul_f32 v194, v194, v82
    v_mfma_f32_16x16x32_bf16 v[32:35], v[168:171], a[40:43], v[32:35]
    ds_read_b64_tr_b16 v[164:165], v249 offset:24576
    ds_read_b64_tr_b16 v[166:167], v249 offset:25088
    v_mfma_f32_16x16x32_bf16 v[40:43], v[168:171], a[112:115], v[40:43]
    buffer_load_dword v224, v241, s[80:83], s65 offen
    s_add_u32 s65, s65, 73728
    v_mfma_f32_16x16x32_bf16 v[48:51], v[168:171], a[184:187], v[48:51]
    v_mul_f32 v195, v195, v83
    v_mul_f32 v196, v196, v112
    v_mfma_f32_16x16x32_bf16 v[56:59], v[168:171], v[128:131], v[56:59]
    v_add_u32 v250, 0xc000, v250
H1_S5_0:
    s_cbranch_execz H1_S8_0
    v_mul_f32 v197, v197, v113
    v_mfma_f32_16x16x32_bf16 v[60:63], v[172:175], v[128:131], v[60:63]
    ds_read_b64_tr_b16 v[168:169], v250 offset:0
    ds_read_b64_tr_b16 v[170:171], v250 offset:512
    v_mfma_f32_16x16x32_bf16 v[52:55], v[172:175], a[184:187], v[52:55]
    v_mul_f32 v198, v198, v114
    v_mul_f32 v199, v199, v115
    v_mfma_f32_16x16x32_bf16 v[44:47], v[172:175], a[112:115], v[44:47]
    v_exp_f32 v192, v192
    v_mfma_f32_16x16x32_bf16 v[36:39], v[172:175], a[40:43], v[36:39]
    s_waitcnt lgkmcnt(10)
    v_exp_f32 v193, v193
    v_mfma_f32_16x16x32_bf16 v[0:3], v[176:179], a[44:47], v[0:3]
    ds_read_b64_tr_b16 v[172:173], v250 offset:24576
    ds_read_b64_tr_b16 v[174:175], v250 offset:25088
    v_mfma_f32_16x16x32_bf16 v[8:11], v[176:179], a[116:119], v[8:11]
    v_exp_f32 v194, v194
    v_mfma_f32_16x16x32_bf16 v[16:19], v[176:179], a[188:191], v[16:19]
    v_exp_f32 v195, v195
    v_mfma_f32_16x16x32_bf16 v[24:27], v[176:179], v[132:135], v[24:27]
    v_exp_f32 v196, v196
    v_mfma_f32_16x16x32_bf16 v[28:31], v[180:183], v[132:135], v[28:31]
    ds_read_b64_tr_b16 v[176:177], v249 offset:4096
    ds_read_b64_tr_b16 v[178:179], v249 offset:4608
    v_mfma_f32_16x16x32_bf16 v[20:23], v[180:183], a[188:191], v[20:23]
    v_exp_f32 v197, v197
    v_mfma_f32_16x16x32_bf16 v[12:15], v[180:183], a[116:119], v[12:15]
    v_exp_f32 v198, v198
    v_mfma_f32_16x16x32_bf16 v[4:7], v[180:183], a[44:47], v[4:7]
    s_waitcnt lgkmcnt(10)
    v_exp_f32 v199, v199
    v_mfma_f32_16x16x32_bf16 v[32:35], v[184:187], a[44:47], v[32:35]
    ds_read_b64_tr_b16 v[180:181], v249 offset:28672
    ds_read_b64_tr_b16 v[182:183], v249 offset:29184
    v_mfma_f32_16x16x32_bf16 v[40:43], v[184:187], a[116:119], v[40:43]
    v_add_f32 v192, 1.0, v192
    v_add_f32 v193, 1.0, v193
    v_mfma_f32_16x16x32_bf16 v[48:51], v[184:187], a[188:191], v[48:51]
    v_add_f32 v194, 1.0, v194
    v_add_f32 v195, 1.0, v195
    v_mfma_f32_16x16x32_bf16 v[56:59], v[184:187], v[132:135], v[56:59]
    v_add_f32 v196, 1.0, v196
    v_add_f32 v197, 1.0, v197
    v_mfma_f32_16x16x32_bf16 v[60:63], v[188:191], v[132:135], v[60:63]
    ds_read_b64_tr_b16 v[184:185], v250 offset:4096
    ds_read_b64_tr_b16 v[186:187], v250 offset:4608
    v_mfma_f32_16x16x32_bf16 v[52:55], v[188:191], a[188:191], v[52:55]
    v_add_f32 v198, 1.0, v198
    v_add_f32 v199, 1.0, v199
    v_mfma_f32_16x16x32_bf16 v[44:47], v[188:191], a[116:119], v[44:47]
    v_rcp_f32 v192, v192
    v_mfma_f32_16x16x32_bf16 v[36:39], v[188:191], a[44:47], v[36:39]
    s_waitcnt lgkmcnt(10)
    v_rcp_f32 v193, v193
    v_mfma_f32_16x16x32_bf16 v[0:3], v[160:163], a[48:51], v[0:3]
    ds_read_b64_tr_b16 v[188:189], v250 offset:28672
    ds_read_b64_tr_b16 v[190:191], v250 offset:29184
    v_mfma_f32_16x16x32_bf16 v[8:11], v[160:163], a[120:123], v[8:11]
    v_rcp_f32 v194, v194
    v_mfma_f32_16x16x32_bf16 v[16:19], v[160:163], a[192:195], v[16:19]
    v_rcp_f32 v195, v195
    v_mfma_f32_16x16x32_bf16 v[24:27], v[160:163], v[136:139], v[24:27]
    v_rcp_f32 v196, v196
    v_mfma_f32_16x16x32_bf16 v[28:31], v[164:167], v[136:139], v[28:31]
    ds_read_b64_tr_b16 v[160:161], v249 offset:8192
    ds_read_b64_tr_b16 v[162:163], v249 offset:8704
    v_mfma_f32_16x16x32_bf16 v[20:23], v[164:167], a[192:195], v[20:23]
    v_rcp_f32 v197, v197
    v_mfma_f32_16x16x32_bf16 v[12:15], v[164:167], a[120:123], v[12:15]
    v_rcp_f32 v198, v198
    v_mfma_f32_16x16x32_bf16 v[4:7], v[164:167], a[48:51], v[4:7]
    s_waitcnt lgkmcnt(10)
    buffer_load_dword v224, v241, s[80:83], s65 offen
    s_add_u32 s65, s65, 73728
    v_mfma_f32_16x16x32_bf16 v[32:35], v[168:171], a[48:51], v[32:35]
    ds_read_b64_tr_b16 v[164:165], v249 offset:32768
    ds_read_b64_tr_b16 v[166:167], v249 offset:33280
    v_mfma_f32_16x16x32_bf16 v[40:43], v[168:171], a[120:123], v[40:43]
    v_rcp_f32 v199, v199
    v_mfma_f32_16x16x32_bf16 v[48:51], v[168:171], a[192:195], v[48:51]
    v_mul_f32 v84, v84, v192
    v_mul_f32 v85, v85, v193
    v_mfma_f32_16x16x32_bf16 v[56:59], v[168:171], v[136:139], v[56:59]
    v_mul_f32 v86, v86, v194
    v_mul_f32 v87, v87, v195
    v_mfma_f32_16x16x32_bf16 v[60:63], v[172:175], v[136:139], v[60:63]
    ds_read_b64_tr_b16 v[168:169], v250 offset:8192
    ds_read_b64_tr_b16 v[170:171], v250 offset:8704
    v_mfma_f32_16x16x32_bf16 v[52:55], v[172:175], a[192:195], v[52:55]
    v_mul_f32 v116, v116, v196
    v_mul_f32 v117, v117, v197
    v_mfma_f32_16x16x32_bf16 v[44:47], v[172:175], a[120:123], v[44:47]
    v_mul_f32 v118, v118, v198
    v_mul_f32 v119, v119, v199
    v_mfma_f32_16x16x32_bf16 v[36:39], v[172:175], a[48:51], v[36:39]
    s_waitcnt lgkmcnt(10)
    v_cvt_pk_bf16_f32 v192, v84, v85
    v_cvt_pk_bf16_f32 v193, v86, v87
    v_mfma_f32_16x16x32_bf16 v[0:3], v[176:179], a[52:55], v[0:3]
    ds_read_b64_tr_b16 v[172:173], v250 offset:32768
    ds_read_b64_tr_b16 v[174:175], v250 offset:33280
    v_mfma_f32_16x16x32_bf16 v[8:11], v[176:179], a[124:127], v[8:11]
    v_cvt_pk_bf16_f32 v194, v116, v117
    v_cvt_pk_bf16_f32 v195, v118, v119
    v_mfma_f32_16x16x32_bf16 v[16:19], v[176:179], a[196:199], v[16:19]
    buffer_store_dwordx4 v[192:195], v222, s[24:27], s49 offen sc0 sc1
    v_mul_f32 v200, v88, v88
    v_mfma_f32_16x16x32_bf16 v[24:27], v[176:179], v[140:143], v[24:27]
    v_mul_f32 v201, v89, v89
    v_mul_f32 v202, v90, v90
    v_mfma_f32_16x16x32_bf16 v[28:31], v[180:183], v[140:143], v[28:31]
    ds_read_b64_tr_b16 v[176:177], v249 offset:12288
    ds_read_b64_tr_b16 v[178:179], v249 offset:12800
    v_mfma_f32_16x16x32_bf16 v[20:23], v[180:183], a[196:199], v[20:23]
    v_mul_f32 v203, v91, v91
    v_min_u32 v253, 7, v208
    v_mfma_f32_16x16x32_bf16 v[12:15], v[180:183], a[124:127], v[12:15]
    v_lshlrev_b32 v253, 5, v253
    v_mfma_f32_16x16x32_bf16 v[4:7], v[180:183], a[52:55], v[4:7]
    s_waitcnt lgkmcnt(10)
    buffer_load_dword v254, v253, s[96:99], 0 offen sc1
    v_mul_f32 v204, v120, v120
    v_mfma_f32_16x16x32_bf16 v[32:35], v[184:187], a[52:55], v[32:35]
    ds_read_b64_tr_b16 v[180:181], v249 offset:36864
    ds_read_b64_tr_b16 v[182:183], v249 offset:37376
    v_mfma_f32_16x16x32_bf16 v[40:43], v[184:187], a[124:127], v[40:43]
    v_mul_f32 v205, v121, v121
    v_mul_f32 v206, v122, v122
    v_mfma_f32_16x16x32_bf16 v[48:51], v[184:187], a[196:199], v[48:51]
    v_mul_f32 v207, v123, v123
    v_mul_f32 v92, v88, v92
    v_mfma_f32_16x16x32_bf16 v[56:59], v[184:187], v[140:143], v[56:59]
    v_mul_f32 v93, v89, v93
    v_mul_f32 v94, v90, v94
    v_mfma_f32_16x16x32_bf16 v[60:63], v[188:191], v[140:143], v[60:63]
    ds_read_b64_tr_b16 v[184:185], v250 offset:12288
    ds_read_b64_tr_b16 v[186:187], v250 offset:12800
    v_mfma_f32_16x16x32_bf16 v[52:55], v[188:191], a[196:199], v[52:55]
    v_mul_f32 v95, v91, v95
    v_mul_f32 v124, v120, v124
    v_mfma_f32_16x16x32_bf16 v[44:47], v[188:191], a[124:127], v[44:47]
    v_mul_f32 v125, v121, v125
    v_mul_f32 v126, v122, v126
    v_mfma_f32_16x16x32_bf16 v[36:39], v[188:191], a[52:55], v[36:39]
    s_waitcnt lgkmcnt(10)
    v_mul_f32 v127, v123, v127
    v_fmaak_f32 v200, v218, v200, 0xc0135761
    v_mfma_f32_16x16x32_bf16 v[0:3], v[160:163], a[56:59], v[0:3]
    ds_read_b64_tr_b16 v[188:189], v250 offset:36864
    ds_read_b64_tr_b16 v[190:191], v250 offset:37376
    v_mfma_f32_16x16x32_bf16 v[8:11], v[160:163], a[128:131], v[8:11]
    v_fmaak_f32 v201, v218, v201, 0xc0135761
    v_fmaak_f32 v202, v218, v202, 0xc0135761
    v_mfma_f32_16x16x32_bf16 v[16:19], v[160:163], a[200:203], v[16:19]
    v_fmaak_f32 v203, v218, v203, 0xc0135761
    v_fmaak_f32 v204, v218, v204, 0xc0135761
    v_mfma_f32_16x16x32_bf16 v[24:27], v[160:163], v[144:147], v[24:27]
    buffer_load_dword v224, v241, s[80:83], s65 offen
    s_add_u32 s65, s65, 73728
    v_mfma_f32_16x16x32_bf16 v[28:31], v[164:167], v[144:147], v[28:31]
    ds_read_b64_tr_b16 v[160:161], v249 offset:16384
    ds_read_b64_tr_b16 v[162:163], v249 offset:16896
    v_mfma_f32_16x16x32_bf16 v[20:23], v[164:167], a[200:203], v[20:23]
    v_fmaak_f32 v205, v218, v205, 0xc0135761
    v_fmaak_f32 v206, v218, v206, 0xc0135761
    v_mfma_f32_16x16x32_bf16 v[12:15], v[164:167], a[128:131], v[12:15]
    v_fmaak_f32 v207, v218, v207, 0xc0135761
    v_mfma_f32_16x16x32_bf16 v[4:7], v[164:167], a[56:59], v[4:7]
    s_waitcnt lgkmcnt(10)
    buffer_store_dwordx4 v[236:239], v222, s[76:79], s3 offen offset:0 sc0 sc1
    v_mul_f32 v200, v200, v88
    v_mfma_f32_16x16x32_bf16 v[32:35], v[168:171], a[56:59], v[32:35]
    ds_read_b64_tr_b16 v[164:165], v249 offset:40960
    ds_read_b64_tr_b16 v[166:167], v249 offset:41472
    v_mfma_f32_16x16x32_bf16 v[40:43], v[168:171], a[128:131], v[40:43]
    v_mul_f32 v201, v201, v89
    v_mul_f32 v202, v202, v90
    v_mfma_f32_16x16x32_bf16 v[48:51], v[168:171], a[200:203], v[48:51]
    v_mul_f32 v203, v203, v91
    v_mul_f32 v204, v204, v120
    v_mfma_f32_16x16x32_bf16 v[56:59], v[168:171], v[144:147], v[56:59]
    v_mul_f32 v205, v205, v121
    v_mul_f32 v206, v206, v122
    v_mfma_f32_16x16x32_bf16 v[60:63], v[172:175], v[144:147], v[60:63]
    ds_read_b64_tr_b16 v[168:169], v250 offset:16384
    ds_read_b64_tr_b16 v[170:171], v250 offset:16896
    v_mfma_f32_16x16x32_bf16 v[52:55], v[172:175], a[200:203], v[52:55]
    v_mul_f32 v207, v207, v123
    v_mfma_f32_16x16x32_bf16 v[44:47], v[172:175], a[128:131], v[44:47]
    v_exp_f32 v200, v200
    v_mfma_f32_16x16x32_bf16 v[36:39], v[172:175], a[56:59], v[36:39]
    s_waitcnt lgkmcnt(10)
    v_exp_f32 v201, v201
    v_mfma_f32_16x16x32_bf16 v[0:3], v[176:179], a[60:63], v[0:3]
    ds_read_b64_tr_b16 v[172:173], v250 offset:40960
    ds_read_b64_tr_b16 v[174:175], v250 offset:41472
    v_mfma_f32_16x16x32_bf16 v[8:11], v[176:179], a[132:135], v[8:11]
    v_exp_f32 v202, v202
    v_mfma_f32_16x16x32_bf16 v[16:19], v[176:179], a[204:207], v[16:19]
    v_exp_f32 v203, v203
    v_mfma_f32_16x16x32_bf16 v[24:27], v[176:179], v[148:151], v[24:27]
    v_exp_f32 v204, v204
    v_mfma_f32_16x16x32_bf16 v[28:31], v[180:183], v[148:151], v[28:31]
    ds_read_b64_tr_b16 v[176:177], v249 offset:20480
    ds_read_b64_tr_b16 v[178:179], v249 offset:20992
    v_mfma_f32_16x16x32_bf16 v[20:23], v[180:183], a[204:207], v[20:23]
    v_exp_f32 v205, v205
    v_mfma_f32_16x16x32_bf16 v[12:15], v[180:183], a[132:135], v[12:15]
    v_exp_f32 v206, v206
    v_mfma_f32_16x16x32_bf16 v[4:7], v[180:183], a[60:63], v[4:7]
    s_waitcnt lgkmcnt(10)
    v_exp_f32 v207, v207
    v_mfma_f32_16x16x32_bf16 v[32:35], v[184:187], a[60:63], v[32:35]
    ds_read_b64_tr_b16 v[180:181], v249 offset:45056
    ds_read_b64_tr_b16 v[182:183], v249 offset:45568
    v_mfma_f32_16x16x32_bf16 v[40:43], v[184:187], a[132:135], v[40:43]
    v_add_f32 v200, 1.0, v200
    v_add_f32 v201, 1.0, v201
    v_mfma_f32_16x16x32_bf16 v[48:51], v[184:187], a[204:207], v[48:51]
    v_add_f32 v202, 1.0, v202
    v_add_f32 v203, 1.0, v203
    v_mfma_f32_16x16x32_bf16 v[56:59], v[184:187], v[148:151], v[56:59]
    v_add_f32 v204, 1.0, v204
    v_add_f32 v205, 1.0, v205
    v_mfma_f32_16x16x32_bf16 v[60:63], v[188:191], v[148:151], v[60:63]
    ds_read_b64_tr_b16 v[184:185], v250 offset:20480
    ds_read_b64_tr_b16 v[186:187], v250 offset:20992
    v_mfma_f32_16x16x32_bf16 v[52:55], v[188:191], a[204:207], v[52:55]
    v_add_f32 v206, 1.0, v206
    v_add_f32 v207, 1.0, v207
    v_mfma_f32_16x16x32_bf16 v[44:47], v[188:191], a[132:135], v[44:47]
    v_rcp_f32 v200, v200
    v_mfma_f32_16x16x32_bf16 v[36:39], v[188:191], a[60:63], v[36:39]
    s_waitcnt lgkmcnt(10)
    v_rcp_f32 v201, v201
    v_mfma_f32_16x16x32_bf16 v[0:3], v[160:163], a[64:67], v[0:3]
    ds_read_b64_tr_b16 v[188:189], v250 offset:45056
    ds_read_b64_tr_b16 v[190:191], v250 offset:45568
    v_mfma_f32_16x16x32_bf16 v[8:11], v[160:163], a[136:139], v[8:11]
    v_rcp_f32 v202, v202
    v_mfma_f32_16x16x32_bf16 v[16:19], v[160:163], a[208:211], v[16:19]
    v_rcp_f32 v203, v203
    v_mfma_f32_16x16x32_bf16 v[24:27], v[160:163], v[152:155], v[24:27]
    v_add_u32 v251, 0xfffe8000, v251
    v_mfma_f32_16x16x32_bf16 v[28:31], v[164:167], v[152:155], v[28:31]
    ds_read_b64_tr_b16 v[160:161], v251 offset:0
    ds_read_b64_tr_b16 v[162:163], v251 offset:512
    v_mfma_f32_16x16x32_bf16 v[20:23], v[164:167], a[208:211], v[20:23]
    v_rcp_f32 v204, v204
    v_mfma_f32_16x16x32_bf16 v[12:15], v[164:167], a[136:139], v[12:15]
    v_rcp_f32 v205, v205
    v_mfma_f32_16x16x32_bf16 v[4:7], v[164:167], a[64:67], v[4:7]
    s_waitcnt lgkmcnt(10)
    v_rcp_f32 v206, v206
    v_mfma_f32_16x16x32_bf16 v[32:35], v[168:171], a[64:67], v[32:35]
    ds_read_b64_tr_b16 v[164:165], v251 offset:24576
    ds_read_b64_tr_b16 v[166:167], v251 offset:25088
    v_mfma_f32_16x16x32_bf16 v[40:43], v[168:171], a[136:139], v[40:43]
    v_rcp_f32 v207, v207
    v_mfma_f32_16x16x32_bf16 v[48:51], v[168:171], a[208:211], v[48:51]
    v_mul_f32 v92, v92, v200
    v_mul_f32 v93, v93, v201
    v_mfma_f32_16x16x32_bf16 v[56:59], v[168:171], v[152:155], v[56:59]
    buffer_load_dword v224, v241, s[80:83], s65 offen
    v_add_u32 v252, 0xfffe8000, v252
    v_mfma_f32_16x16x32_bf16 v[60:63], v[172:175], v[152:155], v[60:63]
    s_add_u32 s65, s65, 73728
    ds_read_b64_tr_b16 v[168:169], v252 offset:0
    ds_read_b64_tr_b16 v[170:171], v252 offset:512
    v_mfma_f32_16x16x32_bf16 v[52:55], v[172:175], a[208:211], v[52:55]
    v_mul_f32 v94, v94, v202
    v_mul_f32 v95, v95, v203
    v_mfma_f32_16x16x32_bf16 v[44:47], v[172:175], a[136:139], v[44:47]
    v_mul_f32 v124, v124, v204
    v_mul_f32 v125, v125, v205
    v_mfma_f32_16x16x32_bf16 v[36:39], v[172:175], a[64:67], v[36:39]
    s_waitcnt lgkmcnt(10)
    v_mul_f32 v126, v126, v206
    v_mul_f32 v127, v127, v207
    v_mfma_f32_16x16x32_bf16 v[0:3], v[176:179], a[68:71], v[0:3]
    ds_read_b64_tr_b16 v[172:173], v252 offset:24576
    ds_read_b64_tr_b16 v[174:175], v252 offset:25088
    v_mfma_f32_16x16x32_bf16 v[8:11], v[176:179], a[140:143], v[8:11]
    v_cvt_pk_bf16_f32 v200, v92, v93
    v_cvt_pk_bf16_f32 v201, v94, v95
    v_mfma_f32_16x16x32_bf16 v[16:19], v[176:179], a[212:215], v[16:19]
    v_cvt_pk_bf16_f32 v202, v124, v125
    v_cvt_pk_bf16_f32 v203, v126, v127
    v_mfma_f32_16x16x32_bf16 v[24:27], v[176:179], v[156:159], v[24:27]
    buffer_store_dwordx4 v[200:203], v216, s[24:27], s49 offen sc0 sc1
    s_add_u32 s48, s48, 7168
    v_mfma_f32_16x16x32_bf16 v[28:31], v[180:183], v[156:159], v[28:31]
    s_add_u32 s49, s49, 7168
    ds_read_b64_tr_b16 v[176:177], v251 offset:4096
    ds_read_b64_tr_b16 v[178:179], v251 offset:4608
    v_mfma_f32_16x16x32_bf16 v[20:23], v[180:183], a[212:215], v[20:23]
    v_mfma_f32_16x16x32_bf16 v[12:15], v[180:183], a[140:143], v[12:15]
    v_mfma_f32_16x16x32_bf16 v[4:7], v[180:183], a[68:71], v[4:7]
    s_waitcnt lgkmcnt(10)
    v_mfma_f32_16x16x32_bf16 v[32:35], v[184:187], a[68:71], v[32:35]
    ds_read_b64_tr_b16 v[180:181], v251 offset:28672
    ds_read_b64_tr_b16 v[182:183], v251 offset:29184
    v_mfma_f32_16x16x32_bf16 v[40:43], v[184:187], a[140:143], v[40:43]
    v_mfma_f32_16x16x32_bf16 v[48:51], v[184:187], a[212:215], v[48:51]
    v_mfma_f32_16x16x32_bf16 v[56:59], v[184:187], v[156:159], v[56:59]
    v_mfma_f32_16x16x32_bf16 v[60:63], v[188:191], v[156:159], v[60:63]
    ds_read_b64_tr_b16 v[184:185], v252 offset:4096
    ds_read_b64_tr_b16 v[186:187], v252 offset:4608
    v_mfma_f32_16x16x32_bf16 v[52:55], v[188:191], a[212:215], v[52:55]
    v_mfma_f32_16x16x32_bf16 v[44:47], v[188:191], a[140:143], v[44:47]
    v_mfma_f32_16x16x32_bf16 v[36:39], v[188:191], a[68:71], v[36:39]
    s_waitcnt lgkmcnt(12)
    s_waitcnt lgkmcnt(10)
    v_mfma_f32_16x16x32_bf16 v[64:67], v[160:163], a[0:3], 0
    ds_read_b64_tr_b16 v[188:189], v252 offset:28672
    ds_read_b64_tr_b16 v[190:191], v252 offset:29184
    v_mfma_f32_16x16x32_bf16 v[72:75], v[160:163], a[72:75], 0
    v_mfma_f32_16x16x32_bf16 v[80:83], v[160:163], a[144:147], 0
    v_mfma_f32_16x16x32_bf16 v[88:91], v[160:163], a[216:219], 0
    v_mfma_f32_16x16x32_bf16 v[92:95], v[164:167], a[216:219], 0
    ds_read_b64_tr_b16 v[160:161], v251 offset:8192
    ds_read_b64_tr_b16 v[162:163], v251 offset:8704
    v_mfma_f32_16x16x32_bf16 v[84:87], v[164:167], a[144:147], 0
    v_mfma_f32_16x16x32_bf16 v[76:79], v[164:167], a[72:75], 0
    v_mfma_f32_16x16x32_bf16 v[68:71], v[164:167], a[0:3], 0
    s_waitcnt lgkmcnt(10)
    v_mfma_f32_16x16x32_bf16 v[96:99], v[168:171], a[0:3], 0
    ds_read_b64_tr_b16 v[164:165], v251 offset:32768
    ds_read_b64_tr_b16 v[166:167], v251 offset:33280
    v_mfma_f32_16x16x32_bf16 v[104:107], v[168:171], a[72:75], 0
    v_mul_f32 v192, v0, v0
    v_mul_f32 v193, v1, v1
    v_mfma_f32_16x16x32_bf16 v[112:115], v[168:171], a[144:147], 0
    v_mul_f32 v194, v2, v2
    v_mul_f32 v195, v3, v3
    v_mfma_f32_16x16x32_bf16 v[120:123], v[168:171], a[216:219], 0
    v_mul_f32 v196, v32, v32
    v_mfma_f32_16x16x32_bf16 v[124:127], v[172:175], a[216:219], 0
    ds_read_b64_tr_b16 v[168:169], v252 offset:8192
    ds_read_b64_tr_b16 v[170:171], v252 offset:8704
    v_mfma_f32_16x16x32_bf16 v[116:119], v[172:175], a[144:147], 0
    buffer_load_dword v224, v241, s[80:83], s65 offen
    s_add_u32 s65, s65, 73728
    v_mfma_f32_16x16x32_bf16 v[108:111], v[172:175], a[72:75], 0
    v_mul_f32 v197, v33, v33
    v_mul_f32 v198, v34, v34
    v_mfma_f32_16x16x32_bf16 v[100:103], v[172:175], a[0:3], 0
    s_waitcnt lgkmcnt(10)
    v_mul_f32 v199, v35, v35
    v_mul_f32 v4, v0, v4
    v_mfma_f32_16x16x32_bf16 v[64:67], v[176:179], a[4:7], v[64:67]
    ds_read_b64_tr_b16 v[172:173], v252 offset:32768
    ds_read_b64_tr_b16 v[174:175], v252 offset:33280
    v_mfma_f32_16x16x32_bf16 v[72:75], v[176:179], a[76:79], v[72:75]
    v_mul_f32 v5, v1, v5
    v_mul_f32 v6, v2, v6
    v_mfma_f32_16x16x32_bf16 v[80:83], v[176:179], a[148:151], v[80:83]
    v_mul_f32 v7, v3, v7
    v_mul_f32 v36, v32, v36
    v_mfma_f32_16x16x32_bf16 v[88:91], v[176:179], a[220:223], v[88:91]
    v_mul_f32 v37, v33, v37
    v_mul_f32 v38, v34, v38
    v_mfma_f32_16x16x32_bf16 v[92:95], v[180:183], a[220:223], v[92:95]
    ds_read_b64_tr_b16 v[176:177], v251 offset:12288
    ds_read_b64_tr_b16 v[178:179], v251 offset:12800
    v_mfma_f32_16x16x32_bf16 v[84:87], v[180:183], a[148:151], v[84:87]
    buffer_store_dwordx4 v[236:239], v222, s[76:79], s3 offen offset:1024 sc0 sc1
    v_mul_f32 v39, v35, v39
    v_mfma_f32_16x16x32_bf16 v[76:79], v[180:183], a[76:79], v[76:79]
    v_fmaak_f32 v192, v218, v192, 0xc0135761
    v_fmaak_f32 v193, v218, v193, 0xc0135761
    v_mfma_f32_16x16x32_bf16 v[68:71], v[180:183], a[4:7], v[68:71]
    s_waitcnt lgkmcnt(10)
    v_fmaak_f32 v194, v218, v194, 0xc0135761
    v_fmaak_f32 v195, v218, v195, 0xc0135761
    v_mfma_f32_16x16x32_bf16 v[96:99], v[184:187], a[4:7], v[96:99]
    ds_read_b64_tr_b16 v[180:181], v251 offset:36864
    ds_read_b64_tr_b16 v[182:183], v251 offset:37376
    v_mfma_f32_16x16x32_bf16 v[104:107], v[184:187], a[76:79], v[104:107]
    v_fmaak_f32 v196, v218, v196, 0xc0135761
    v_fmaak_f32 v197, v218, v197, 0xc0135761
    v_mfma_f32_16x16x32_bf16 v[112:115], v[184:187], a[148:151], v[112:115]
    v_fmaak_f32 v198, v218, v198, 0xc0135761
    v_fmaak_f32 v199, v218, v199, 0xc0135761
    v_mfma_f32_16x16x32_bf16 v[120:123], v[184:187], a[220:223], v[120:123]
    v_mul_f32 v192, v192, v0
    v_mul_f32 v193, v193, v1
    v_mfma_f32_16x16x32_bf16 v[124:127], v[188:191], a[220:223], v[124:127]
    ds_read_b64_tr_b16 v[184:185], v252 offset:12288
    ds_read_b64_tr_b16 v[186:187], v252 offset:12800
    v_mfma_f32_16x16x32_bf16 v[116:119], v[188:191], a[148:151], v[116:119]
    v_mul_f32 v194, v194, v2
    v_mfma_f32_16x16x32_bf16 v[108:111], v[188:191], a[76:79], v[108:111]
    buffer_load_dword v224, v241, s[80:83], s65 offen
    s_add_u32 s65, s65, 73728
    v_mfma_f32_16x16x32_bf16 v[100:103], v[188:191], a[4:7], v[100:103]
    s_waitcnt lgkmcnt(10)
    v_mul_f32 v195, v195, v3
    v_mul_f32 v196, v196, v32
    v_mfma_f32_16x16x32_bf16 v[64:67], v[160:163], a[8:11], v[64:67]
    ds_read_b64_tr_b16 v[188:189], v252 offset:36864
    ds_read_b64_tr_b16 v[190:191], v252 offset:37376
    v_mfma_f32_16x16x32_bf16 v[72:75], v[160:163], a[80:83], v[72:75]
    v_mul_f32 v197, v197, v33
    v_mul_f32 v198, v198, v34
    v_mfma_f32_16x16x32_bf16 v[80:83], v[160:163], a[152:155], v[80:83]
    v_mul_f32 v199, v199, v35
    v_mfma_f32_16x16x32_bf16 v[88:91], v[160:163], a[224:227], v[88:91]
    v_exp_f32 v192, v192
    v_mfma_f32_16x16x32_bf16 v[92:95], v[164:167], a[224:227], v[92:95]
    ds_read_b64_tr_b16 v[160:161], v251 offset:16384
    ds_read_b64_tr_b16 v[162:163], v251 offset:16896
    v_mfma_f32_16x16x32_bf16 v[84:87], v[164:167], a[152:155], v[84:87]
    v_exp_f32 v193, v193
    v_mfma_f32_16x16x32_bf16 v[76:79], v[164:167], a[80:83], v[76:79]
    v_exp_f32 v194, v194
    v_mfma_f32_16x16x32_bf16 v[68:71], v[164:167], a[8:11], v[68:71]
    s_waitcnt lgkmcnt(10)
    v_exp_f32 v195, v195
    v_mfma_f32_16x16x32_bf16 v[96:99], v[168:171], a[8:11], v[96:99]
    ds_read_b64_tr_b16 v[164:165], v251 offset:40960
    ds_read_b64_tr_b16 v[166:167], v251 offset:41472
    v_mfma_f32_16x16x32_bf16 v[104:107], v[168:171], a[80:83], v[104:107]
    v_exp_f32 v196, v196
    v_mfma_f32_16x16x32_bf16 v[112:115], v[168:171], a[152:155], v[112:115]
    v_exp_f32 v197, v197
    v_mfma_f32_16x16x32_bf16 v[120:123], v[168:171], a[224:227], v[120:123]
    v_exp_f32 v198, v198
    v_mfma_f32_16x16x32_bf16 v[124:127], v[172:175], a[224:227], v[124:127]
    ds_read_b64_tr_b16 v[168:169], v252 offset:16384
    ds_read_b64_tr_b16 v[170:171], v252 offset:16896
    v_mfma_f32_16x16x32_bf16 v[116:119], v[172:175], a[152:155], v[116:119]
    v_exp_f32 v199, v199
    v_mfma_f32_16x16x32_bf16 v[108:111], v[172:175], a[80:83], v[108:111]
    v_add_f32 v192, 1.0, v192
    v_add_f32 v193, 1.0, v193
    v_mfma_f32_16x16x32_bf16 v[100:103], v[172:175], a[8:11], v[100:103]
    s_waitcnt lgkmcnt(10)
    v_add_f32 v194, 1.0, v194
    v_add_f32 v195, 1.0, v195
    v_mfma_f32_16x16x32_bf16 v[64:67], v[176:179], a[12:15], v[64:67]
    ds_read_b64_tr_b16 v[172:173], v252 offset:40960
    ds_read_b64_tr_b16 v[174:175], v252 offset:41472
    v_mfma_f32_16x16x32_bf16 v[72:75], v[176:179], a[84:87], v[72:75]
    buffer_store_dwordx4 v[236:239], v222, s[76:79], s3 offen offset:2048 sc0 sc1
    v_add_f32 v196, 1.0, v196
    v_mfma_f32_16x16x32_bf16 v[80:83], v[176:179], a[156:159], v[80:83]
    v_add_f32 v197, 1.0, v197
    v_add_f32 v198, 1.0, v198
    v_mfma_f32_16x16x32_bf16 v[88:91], v[176:179], a[228:231], v[88:91]
    v_add_f32 v199, 1.0, v199
    v_mfma_f32_16x16x32_bf16 v[92:95], v[180:183], a[228:231], v[92:95]
    ds_read_b64_tr_b16 v[176:177], v251 offset:20480
    ds_read_b64_tr_b16 v[178:179], v251 offset:20992
    v_mfma_f32_16x16x32_bf16 v[84:87], v[180:183], a[156:159], v[84:87]
    v_rcp_f32 v192, v192
    v_mfma_f32_16x16x32_bf16 v[76:79], v[180:183], a[84:87], v[76:79]
    v_rcp_f32 v193, v193
    v_mfma_f32_16x16x32_bf16 v[68:71], v[180:183], a[12:15], v[68:71]
    s_waitcnt lgkmcnt(10)
    v_rcp_f32 v194, v194
    v_mfma_f32_16x16x32_bf16 v[96:99], v[184:187], a[12:15], v[96:99]
    ds_read_b64_tr_b16 v[180:181], v251 offset:45056
    ds_read_b64_tr_b16 v[182:183], v251 offset:45568
    v_mfma_f32_16x16x32_bf16 v[104:107], v[184:187], a[84:87], v[104:107]
    v_rcp_f32 v195, v195
    v_mfma_f32_16x16x32_bf16 v[112:115], v[184:187], a[156:159], v[112:115]
    v_rcp_f32 v196, v196
    v_mfma_f32_16x16x32_bf16 v[120:123], v[184:187], a[228:231], v[120:123]
    v_rcp_f32 v197, v197
    v_mfma_f32_16x16x32_bf16 v[124:127], v[188:191], a[228:231], v[124:127]
    ds_read_b64_tr_b16 v[184:185], v252 offset:20480
    ds_read_b64_tr_b16 v[186:187], v252 offset:20992
    v_mfma_f32_16x16x32_bf16 v[116:119], v[188:191], a[156:159], v[116:119]
    v_rcp_f32 v198, v198
    v_mfma_f32_16x16x32_bf16 v[108:111], v[188:191], a[84:87], v[108:111]
    v_rcp_f32 v199, v199
    v_mfma_f32_16x16x32_bf16 v[100:103], v[188:191], a[12:15], v[100:103]
    s_waitcnt lgkmcnt(10)
    v_mul_f32 v4, v4, v192
    v_mul_f32 v5, v5, v193
    v_mfma_f32_16x16x32_bf16 v[64:67], v[160:163], a[16:19], v[64:67]
    ds_read_b64_tr_b16 v[188:189], v252 offset:45056
    ds_read_b64_tr_b16 v[190:191], v252 offset:45568
    v_mfma_f32_16x16x32_bf16 v[72:75], v[160:163], a[88:91], v[72:75]
    s_and_b32 s84, s36, 1
    s_lshl_b32 s84, s84, 6
    v_add_u32 v234, s84, v208
    v_mfma_f32_16x16x32_bf16 v[80:83], v[160:163], a[160:163], v[80:83]
    v_mul_u32_u24 v235, 3641, v234
    v_lshrrev_b32 v235, 16, v235
    v_mfma_f32_16x16x32_bf16 v[88:91], v[160:163], a[232:235], v[88:91]
    v_add_u32 v251, 0xc000, v251
    v_mul_u32_u24 v225, 864, v235
    v_mfma_f32_16x16x32_bf16 v[92:95], v[164:167], a[232:235], v[92:95]
    ds_read_b64_tr_b16 v[160:161], v251 offset:0
    ds_read_b64_tr_b16 v[162:163], v251 offset:512
    v_mfma_f32_16x16x32_bf16 v[84:87], v[164:167], a[160:163], v[84:87]
    v_lshl_add_u32 v225, v234, 4, v225
    v_add_u32 v234, 128, v234
    v_mul_u32_u24 v235, 3641, v234
    v_mfma_f32_16x16x32_bf16 v[76:79], v[164:167], a[88:91], v[76:79]
    v_lshrrev_b32 v235, 16, v235
    v_mul_u32_u24 v226, 864, v235
    v_mfma_f32_16x16x32_bf16 v[68:71], v[164:167], a[16:19], v[68:71]
    s_waitcnt lgkmcnt(10)
    v_lshl_add_u32 v226, v234, 4, v226
    v_add_u32 v234, 128, v234
    v_mfma_f32_16x16x32_bf16 v[96:99], v[168:171], a[16:19], v[96:99]
    ds_read_b64_tr_b16 v[164:165], v251 offset:24576
    ds_read_b64_tr_b16 v[166:167], v251 offset:25088
    v_mfma_f32_16x16x32_bf16 v[104:107], v[168:171], a[88:91], v[104:107]
    v_mul_u32_u24 v235, 3641, v234
    v_lshrrev_b32 v235, 16, v235
    v_mfma_f32_16x16x32_bf16 v[112:115], v[168:171], a[160:163], v[112:115]
    v_mul_u32_u24 v227, 864, v235
    v_lshl_add_u32 v227, v234, 4, v227
    v_mfma_f32_16x16x32_bf16 v[120:123], v[168:171], a[232:235], v[120:123]
    v_add_u32 v252, 0xc000, v252
    v_add_u32 v234, 128, v234
    v_mfma_f32_16x16x32_bf16 v[124:127], v[172:175], a[232:235], v[124:127]
    ds_read_b64_tr_b16 v[168:169], v252 offset:0
    ds_read_b64_tr_b16 v[170:171], v252 offset:512
    v_mfma_f32_16x16x32_bf16 v[116:119], v[172:175], a[160:163], v[116:119]
    v_mul_u32_u24 v235, 3641, v234
    v_lshrrev_b32 v235, 16, v235
    v_mfma_f32_16x16x32_bf16 v[108:111], v[172:175], a[88:91], v[108:111]
    v_mul_u32_u24 v228, 864, v235
    v_lshl_add_u32 v228, v234, 4, v228
    v_mfma_f32_16x16x32_bf16 v[100:103], v[172:175], a[16:19], v[100:103]
    s_waitcnt lgkmcnt(10)
    v_add_u32 v234, 128, v234
    v_mul_u32_u24 v235, 3641, v234
    v_mfma_f32_16x16x32_bf16 v[64:67], v[176:179], a[20:23], v[64:67]
    ds_read_b64_tr_b16 v[172:173], v252 offset:24576
    ds_read_b64_tr_b16 v[174:175], v252 offset:25088
    v_mfma_f32_16x16x32_bf16 v[72:75], v[176:179], a[92:95], v[72:75]
    v_lshrrev_b32 v235, 16, v235
    v_mul_u32_u24 v229, 864, v235
    v_mfma_f32_16x16x32_bf16 v[80:83], v[176:179], a[164:167], v[80:83]
    v_lshl_add_u32 v229, v234, 4, v229
    v_add_u32 v234, 128, v234
    v_mfma_f32_16x16x32_bf16 v[88:91], v[176:179], a[236:239], v[88:91]
    v_mul_u32_u24 v235, 3641, v234
    v_lshrrev_b32 v235, 16, v235
    v_mfma_f32_16x16x32_bf16 v[92:95], v[180:183], a[236:239], v[92:95]
    ds_read_b64_tr_b16 v[176:177], v251 offset:4096
    ds_read_b64_tr_b16 v[178:179], v251 offset:4608
    v_mfma_f32_16x16x32_bf16 v[84:87], v[180:183], a[164:167], v[84:87]
    v_mul_u32_u24 v230, 864, v235
    v_lshl_add_u32 v230, v234, 4, v230
    v_mfma_f32_16x16x32_bf16 v[76:79], v[180:183], a[92:95], v[76:79]
    v_add_u32 v234, 128, v234
    v_mul_u32_u24 v235, 3641, v234
    v_mfma_f32_16x16x32_bf16 v[68:71], v[180:183], a[20:23], v[68:71]
    s_waitcnt lgkmcnt(10)
    v_lshrrev_b32 v235, 16, v235
    v_mul_u32_u24 v231, 864, v235
    v_mfma_f32_16x16x32_bf16 v[96:99], v[184:187], a[20:23], v[96:99]
    ds_read_b64_tr_b16 v[180:181], v251 offset:28672
    ds_read_b64_tr_b16 v[182:183], v251 offset:29184
    v_mfma_f32_16x16x32_bf16 v[104:107], v[184:187], a[92:95], v[104:107]
    v_lshl_add_u32 v231, v234, 4, v231
    v_add_u32 v234, 128, v234
    v_mfma_f32_16x16x32_bf16 v[112:115], v[184:187], a[164:167], v[112:115]
    v_mul_u32_u24 v235, 3641, v234
    v_lshrrev_b32 v235, 16, v235
    v_mfma_f32_16x16x32_bf16 v[120:123], v[184:187], a[236:239], v[120:123]
    v_mul_u32_u24 v232, 864, v235
    v_lshl_add_u32 v232, v234, 4, v232
    v_mfma_f32_16x16x32_bf16 v[124:127], v[188:191], a[236:239], v[124:127]
    ds_read_b64_tr_b16 v[184:185], v252 offset:4096
    ds_read_b64_tr_b16 v[186:187], v252 offset:4608
    v_mfma_f32_16x16x32_bf16 v[116:119], v[188:191], a[164:167], v[116:119]
    v_add_u32 v234, 128, v234
    v_mul_u32_u24 v235, 3641, v234
    v_mfma_f32_16x16x32_bf16 v[108:111], v[188:191], a[92:95], v[108:111]
    v_lshrrev_b32 v235, 16, v235
    v_mul_u32_u24 v233, 864, v235
    v_mfma_f32_16x16x32_bf16 v[100:103], v[188:191], a[20:23], v[100:103]
    s_waitcnt lgkmcnt(10)
    v_lshl_add_u32 v233, v234, 4, v233
    v_mul_f32 v6, v6, v194
    v_mfma_f32_16x16x32_bf16 v[64:67], v[160:163], a[24:27], v[64:67]
    ds_read_b64_tr_b16 v[188:189], v252 offset:28672
    ds_read_b64_tr_b16 v[190:191], v252 offset:29184
    v_mfma_f32_16x16x32_bf16 v[72:75], v[160:163], a[96:99], v[72:75]
    v_mul_f32 v7, v7, v195
    v_mul_f32 v36, v36, v196
    v_mfma_f32_16x16x32_bf16 v[80:83], v[160:163], a[168:171], v[80:83]
    v_mul_f32 v37, v37, v197
    v_mul_f32 v38, v38, v198
    v_mfma_f32_16x16x32_bf16 v[88:91], v[160:163], a[240:243], v[88:91]
    v_mul_f32 v39, v39, v199
    v_cvt_pk_bf16_f32 v192, v4, v5
    v_mfma_f32_16x16x32_bf16 v[92:95], v[164:167], a[240:243], v[92:95]
    ds_read_b64_tr_b16 v[160:161], v251 offset:8192
    ds_read_b64_tr_b16 v[162:163], v251 offset:8704
    v_mfma_f32_16x16x32_bf16 v[84:87], v[164:167], a[168:171], v[84:87]
    v_cvt_pk_bf16_f32 v193, v6, v7
    v_cvt_pk_bf16_f32 v194, v36, v37
    v_mfma_f32_16x16x32_bf16 v[76:79], v[164:167], a[96:99], v[76:79]
    v_cvt_pk_bf16_f32 v195, v38, v39
    v_mfma_f32_16x16x32_bf16 v[68:71], v[164:167], a[24:27], v[68:71]
    s_waitcnt lgkmcnt(10)
    buffer_store_dwordx4 v[192:195], v222, s[24:27], s48 offen sc0 sc1
    v_mul_f32 v200, v8, v8
H1_S6_0:
    s_cbranch_execz H1_S9_0
    v_mfma_f32_16x16x32_bf16 v[96:99], v[168:171], a[24:27], v[96:99]
    ds_read_b64_tr_b16 v[164:165], v251 offset:32768
    ds_read_b64_tr_b16 v[166:167], v251 offset:33280
    v_mfma_f32_16x16x32_bf16 v[104:107], v[168:171], a[96:99], v[104:107]
    v_mul_f32 v201, v9, v9
    v_mul_f32 v202, v10, v10
    v_mfma_f32_16x16x32_bf16 v[112:115], v[168:171], a[168:171], v[112:115]
    v_mul_f32 v203, v11, v11
    v_mul_f32 v204, v40, v40
    v_mfma_f32_16x16x32_bf16 v[120:123], v[168:171], a[240:243], v[120:123]
    v_mul_f32 v205, v41, v41
    v_mul_f32 v206, v42, v42
    v_mfma_f32_16x16x32_bf16 v[124:127], v[172:175], a[240:243], v[124:127]
    ds_read_b64_tr_b16 v[168:169], v252 offset:8192
    ds_read_b64_tr_b16 v[170:171], v252 offset:8704
    v_mfma_f32_16x16x32_bf16 v[116:119], v[172:175], a[168:171], v[116:119]
    v_mul_f32 v207, v43, v43
    v_mul_f32 v12, v8, v12
    v_mfma_f32_16x16x32_bf16 v[108:111], v[172:175], a[96:99], v[108:111]
    v_mul_f32 v13, v9, v13
    v_mul_f32 v14, v10, v14
    v_mfma_f32_16x16x32_bf16 v[100:103], v[172:175], a[24:27], v[100:103]
    s_waitcnt lgkmcnt(10)
    v_mul_f32 v15, v11, v15
    v_mul_f32 v44, v40, v44
    s_barrier
    v_mfma_f32_16x16x32_bf16 v[64:67], v[176:179], a[28:31], v[64:67]
    ds_read_b64_tr_b16 v[172:173], v252 offset:32768
    ds_read_b64_tr_b16 v[174:175], v252 offset:33280
    v_mfma_f32_16x16x32_bf16 v[72:75], v[176:179], a[100:103], v[72:75]
    s_add_u32 s60, s60, 1
    s_cmp_eq_u32 s60, s39
    s_cselect_b32 s51, s45, s46
    v_mul_f32 v45, v41, v45
    v_mul_f32 v46, v42, v46
    v_mfma_f32_16x16x32_bf16 v[80:83], v[176:179], a[172:175], v[80:83]
    s_add_u32 s52, s60, s40
    s_lshl_b32 s52, s52, 6
    v_mul_f32 v47, v43, v47
    s_cmp_lt_u32 s60, s39
    s_cselect_b32 s51, s52, s51
    s_cselect_b32 s32, s12, s16
    s_cselect_b32 s33, s13, s17
    s_cselect_b32 s34, s14, s18
    s_mov_b32 s35, 0x00020000
    s_cselect_b32 s62, 8, 3
    s_cselect_b64 s[66:67], -1, 0
    v_mfma_f32_16x16x32_bf16 v[88:91], v[176:179], a[244:247], v[88:91]
    v_fmaak_f32 v200, v218, v200, 0xc0135761
    v_fmaak_f32 v201, v218, v201, 0xc0135761
    s_mul_i32 s62, s62, 18432
    s_mul_i32 s52, s62, s64
    s_add_u32 s61, s51, s52
    s_lshl_b32 s62, s62, 1
    v_cndmask_b32 v215, v214, v213, s[66:67]
    v_mfma_f32_16x16x32_bf16 v[92:95], v[180:183], a[244:247], v[92:95]
    s_add_u32 m0, s54, 0
    ds_read_b64_tr_b16 v[176:177], v251 offset:12288
    ds_read_b64_tr_b16 v[178:179], v251 offset:12800
    v_mfma_f32_16x16x32_bf16 v[84:87], v[180:183], a[172:175], v[84:87]
    buffer_load_dwordx4 v215, s[32:35], s61 offen lds
    s_add_u32 s61, s61, s62
    v_fmaak_f32 v202, v218, v202, 0xc0135761
    v_fmaak_f32 v203, v218, v203, 0xc0135761
    v_fmaak_f32 v204, v218, v204, 0xc0135761
    v_mfma_f32_16x16x32_bf16 v[76:79], v[180:183], a[100:103], v[76:79]
    s_add_u32 m0, s54, 2048
    v_fmaak_f32 v205, v218, v205, 0xc0135761
    v_fmaak_f32 v206, v218, v206, 0xc0135761
    v_mfma_f32_16x16x32_bf16 v[68:71], v[180:183], a[28:31], v[68:71]
    s_waitcnt lgkmcnt(10)
    buffer_load_dwordx4 v215, s[32:35], s61 offen lds
    s_add_u32 s61, s61, s62
    v_fmaak_f32 v207, v218, v207, 0xc0135761
    v_mfma_f32_16x16x32_bf16 v[96:99], v[184:187], a[28:31], v[96:99]
    s_add_u32 m0, s54, 4096
    ds_read_b64_tr_b16 v[180:181], v251 offset:36864
    ds_read_b64_tr_b16 v[182:183], v251 offset:37376
    v_mfma_f32_16x16x32_bf16 v[104:107], v[184:187], a[100:103], v[104:107]
    v_mul_f32 v200, v200, v8
    v_mul_f32 v201, v201, v9
    v_mfma_f32_16x16x32_bf16 v[112:115], v[184:187], a[172:175], v[112:115]
    v_mul_f32 v202, v202, v10
    v_mul_f32 v203, v203, v11
    v_mfma_f32_16x16x32_bf16 v[120:123], v[184:187], a[244:247], v[120:123]
    v_mul_f32 v204, v204, v40
    v_mfma_f32_16x16x32_bf16 v[124:127], v[188:191], a[244:247], v[124:127]
    ds_read_b64_tr_b16 v[184:185], v252 offset:12288
    ds_read_b64_tr_b16 v[186:187], v252 offset:12800
    v_mfma_f32_16x16x32_bf16 v[116:119], v[188:191], a[172:175], v[116:119]
    buffer_load_dwordx4 v215, s[32:35], s61 offen lds
    buffer_store_dwordx4 v[236:239], v222, s[76:79], s3 offen offset:3072 sc0 sc1
    s_add_u32 s3, s3, 4096
    v_mul_f32 v205, v205, v41
    v_mul_f32 v206, v206, v42
    v_mfma_f32_16x16x32_bf16 v[108:111], v[188:191], a[100:103], v[108:111]
    s_add_u32 s61, s61, s62
    s_add_u32 m0, s54, 6144
    v_mul_f32 v207, v207, v43
    v_exp_f32 v200, v200
    v_mfma_f32_16x16x32_bf16 v[100:103], v[188:191], a[28:31], v[100:103]
    s_waitcnt lgkmcnt(10)
    v_exp_f32 v201, v201
    v_mfma_f32_16x16x32_bf16 v[64:67], v[160:163], a[32:35], v[64:67]
    ds_read_b64_tr_b16 v[188:189], v252 offset:36864
    ds_read_b64_tr_b16 v[190:191], v252 offset:37376
    v_mfma_f32_16x16x32_bf16 v[72:75], v[160:163], a[104:107], v[72:75]
    v_exp_f32 v202, v202
    v_mfma_f32_16x16x32_bf16 v[80:83], v[160:163], a[176:179], v[80:83]
    v_exp_f32 v203, v203
    v_mfma_f32_16x16x32_bf16 v[88:91], v[160:163], a[248:251], v[88:91]
    v_exp_f32 v204, v204
    v_mfma_f32_16x16x32_bf16 v[92:95], v[164:167], a[248:251], v[92:95]
    ds_read_b64_tr_b16 v[160:161], v251 offset:16384
    ds_read_b64_tr_b16 v[162:163], v251 offset:16896
    v_mfma_f32_16x16x32_bf16 v[84:87], v[164:167], a[176:179], v[84:87]
    buffer_load_dwordx4 v215, s[32:35], s61 offen lds
    s_add_u32 s61, s61, s62
    v_exp_f32 v205, v205
    v_mfma_f32_16x16x32_bf16 v[76:79], v[164:167], a[104:107], v[76:79]
    s_add_u32 m0, s54, 8192
    v_exp_f32 v206, v206
    v_mfma_f32_16x16x32_bf16 v[68:71], v[164:167], a[32:35], v[68:71]
    s_waitcnt lgkmcnt(10)
    v_exp_f32 v207, v207
    v_mfma_f32_16x16x32_bf16 v[96:99], v[168:171], a[32:35], v[96:99]
    ds_read_b64_tr_b16 v[164:165], v251 offset:40960
    ds_read_b64_tr_b16 v[166:167], v251 offset:41472
    v_mfma_f32_16x16x32_bf16 v[104:107], v[168:171], a[104:107], v[104:107]
    v_add_f32 v200, 1.0, v200
    v_add_f32 v201, 1.0, v201
    v_mfma_f32_16x16x32_bf16 v[112:115], v[168:171], a[176:179], v[112:115]
    v_add_f32 v202, 1.0, v202
    v_add_f32 v203, 1.0, v203
    v_mfma_f32_16x16x32_bf16 v[120:123], v[168:171], a[248:251], v[120:123]
    v_add_f32 v204, 1.0, v204
    v_add_f32 v205, 1.0, v205
    v_mfma_f32_16x16x32_bf16 v[124:127], v[172:175], a[248:251], v[124:127]
    ds_read_b64_tr_b16 v[168:169], v252 offset:16384
    ds_read_b64_tr_b16 v[170:171], v252 offset:16896
    v_mfma_f32_16x16x32_bf16 v[116:119], v[172:175], a[176:179], v[116:119]
    buffer_load_dwordx4 v215, s[32:35], s61 offen lds
    s_add_u32 s61, s61, s62
    v_add_f32 v206, 1.0, v206
    v_mfma_f32_16x16x32_bf16 v[108:111], v[172:175], a[104:107], v[108:111]
    s_add_u32 m0, s54, 10240
    v_add_f32 v207, 1.0, v207
    v_mfma_f32_16x16x32_bf16 v[100:103], v[172:175], a[32:35], v[100:103]
    s_waitcnt lgkmcnt(10)
    v_rcp_f32 v200, v200
    v_mfma_f32_16x16x32_bf16 v[64:67], v[176:179], a[36:39], v[64:67]
    ds_read_b64_tr_b16 v[172:173], v252 offset:40960
    ds_read_b64_tr_b16 v[174:175], v252 offset:41472
    v_mfma_f32_16x16x32_bf16 v[72:75], v[176:179], a[108:111], v[72:75]
    buffer_load_dwordx4 v215, s[32:35], s61 offen lds
    s_add_u32 s61, s61, s62
    v_rcp_f32 v201, v201
    v_mfma_f32_16x16x32_bf16 v[80:83], v[176:179], a[180:183], v[80:83]
    s_add_u32 m0, s54, 24576
    v_rcp_f32 v202, v202
    v_mfma_f32_16x16x32_bf16 v[88:91], v[176:179], a[252:255], v[88:91]
    v_rcp_f32 v203, v203
    v_mfma_f32_16x16x32_bf16 v[92:95], v[180:183], a[252:255], v[92:95]
    ds_read_b64_tr_b16 v[176:177], v251 offset:20480
    ds_read_b64_tr_b16 v[178:179], v251 offset:20992
    v_mfma_f32_16x16x32_bf16 v[84:87], v[180:183], a[180:183], v[84:87]
    v_rcp_f32 v204, v204
    v_mfma_f32_16x16x32_bf16 v[76:79], v[180:183], a[108:111], v[76:79]
    v_rcp_f32 v205, v205
    v_mfma_f32_16x16x32_bf16 v[68:71], v[180:183], a[36:39], v[68:71]
    s_waitcnt lgkmcnt(10)
    v_rcp_f32 v206, v206
    v_mfma_f32_16x16x32_bf16 v[96:99], v[184:187], a[36:39], v[96:99]
    ds_read_b64_tr_b16 v[180:181], v251 offset:45056
    ds_read_b64_tr_b16 v[182:183], v251 offset:45568
    v_mfma_f32_16x16x32_bf16 v[104:107], v[184:187], a[108:111], v[104:107]
    buffer_load_dwordx4 v215, s[32:35], s61 offen lds
    s_add_u32 s61, s61, s62
    v_rcp_f32 v207, v207
    v_mfma_f32_16x16x32_bf16 v[112:115], v[184:187], a[180:183], v[112:115]
    s_add_u32 m0, s54, 26624
    v_mul_f32 v12, v12, v200
    v_mul_f32 v13, v13, v201
    v_mfma_f32_16x16x32_bf16 v[120:123], v[184:187], a[252:255], v[120:123]
    v_mul_f32 v14, v14, v202
    v_mul_f32 v15, v15, v203
    v_mfma_f32_16x16x32_bf16 v[124:127], v[188:191], a[252:255], v[124:127]
    ds_read_b64_tr_b16 v[184:185], v252 offset:20480
    ds_read_b64_tr_b16 v[186:187], v252 offset:20992
    v_mfma_f32_16x16x32_bf16 v[116:119], v[188:191], a[180:183], v[116:119]
    v_mul_f32 v44, v44, v204
    v_mul_f32 v45, v45, v205
    v_mfma_f32_16x16x32_bf16 v[108:111], v[188:191], a[108:111], v[108:111]
    v_mul_f32 v46, v46, v206
    v_mul_f32 v47, v47, v207
    v_mfma_f32_16x16x32_bf16 v[100:103], v[188:191], a[36:39], v[100:103]
    s_waitcnt lgkmcnt(10)
    v_cvt_pk_bf16_f32 v200, v12, v13
    v_cvt_pk_bf16_f32 v201, v14, v15
    v_mfma_f32_16x16x32_bf16 v[64:67], v[160:163], a[40:43], v[64:67]
    ds_read_b64_tr_b16 v[188:189], v252 offset:45056
    ds_read_b64_tr_b16 v[190:191], v252 offset:45568
    v_mfma_f32_16x16x32_bf16 v[72:75], v[160:163], a[112:115], v[72:75]
    buffer_load_dwordx4 v215, s[32:35], s61 offen lds
    s_add_u32 s61, s61, s62
    v_cvt_pk_bf16_f32 v202, v44, v45
    v_cvt_pk_bf16_f32 v203, v46, v47
    v_mfma_f32_16x16x32_bf16 v[80:83], v[160:163], a[184:187], v[80:83]
    s_add_u32 m0, s54, 28672
    buffer_store_dwordx4 v[200:203], v216, s[24:27], s48 offen sc0 sc1
    v_mul_f32 v192, v16, v16
    v_mfma_f32_16x16x32_bf16 v[88:91], v[160:163], v[128:131], v[88:91]
    v_add_u32 v251, 0xc000, v251
    v_mul_f32 v193, v17, v17
    v_mfma_f32_16x16x32_bf16 v[92:95], v[164:167], v[128:131], v[92:95]
    ds_read_b64_tr_b16 v[160:161], v251 offset:0
    ds_read_b64_tr_b16 v[162:163], v251 offset:512
    v_mfma_f32_16x16x32_bf16 v[84:87], v[164:167], a[184:187], v[84:87]
    buffer_load_dwordx4 v215, s[32:35], s61 offen lds
    s_add_u32 s61, s61, s62
    v_mul_f32 v194, v18, v18
    v_mul_f32 v195, v19, v19
    v_mul_f32 v196, v48, v48
    v_mfma_f32_16x16x32_bf16 v[76:79], v[164:167], a[112:115], v[76:79]
    s_add_u32 m0, s54, 30720
    v_mul_f32 v197, v49, v49
    v_mul_f32 v198, v50, v50
    v_mfma_f32_16x16x32_bf16 v[68:71], v[164:167], a[40:43], v[68:71]
    s_waitcnt lgkmcnt(10)
    v_mul_f32 v199, v51, v51
    s_waitcnt vmcnt(16)
    v_mfma_f32_16x16x32_bf16 v[96:99], v[168:171], a[40:43], v[96:99]
    ds_read_b64_tr_b16 v[164:165], v251 offset:24576
    ds_read_b64_tr_b16 v[166:167], v251 offset:25088
    v_mfma_f32_16x16x32_bf16 v[104:107], v[168:171], a[112:115], v[104:107]
    v_mov_b32 v255, 1
    v_mfma_f32_16x16x32_bf16 v[112:115], v[168:171], a[184:187], v[112:115]
    s_mov_b64 exec, 1
    buffer_store_dword v255, off, s[92:95], s5 sc0 sc1
    s_mov_b64 exec, -1
    v_cmp_gt_u32 vcc, 32, v254
    s_nop 4
    s_cbranch_vccnz C0_spin
C0_ret:
    v_mul_f32 v20, v16, v20
    v_mfma_f32_16x16x32_bf16 v[120:123], v[168:171], v[128:131], v[120:123]
    v_add_u32 v252, 0xc000, v252
    v_mul_f32 v21, v17, v21
    v_mfma_f32_16x16x32_bf16 v[124:127], v[172:175], v[128:131], v[124:127]
    ds_read_b64_tr_b16 v[168:169], v252 offset:0
    ds_read_b64_tr_b16 v[170:171], v252 offset:512
    v_mfma_f32_16x16x32_bf16 v[116:119], v[172:175], a[184:187], v[116:119]
    buffer_load_dwordx4 v215, s[32:35], s61 offen lds
    s_add_u32 s61, s61, s62
    v_mul_f32 v22, v18, v22
    v_mul_f32 v23, v19, v23
    v_mul_f32 v52, v48, v52
    v_mfma_f32_16x16x32_bf16 v[108:111], v[172:175], a[112:115], v[108:111]
    s_add_u32 m0, s54, 32768
    v_mul_f32 v53, v49, v53
    v_mul_f32 v54, v50, v54
    v_mfma_f32_16x16x32_bf16 v[100:103], v[172:175], a[40:43], v[100:103]
    s_waitcnt lgkmcnt(10)
    v_mul_f32 v55, v51, v55
    v_fmaak_f32 v192, v218, v192, 0xc0135761
    v_mfma_f32_16x16x32_bf16 v[64:67], v[176:179], a[44:47], v[64:67]
    ds_read_b64_tr_b16 v[172:173], v252 offset:24576
    ds_read_b64_tr_b16 v[174:175], v252 offset:25088
    v_mfma_f32_16x16x32_bf16 v[72:75], v[176:179], a[116:119], v[72:75]
    v_fmaak_f32 v193, v218, v193, 0xc0135761
    v_mfma_f32_16x16x32_bf16 v[80:83], v[176:179], a[188:191], v[80:83]
    buffer_store_dwordx4 v[236:239], v222, s[76:79], s3 offen offset:0 sc0 sc1
    v_fmaak_f32 v194, v218, v194, 0xc0135761
    v_mfma_f32_16x16x32_bf16 v[88:91], v[176:179], v[132:135], v[88:91]
    v_fmaak_f32 v195, v218, v195, 0xc0135761
    v_fmaak_f32 v196, v218, v196, 0xc0135761
    v_mfma_f32_16x16x32_bf16 v[92:95], v[180:183], v[132:135], v[92:95]
    ds_read_b64_tr_b16 v[176:177], v251 offset:4096
    ds_read_b64_tr_b16 v[178:179], v251 offset:4608
    v_mfma_f32_16x16x32_bf16 v[84:87], v[180:183], a[188:191], v[84:87]
    buffer_load_dwordx4 v215, s[32:35], s61 offen lds
    s_add_u32 s61, s61, s62
    v_fmaak_f32 v197, v218, v197, 0xc0135761
    v_fmaak_f32 v198, v218, v198, 0xc0135761
    v_fmaak_f32 v199, v218, v199, 0xc0135761
    v_mfma_f32_16x16x32_bf16 v[76:79], v[180:183], a[116:119], v[76:79]
    s_add_u32 m0, s54, 34816
    v_mul_f32 v192, v192, v16
    v_mul_f32 v193, v193, v17
    v_mfma_f32_16x16x32_bf16 v[68:71], v[180:183], a[44:47], v[68:71]
    s_waitcnt lgkmcnt(10)
    v_mul_f32 v194, v194, v18
    v_mul_f32 v195, v195, v19
    v_mfma_f32_16x16x32_bf16 v[96:99], v[184:187], a[44:47], v[96:99]
    ds_read_b64_tr_b16 v[180:181], v251 offset:28672
    ds_read_b64_tr_b16 v[182:183], v251 offset:29184
    v_mfma_f32_16x16x32_bf16 v[104:107], v[184:187], a[116:119], v[104:107]
    buffer_load_dwordx4 v215, s[32:35], s61 offen lds
    s_add_u32 s61, s61, s62
    v_mul_f32 v196, v196, v48
    v_mul_f32 v197, v197, v49
    v_mfma_f32_16x16x32_bf16 v[112:115], v[184:187], a[188:191], v[112:115]
    v_mul_f32 v198, v198, v50
    v_mul_f32 v199, v199, v51
    v_mfma_f32_16x16x32_bf16 v[120:123], v[184:187], v[132:135], v[120:123]
    v_exp_f32 v192, v192
    v_mfma_f32_16x16x32_bf16 v[124:127], v[188:191], v[132:135], v[124:127]
    ds_read_b64_tr_b16 v[184:185], v252 offset:4096
    ds_read_b64_tr_b16 v[186:187], v252 offset:4608
    v_mfma_f32_16x16x32_bf16 v[116:119], v[188:191], a[188:191], v[116:119]
    v_exp_f32 v193, v193
    v_mfma_f32_16x16x32_bf16 v[108:111], v[188:191], a[116:119], v[108:111]
    v_exp_f32 v194, v194
    v_mfma_f32_16x16x32_bf16 v[100:103], v[188:191], a[44:47], v[100:103]
    s_waitcnt lgkmcnt(10)
    v_exp_f32 v195, v195
    v_mfma_f32_16x16x32_bf16 v[64:67], v[160:163], a[48:51], v[64:67]
    ds_read_b64_tr_b16 v[188:189], v252 offset:28672
    ds_read_b64_tr_b16 v[190:191], v252 offset:29184
    v_mfma_f32_16x16x32_bf16 v[72:75], v[160:163], a[120:123], v[72:75]
    v_exp_f32 v196, v196
    v_mfma_f32_16x16x32_bf16 v[80:83], v[160:163], a[192:195], v[80:83]
    v_exp_f32 v197, v197
    v_mfma_f32_16x16x32_bf16 v[88:91], v[160:163], v[136:139], v[88:91]
    v_exp_f32 v198, v198
    v_mfma_f32_16x16x32_bf16 v[92:95], v[164:167], v[136:139], v[92:95]
    ds_read_b64_tr_b16 v[160:161], v251 offset:8192
    ds_read_b64_tr_b16 v[162:163], v251 offset:8704
    v_mfma_f32_16x16x32_bf16 v[84:87], v[164:167], a[192:195], v[84:87]
    v_exp_f32 v199, v199
    v_mfma_f32_16x16x32_bf16 v[76:79], v[164:167], a[120:123], v[76:79]
    v_add_f32 v192, 1.0, v192
    v_add_f32 v193, 1.0, v193
    v_mfma_f32_16x16x32_bf16 v[68:71], v[164:167], a[48:51], v[68:71]
    s_waitcnt lgkmcnt(10)
    v_add_f32 v194, 1.0, v194
    v_add_f32 v195, 1.0, v195
    v_mfma_f32_16x16x32_bf16 v[96:99], v[168:171], a[48:51], v[96:99]
    ds_read_b64_tr_b16 v[164:165], v251 offset:32768
    ds_read_b64_tr_b16 v[166:167], v251 offset:33280
    v_mfma_f32_16x16x32_bf16 v[104:107], v[168:171], a[120:123], v[104:107]
    v_add_f32 v196, 1.0, v196
    v_add_f32 v197, 1.0, v197
    v_mfma_f32_16x16x32_bf16 v[112:115], v[168:171], a[192:195], v[112:115]
    v_add_f32 v198, 1.0, v198
    v_add_f32 v199, 1.0, v199
    v_mfma_f32_16x16x32_bf16 v[120:123], v[168:171], v[136:139], v[120:123]
    v_rcp_f32 v192, v192
    v_mfma_f32_16x16x32_bf16 v[124:127], v[172:175], v[136:139], v[124:127]
    ds_read_b64_tr_b16 v[168:169], v252 offset:8192
    ds_read_b64_tr_b16 v[170:171], v252 offset:8704
    v_mfma_f32_16x16x32_bf16 v[116:119], v[172:175], a[192:195], v[116:119]
    v_rcp_f32 v193, v193
    v_mfma_f32_16x16x32_bf16 v[108:111], v[172:175], a[120:123], v[108:111]
    v_rcp_f32 v194, v194
    v_mfma_f32_16x16x32_bf16 v[100:103], v[172:175], a[48:51], v[100:103]
    s_waitcnt lgkmcnt(10)
    v_rcp_f32 v195, v195
    s_barrier
    v_mfma_f32_16x16x32_bf16 v[64:67], v[176:179], a[52:55], v[64:67]
    s_add_u32 m0, s54, 49152
    ds_read_b64_tr_b16 v[172:173], v252 offset:32768
    ds_read_b64_tr_b16 v[174:175], v252 offset:33280
    v_mfma_f32_16x16x32_bf16 v[72:75], v[176:179], a[124:127], v[72:75]
    s_mov_b64 s[8:9], s[96:97]
    buffer_load_dwordx4 v215, s[32:35], s61 offen lds
    s_add_u32 s61, s61, s62
    s_and_b32 s84, s2, 6
    s_lshr_b32 s85, s36, 1
    s_add_u32 s84, s84, s85
    s_mul_i32 s97, s85, 9216
    s_mul_i32 s96, s84, 663552
    s_mul_i32 s98, s84, 18432
    s_mul_i32 s100, s85, 294912
    s_bfe_u32 s84, s2, 0x20003
    s_mul_i32 s84, s84, 288
    s_add_u32 s96, s96, s84
    s_and_b32 s89, s36, 1
    s_lshl_b32 s85, s89, 10
    s_add_u32 s97, s97, s85
    s_and_b32 s85, s2, 1
    s_lshl_b32 s85, s85, 4
    s_add_u32 s84, s89, s85
    s_lshr_b32 s85, s2, 5
    s_lshl_b32 s85, s85, 1
    s_add_u32 s84, s84, s85
    s_mul_i32 s84, s84, 589824
    s_add_u32 s84, s98, s84
    s_add_u32 s98, s84, s100
    s_sub_u32 s100, s84, s100
    s_add_u32 s100, s100, 294912
    s_add_u32 s99, s98, 147456
    s_add_u32 s101, s100, 147456
    s_load_dwordx2 s[6:7], s[0:1], 0
    s_load_dwordx2 s[20:21], s[0:1], 56
    s_mov_b64 s[84:85], s[8:9]
    s_mov_b32 s86, 256
    s_mov_b32 s87, 0x00020000
    v_rcp_f32 v196, v196
    v_mfma_f32_16x16x32_bf16 v[80:83], v[176:179], a[196:199], v[80:83]
    s_add_u32 m0, s54, 51200
    v_rcp_f32 v197, v197
    v_mfma_f32_16x16x32_bf16 v[88:91], v[176:179], v[140:143], v[88:91]
    buffer_load_dwordx4 v215, s[32:35], s61 offen lds
    s_add_u32 s61, s61, s62
    v_mfma_f32_16x16x32_bf16 v[92:95], v[180:183], v[140:143], v[92:95]
    s_add_u32 m0, s54, 53248
    ds_read_b64_tr_b16 v[176:177], v251 offset:12288
    ds_read_b64_tr_b16 v[178:179], v251 offset:12800
    v_mfma_f32_16x16x32_bf16 v[84:87], v[180:183], a[196:199], v[84:87]
    v_rcp_f32 v198, v198
    v_mfma_f32_16x16x32_bf16 v[76:79], v[180:183], a[124:127], v[76:79]
    v_rcp_f32 v199, v199
    v_mfma_f32_16x16x32_bf16 v[68:71], v[180:183], a[52:55], v[68:71]
    s_waitcnt lgkmcnt(10)
    v_mul_f32 v20, v20, v192
    v_mul_f32 v21, v21, v193
    v_mfma_f32_16x16x32_bf16 v[96:99], v[184:187], a[52:55], v[96:99]
    ds_read_b64_tr_b16 v[180:181], v251 offset:36864
    ds_read_b64_tr_b16 v[182:183], v251 offset:37376
    v_mfma_f32_16x16x32_bf16 v[104:107], v[184:187], a[124:127], v[104:107]
    buffer_load_dwordx4 v215, s[32:35], s61 offen lds
    s_add_u32 s61, s61, s62
    v_mul_f32 v22, v22, v194
    v_mul_f32 v23, v23, v195
    v_mfma_f32_16x16x32_bf16 v[112:115], v[184:187], a[196:199], v[112:115]
    s_add_u32 m0, s54, 55296
    v_mul_f32 v52, v52, v196
    v_mul_f32 v53, v53, v197
    v_mfma_f32_16x16x32_bf16 v[120:123], v[184:187], v[140:143], v[120:123]
    v_mul_f32 v54, v54, v198
    v_mul_f32 v55, v55, v199
    v_mfma_f32_16x16x32_bf16 v[124:127], v[188:191], v[140:143], v[124:127]
    ds_read_b64_tr_b16 v[184:185], v252 offset:12288
    ds_read_b64_tr_b16 v[186:187], v252 offset:12800
    v_mfma_f32_16x16x32_bf16 v[116:119], v[188:191], a[196:199], v[116:119]
    v_cvt_pk_bf16_f32 v192, v20, v21
    v_cvt_pk_bf16_f32 v193, v22, v23
    v_mfma_f32_16x16x32_bf16 v[108:111], v[188:191], a[124:127], v[108:111]
    v_cvt_pk_bf16_f32 v194, v52, v53
    v_cvt_pk_bf16_f32 v195, v54, v55
    v_mfma_f32_16x16x32_bf16 v[100:103], v[188:191], a[52:55], v[100:103]
    s_waitcnt lgkmcnt(10)
    buffer_store_dwordx4 v[192:195], v222, s[24:27], s49 offen sc0 sc1
    v_mul_f32 v200, v24, v24
    v_mfma_f32_16x16x32_bf16 v[64:67], v[160:163], a[56:59], v[64:67]
    ds_read_b64_tr_b16 v[188:189], v252 offset:36864
    ds_read_b64_tr_b16 v[190:191], v252 offset:37376
    v_mfma_f32_16x16x32_bf16 v[72:75], v[160:163], a[128:131], v[72:75]
    buffer_load_dwordx4 v215, s[32:35], s61 offen lds
    s_add_u32 s61, s61, s62
    v_mul_f32 v201, v25, v25
    v_mul_f32 v202, v26, v26
    v_mfma_f32_16x16x32_bf16 v[80:83], v[160:163], a[200:203], v[80:83]
    s_add_u32 m0, s54, 57344
    v_mul_f32 v203, v27, v27
    v_mul_f32 v204, v56, v56
    v_mfma_f32_16x16x32_bf16 v[88:91], v[160:163], v[144:147], v[88:91]
    v_mul_f32 v205, v57, v57
    v_mul_f32 v206, v58, v58
    v_mfma_f32_16x16x32_bf16 v[92:95], v[164:167], v[144:147], v[92:95]
    ds_read_b64_tr_b16 v[160:161], v251 offset:16384
    ds_read_b64_tr_b16 v[162:163], v251 offset:16896
    v_mfma_f32_16x16x32_bf16 v[84:87], v[164:167], a[200:203], v[84:87]
    v_mul_f32 v207, v59, v59
    v_mfma_f32_16x16x32_bf16 v[76:79], v[164:167], a[128:131], v[76:79]
    buffer_store_dwordx4 v[236:239], v222, s[76:79], s3 offen offset:1024 sc0 sc1
    v_mul_f32 v28, v24, v28
    v_mfma_f32_16x16x32_bf16 v[68:71], v[164:167], a[56:59], v[68:71]
    s_waitcnt lgkmcnt(10)
    v_mul_f32 v29, v25, v29
    v_mul_f32 v30, v26, v30
    v_mfma_f32_16x16x32_bf16 v[96:99], v[168:171], a[56:59], v[96:99]
    ds_read_b64_tr_b16 v[164:165], v251 offset:40960
    ds_read_b64_tr_b16 v[166:167], v251 offset:41472
    v_mfma_f32_16x16x32_bf16 v[104:107], v[168:171], a[128:131], v[104:107]
    buffer_load_dwordx4 v215, s[32:35], s61 offen lds
    s_add_u32 s61, s61, s62
    v_mul_f32 v31, v27, v31
    v_mul_f32 v60, v56, v60
    v_mul_f32 v61, v57, v61
    v_mfma_f32_16x16x32_bf16 v[112:115], v[168:171], a[200:203], v[112:115]
    s_add_u32 m0, s54, 59392
    v_mul_f32 v62, v58, v62
    v_mul_f32 v63, v59, v63
    v_mfma_f32_16x16x32_bf16 v[120:123], v[168:171], v[144:147], v[120:123]
    v_fmaak_f32 v200, v218, v200, 0xc0135761
    v_fmaak_f32 v201, v218, v201, 0xc0135761
    v_mfma_f32_16x16x32_bf16 v[124:127], v[172:175], v[144:147], v[124:127]
    ds_read_b64_tr_b16 v[168:169], v252 offset:16384
    ds_read_b64_tr_b16 v[170:171], v252 offset:16896
    v_mfma_f32_16x16x32_bf16 v[116:119], v[172:175], a[200:203], v[116:119]
    buffer_load_dwordx4 v215, s[32:35], s61 offen lds
    s_add_u32 s61, s61, s62
    v_fmaak_f32 v202, v218, v202, 0xc0135761
    v_mfma_f32_16x16x32_bf16 v[108:111], v[172:175], a[128:131], v[108:111]
    v_fmaak_f32 v203, v218, v203, 0xc0135761
    v_fmaak_f32 v204, v218, v204, 0xc0135761
    v_mfma_f32_16x16x32_bf16 v[100:103], v[172:175], a[56:59], v[100:103]
    s_waitcnt lgkmcnt(10)
    v_fmaak_f32 v205, v218, v205, 0xc0135761
    v_fmaak_f32 v206, v218, v206, 0xc0135761
    v_mfma_f32_16x16x32_bf16 v[64:67], v[176:179], a[60:63], v[64:67]
    ds_read_b64_tr_b16 v[172:173], v252 offset:40960
    ds_read_b64_tr_b16 v[174:175], v252 offset:41472
    v_mfma_f32_16x16x32_bf16 v[72:75], v[176:179], a[132:135], v[72:75]
    v_fmaak_f32 v207, v218, v207, 0xc0135761
    v_mul_f32 v200, v200, v24
    v_mfma_f32_16x16x32_bf16 v[80:83], v[176:179], a[204:207], v[80:83]
    v_mul_f32 v201, v201, v25
    v_mul_f32 v202, v202, v26
    v_mfma_f32_16x16x32_bf16 v[88:91], v[176:179], v[148:151], v[88:91]
    v_mul_f32 v203, v203, v27
    v_mul_f32 v204, v204, v56
    v_mfma_f32_16x16x32_bf16 v[92:95], v[180:183], v[148:151], v[92:95]
    ds_read_b64_tr_b16 v[176:177], v251 offset:20480
    ds_read_b64_tr_b16 v[178:179], v251 offset:20992
    v_mfma_f32_16x16x32_bf16 v[84:87], v[180:183], a[204:207], v[84:87]
    v_mul_f32 v205, v205, v57
    v_mul_f32 v206, v206, v58
    v_mfma_f32_16x16x32_bf16 v[76:79], v[180:183], a[132:135], v[76:79]
    v_mul_f32 v207, v207, v59
    v_mfma_f32_16x16x32_bf16 v[68:71], v[180:183], a[60:63], v[68:71]
    s_waitcnt lgkmcnt(10)
    v_exp_f32 v200, v200
    v_mfma_f32_16x16x32_bf16 v[96:99], v[184:187], a[60:63], v[96:99]
    ds_read_b64_tr_b16 v[180:181], v251 offset:45056
    ds_read_b64_tr_b16 v[182:183], v251 offset:45568
    v_mfma_f32_16x16x32_bf16 v[104:107], v[184:187], a[132:135], v[104:107]
    v_exp_f32 v201, v201
    v_exp_f32 v202, v202
    v_mfma_f32_16x16x32_bf16 v[112:115], v[184:187], a[204:207], v[112:115]
    v_exp_f32 v203, v203
    v_mfma_f32_16x16x32_bf16 v[120:123], v[184:187], v[148:151], v[120:123]
    v_exp_f32 v204, v204
    v_mfma_f32_16x16x32_bf16 v[124:127], v[188:191], v[148:151], v[124:127]
    ds_read_b64_tr_b16 v[184:185], v252 offset:20480
    ds_read_b64_tr_b16 v[186:187], v252 offset:20992
    v_mfma_f32_16x16x32_bf16 v[116:119], v[188:191], a[204:207], v[116:119]
    v_exp_f32 v205, v205
    v_mfma_f32_16x16x32_bf16 v[108:111], v[188:191], a[132:135], v[108:111]
    v_exp_f32 v206, v206
    v_mfma_f32_16x16x32_bf16 v[100:103], v[188:191], a[60:63], v[100:103]
    s_waitcnt lgkmcnt(10)
    v_exp_f32 v207, v207
    s_waitcnt vmcnt(17)
    s_barrier
    v_mfma_f32_16x16x32_bf16 v[64:67], v[160:163], a[64:67], v[64:67]
    ds_read_b64_tr_b16 v[188:189], v252 offset:45056
    ds_read_b64_tr_b16 v[190:191], v252 offset:45568
    v_mfma_f32_16x16x32_bf16 v[72:75], v[160:163], a[136:139], v[72:75]
    v_add_f32 v200, 1.0, v200
    v_add_f32 v201, 1.0, v201
    v_mfma_f32_16x16x32_bf16 v[80:83], v[160:163], a[208:211], v[80:83]
    v_add_f32 v202, 1.0, v202
    v_add_f32 v203, 1.0, v203
    v_mfma_f32_16x16x32_bf16 v[88:91], v[160:163], v[152:155], v[88:91]
    v_add_f32 v204, 1.0, v204
    v_add_f32 v205, 1.0, v205
    v_mfma_f32_16x16x32_bf16 v[92:95], v[164:167], v[152:155], v[92:95]
    ds_read_b64_tr_b16 v[160:161], v209 offset:0
    ds_read_b64_tr_b16 v[162:163], v209 offset:256
    v_mfma_f32_16x16x32_bf16 v[84:87], v[164:167], a[208:211], v[84:87]
    v_add_f32 v206, 1.0, v206
    v_add_f32 v207, 1.0, v207
    v_mfma_f32_16x16x32_bf16 v[76:79], v[164:167], a[136:139], v[76:79]
    v_rcp_f32 v200, v200
    v_mfma_f32_16x16x32_bf16 v[68:71], v[164:167], a[64:67], v[68:71]
    s_waitcnt lgkmcnt(10)
    v_rcp_f32 v201, v201
    v_mfma_f32_16x16x32_bf16 v[96:99], v[168:171], a[64:67], v[96:99]
    ds_read_b64_tr_b16 v[164:165], v209 offset:12288
    ds_read_b64_tr_b16 v[166:167], v209 offset:12544
    v_mfma_f32_16x16x32_bf16 v[104:107], v[168:171], a[136:139], v[104:107]
    v_rcp_f32 v202, v202
    v_mfma_f32_16x16x32_bf16 v[112:115], v[168:171], a[208:211], v[112:115]
    v_rcp_f32 v203, v203
    v_mfma_f32_16x16x32_bf16 v[120:123], v[168:171], v[152:155], v[120:123]
    v_rcp_f32 v204, v204
    v_mfma_f32_16x16x32_bf16 v[124:127], v[172:175], v[152:155], v[124:127]
    ds_read_b64_tr_b16 v[168:169], v210 offset:0
    ds_read_b64_tr_b16 v[170:171], v210 offset:256
    v_mfma_f32_16x16x32_bf16 v[116:119], v[172:175], a[208:211], v[116:119]
    v_rcp_f32 v205, v205
    v_mfma_f32_16x16x32_bf16 v[108:111], v[172:175], a[136:139], v[108:111]
    v_rcp_f32 v206, v206
    v_mfma_f32_16x16x32_bf16 v[100:103], v[172:175], a[64:67], v[100:103]
    s_waitcnt lgkmcnt(10)
    v_rcp_f32 v207, v207
    v_mfma_f32_16x16x32_bf16 v[64:67], v[176:179], a[68:71], v[64:67]
    ds_read_b64_tr_b16 v[172:173], v210 offset:12288
    ds_read_b64_tr_b16 v[174:175], v210 offset:12544
    v_mfma_f32_16x16x32_bf16 v[72:75], v[176:179], a[140:143], v[72:75]
    v_mul_f32 v28, v28, v200
    v_mfma_f32_16x16x32_bf16 v[80:83], v[176:179], a[212:215], v[80:83]
    buffer_store_dwordx4 v[236:239], v222, s[76:79], s3 offen offset:2048 sc0 sc1
    v_mul_f32 v29, v29, v201
    v_mfma_f32_16x16x32_bf16 v[88:91], v[176:179], v[156:159], v[88:91]
    v_mul_f32 v30, v30, v202
    v_mul_f32 v31, v31, v203
    v_mfma_f32_16x16x32_bf16 v[92:95], v[180:183], v[156:159], v[92:95]
    ds_read_b64_tr_b16 v[176:177], v209 offset:2048
    ds_read_b64_tr_b16 v[178:179], v209 offset:2304
    v_mfma_f32_16x16x32_bf16 v[84:87], v[180:183], a[212:215], v[84:87]
    v_mul_f32 v60, v60, v204
    v_mul_f32 v61, v61, v205
    v_mfma_f32_16x16x32_bf16 v[76:79], v[180:183], a[140:143], v[76:79]
    v_mul_f32 v62, v62, v206
    v_mul_f32 v63, v63, v207
    v_mfma_f32_16x16x32_bf16 v[68:71], v[180:183], a[68:71], v[68:71]
    s_waitcnt lgkmcnt(10)
    v_cvt_pk_bf16_f32 v200, v28, v29
    v_cvt_pk_bf16_f32 v201, v30, v31
    v_mfma_f32_16x16x32_bf16 v[96:99], v[184:187], a[68:71], v[96:99]
    ds_read_b64_tr_b16 v[180:181], v209 offset:14336
    ds_read_b64_tr_b16 v[182:183], v209 offset:14592
    v_mfma_f32_16x16x32_bf16 v[104:107], v[184:187], a[140:143], v[104:107]
    v_cvt_pk_bf16_f32 v202, v60, v61
    v_cvt_pk_bf16_f32 v203, v62, v63
    v_mfma_f32_16x16x32_bf16 v[112:115], v[184:187], a[212:215], v[112:115]
    buffer_store_dwordx4 v[200:203], v216, s[24:27], s49 offen sc0 sc1
    s_add_u32 s48, s48, 1024
    v_mfma_f32_16x16x32_bf16 v[120:123], v[184:187], v[156:159], v[120:123]
    s_add_u32 s49, s49, 1024
    v_mfma_f32_16x16x32_bf16 v[124:127], v[188:191], v[156:159], v[124:127]
    ds_read_b64_tr_b16 v[184:185], v210 offset:2048
    ds_read_b64_tr_b16 v[186:187], v210 offset:2304
    v_mfma_f32_16x16x32_bf16 v[116:119], v[188:191], a[212:215], v[116:119]
    v_mfma_f32_16x16x32_bf16 v[108:111], v[188:191], a[140:143], v[108:111]
    v_mfma_f32_16x16x32_bf16 v[100:103], v[188:191], a[68:71], v[100:103]
    s_waitcnt lgkmcnt(12)
    s_waitcnt lgkmcnt(10)
    v_mfma_f32_16x16x32_bf16 v[0:3], v[160:163], a[0:3], 0
    ds_read_b64_tr_b16 v[188:189], v210 offset:14336
    ds_read_b64_tr_b16 v[190:191], v210 offset:14592
    v_mfma_f32_16x16x32_bf16 v[8:11], v[160:163], a[72:75], 0
    v_mfma_f32_16x16x32_bf16 v[16:19], v[160:163], a[144:147], 0
    v_mfma_f32_16x16x32_bf16 v[24:27], v[160:163], a[216:219], 0
    v_mfma_f32_16x16x32_bf16 v[28:31], v[164:167], a[216:219], 0
    ds_read_b64_tr_b16 v[160:161], v209 offset:4096
H1_S7_0:
    s_cbranch_execz H1_ret
    ds_read_b64_tr_b16 v[162:163], v209 offset:4352
    v_mfma_f32_16x16x32_bf16 v[20:23], v[164:167], a[144:147], 0
    v_mfma_f32_16x16x32_bf16 v[12:15], v[164:167], a[72:75], 0
    v_mfma_f32_16x16x32_bf16 v[4:7], v[164:167], a[0:3], 0
    s_waitcnt lgkmcnt(10)
    v_mfma_f32_16x16x32_bf16 v[32:35], v[168:171], a[0:3], 0
    ds_read_b64_tr_b16 v[164:165], v209 offset:16384
    ds_read_b64_tr_b16 v[166:167], v209 offset:16640
    v_mfma_f32_16x16x32_bf16 v[40:43], v[168:171], a[72:75], 0
    v_mul_f32 v192, v64, v64
    v_mul_f32 v193, v65, v65
    v_mfma_f32_16x16x32_bf16 v[48:51], v[168:171], a[144:147], 0
    v_mul_f32 v194, v66, v66
    v_mul_f32 v195, v67, v67
    v_mfma_f32_16x16x32_bf16 v[56:59], v[168:171], a[216:219], 0
    v_mul_f32 v196, v96, v96
    v_mul_f32 v197, v97, v97
    v_mfma_f32_16x16x32_bf16 v[60:63], v[172:175], a[216:219], 0
    ds_read_b64_tr_b16 v[168:169], v210 offset:4096
    ds_read_b64_tr_b16 v[170:171], v210 offset:4352
    v_mfma_f32_16x16x32_bf16 v[52:55], v[172:175], a[144:147], 0
    v_mul_f32 v198, v98, v98
    v_mul_f32 v199, v99, v99
    v_mfma_f32_16x16x32_bf16 v[44:47], v[172:175], a[72:75], 0
    v_mul_f32 v68, v64, v68
    v_mul_f32 v69, v65, v69
    v_mfma_f32_16x16x32_bf16 v[36:39], v[172:175], a[0:3], 0
    s_waitcnt lgkmcnt(10)
    v_mul_f32 v70, v66, v70
    v_mul_f32 v71, v67, v71
    s_waitcnt vmcnt(10)
    s_barrier
    v_mfma_f32_16x16x32_bf16 v[0:3], v[176:179], a[4:7], v[0:3]
    ds_read_b64_tr_b16 v[172:173], v210 offset:16384
    ds_read_b64_tr_b16 v[174:175], v210 offset:16640
    v_mfma_f32_16x16x32_bf16 v[8:11], v[176:179], a[76:79], v[8:11]
    s_cmp_eq_u32 s47, 3
    s_cselect_b32 s61, s43, s41
    s_mul_i32 s62, s36, 55296
    v_mfma_f32_16x16x32_bf16 v[16:19], v[176:179], a[148:151], v[16:19]
    s_add_u32 s61, s61, s62
    s_lshl_b32 s62, s36, 10
    s_add_u32 m0, s62, 110592
    v_mfma_f32_16x16x32_bf16 v[24:27], v[176:179], a[220:223], v[24:27]
    buffer_load_dwordx4 v214, s[16:19], s61 offen lds
    s_add_u32 s61, s61, 221184
    v_mfma_f32_16x16x32_bf16 v[28:31], v[180:183], a[220:223], v[28:31]
    s_add_u32 m0, s62, 114688
    ds_read_b64_tr_b16 v[176:177], v209 offset:6144
    ds_read_b64_tr_b16 v[178:179], v209 offset:6400
    v_mfma_f32_16x16x32_bf16 v[20:23], v[180:183], a[148:151], v[20:23]
    buffer_load_dwordx4 v214, s[16:19], s61 offen lds
    s_add_u32 s61, s61, 221184
    v_mfma_f32_16x16x32_bf16 v[12:15], v[180:183], a[76:79], v[12:15]
    s_add_u32 m0, s62, 118784
    v_mul_f32 v100, v96, v100
    v_mul_f32 v101, v97, v101
    v_mfma_f32_16x16x32_bf16 v[4:7], v[180:183], a[4:7], v[4:7]
    s_waitcnt lgkmcnt(10)
    v_mul_f32 v102, v98, v102
    v_mul_f32 v103, v99, v103
    v_mfma_f32_16x16x32_bf16 v[32:35], v[184:187], a[4:7], v[32:35]
    ds_read_b64_tr_b16 v[180:181], v209 offset:18432
    ds_read_b64_tr_b16 v[182:183], v209 offset:18688
    v_mfma_f32_16x16x32_bf16 v[40:43], v[184:187], a[76:79], v[40:43]
    buffer_load_dwordx4 v214, s[16:19], s61 offen lds
    s_add_u32 s61, s61, 221184
    v_fmaak_f32 v192, v218, v192, 0xc0135761
    v_mfma_f32_16x16x32_bf16 v[48:51], v[184:187], a[148:151], v[48:51]
    s_add_u32 m0, s62, 122880
    v_fmaak_f32 v193, v218, v193, 0xc0135761
    v_fmaak_f32 v194, v218, v194, 0xc0135761
    v_mfma_f32_16x16x32_bf16 v[56:59], v[184:187], a[220:223], v[56:59]
    v_fmaak_f32 v195, v218, v195, 0xc0135761
    v_fmaak_f32 v196, v218, v196, 0xc0135761
    v_mfma_f32_16x16x32_bf16 v[60:63], v[188:191], a[220:223], v[60:63]
    ds_read_b64_tr_b16 v[184:185], v210 offset:6144
    ds_read_b64_tr_b16 v[186:187], v210 offset:6400
    v_mfma_f32_16x16x32_bf16 v[52:55], v[188:191], a[148:151], v[52:55]
    v_fmaak_f32 v197, v218, v197, 0xc0135761
    v_fmaak_f32 v198, v218, v198, 0xc0135761
    v_mfma_f32_16x16x32_bf16 v[44:47], v[188:191], a[76:79], v[44:47]
    v_fmaak_f32 v199, v218, v199, 0xc0135761
    v_mul_f32 v192, v192, v64
    v_mfma_f32_16x16x32_bf16 v[36:39], v[188:191], a[4:7], v[36:39]
    s_waitcnt lgkmcnt(10)
    v_mul_f32 v193, v193, v65
    v_mul_f32 v194, v194, v66
    v_mfma_f32_16x16x32_bf16 v[0:3], v[160:163], a[8:11], v[0:3]
    ds_read_b64_tr_b16 v[188:189], v210 offset:18432
    ds_read_b64_tr_b16 v[190:191], v210 offset:18688
    v_mfma_f32_16x16x32_bf16 v[8:11], v[160:163], a[80:83], v[8:11]
    buffer_load_dwordx4 v214, s[16:19], s61 offen lds
    s_add_u32 s61, s61, 221184
    v_mul_f32 v195, v195, v67
    v_mfma_f32_16x16x32_bf16 v[16:19], v[160:163], a[152:155], v[16:19]
    s_add_u32 m0, s62, 126976
    v_mul_f32 v196, v196, v96
    v_mul_f32 v197, v197, v97
    v_mfma_f32_16x16x32_bf16 v[24:27], v[160:163], a[224:227], v[24:27]
    v_mul_f32 v198, v198, v98
    v_mul_f32 v199, v199, v99
    v_mfma_f32_16x16x32_bf16 v[28:31], v[164:167], a[224:227], v[28:31]
    ds_read_b64_tr_b16 v[160:161], v209 offset:8192
    ds_read_b64_tr_b16 v[162:163], v209 offset:8448
    v_mfma_f32_16x16x32_bf16 v[20:23], v[164:167], a[152:155], v[20:23]
    buffer_load_dwordx4 v214, s[16:19], s61 offen lds
    s_add_u32 s61, s61, 221184
    v_exp_f32 v192, v192
    v_mfma_f32_16x16x32_bf16 v[12:15], v[164:167], a[80:83], v[12:15]
    s_add_u32 m0, s62, 131072
    v_exp_f32 v193, v193
    v_mfma_f32_16x16x32_bf16 v[4:7], v[164:167], a[8:11], v[4:7]
    s_waitcnt lgkmcnt(10)
    v_exp_f32 v194, v194
    v_mfma_f32_16x16x32_bf16 v[32:35], v[168:171], a[8:11], v[32:35]
    ds_read_b64_tr_b16 v[164:165], v209 offset:20480
    ds_read_b64_tr_b16 v[166:167], v209 offset:20736
    v_mfma_f32_16x16x32_bf16 v[40:43], v[168:171], a[80:83], v[40:43]
    v_exp_f32 v195, v195
    v_mfma_f32_16x16x32_bf16 v[48:51], v[168:171], a[152:155], v[48:51]
    v_exp_f32 v196, v196
    v_mfma_f32_16x16x32_bf16 v[56:59], v[168:171], a[224:227], v[56:59]
    v_exp_f32 v197, v197
    v_mfma_f32_16x16x32_bf16 v[60:63], v[172:175], a[224:227], v[60:63]
    ds_read_b64_tr_b16 v[168:169], v210 offset:8192
    ds_read_b64_tr_b16 v[170:171], v210 offset:8448
    v_mfma_f32_16x16x32_bf16 v[52:55], v[172:175], a[152:155], v[52:55]
    buffer_load_dwordx4 v214, s[16:19], s61 offen lds
    s_add_u32 s61, s61, 221184
    v_mfma_f32_16x16x32_bf16 v[44:47], v[172:175], a[80:83], v[44:47]
    s_add_u32 m0, s62, 135168
    v_exp_f32 v198, v198
    v_mfma_f32_16x16x32_bf16 v[36:39], v[172:175], a[8:11], v[36:39]
    s_waitcnt lgkmcnt(10)
    v_exp_f32 v199, v199
    v_mfma_f32_16x16x32_bf16 v[0:3], v[176:179], a[12:15], v[0:3]
    ds_read_b64_tr_b16 v[172:173], v210 offset:20480
    ds_read_b64_tr_b16 v[174:175], v210 offset:20736
    v_mfma_f32_16x16x32_bf16 v[8:11], v[176:179], a[84:87], v[8:11]
    v_add_f32 v192, 1.0, v192
    v_add_f32 v193, 1.0, v193
    v_mfma_f32_16x16x32_bf16 v[16:19], v[176:179], a[156:159], v[16:19]
    v_add_f32 v194, 1.0, v194
    v_add_f32 v195, 1.0, v195
    v_mfma_f32_16x16x32_bf16 v[24:27], v[176:179], a[228:231], v[24:27]
    v_add_f32 v196, 1.0, v196
    v_add_f32 v197, 1.0, v197
    v_mfma_f32_16x16x32_bf16 v[28:31], v[180:183], a[228:231], v[28:31]
    ds_read_b64_tr_b16 v[176:177], v209 offset:10240
    ds_read_b64_tr_b16 v[178:179], v209 offset:10496
    v_mfma_f32_16x16x32_bf16 v[20:23], v[180:183], a[156:159], v[20:23]
    buffer_load_dwordx4 v214, s[16:19], s61 offen lds
    s_add_u32 s61, s61, 221184
    v_mfma_f32_16x16x32_bf16 v[12:15], v[180:183], a[84:87], v[12:15]
    s_add_u32 m0, s62, 139264
    v_add_f32 v198, 1.0, v198
    v_add_f32 v199, 1.0, v199
    v_mfma_f32_16x16x32_bf16 v[4:7], v[180:183], a[12:15], v[4:7]
    s_waitcnt lgkmcnt(10)
    v_rcp_f32 v192, v192
    v_mfma_f32_16x16x32_bf16 v[32:35], v[184:187], a[12:15], v[32:35]
    ds_read_b64_tr_b16 v[180:181], v209 offset:22528
    ds_read_b64_tr_b16 v[182:183], v209 offset:22784
    v_mfma_f32_16x16x32_bf16 v[40:43], v[184:187], a[84:87], v[40:43]
    v_rcp_f32 v193, v193
    v_mfma_f32_16x16x32_bf16 v[48:51], v[184:187], a[156:159], v[48:51]
    v_rcp_f32 v194, v194
    v_mfma_f32_16x16x32_bf16 v[56:59], v[184:187], a[228:231], v[56:59]
    v_rcp_f32 v195, v195
    v_mfma_f32_16x16x32_bf16 v[60:63], v[188:191], a[228:231], v[60:63]
    ds_read_b64_tr_b16 v[184:185], v210 offset:10240
    ds_read_b64_tr_b16 v[186:187], v210 offset:10496
    v_mfma_f32_16x16x32_bf16 v[52:55], v[188:191], a[156:159], v[52:55]
    buffer_load_dwordx4 v214, s[16:19], s61 offen lds
    s_add_u32 s61, s61, 221184
    v_mfma_f32_16x16x32_bf16 v[44:47], v[188:191], a[84:87], v[44:47]
    s_add_u32 m0, s62, 143360
    v_rcp_f32 v196, v196
    v_mfma_f32_16x16x32_bf16 v[36:39], v[188:191], a[12:15], v[36:39]
    s_waitcnt lgkmcnt(10)
    v_rcp_f32 v197, v197
    v_mfma_f32_16x16x32_bf16 v[0:3], v[160:163], a[16:19], v[0:3]
    ds_read_b64_tr_b16 v[188:189], v210 offset:22528
    ds_read_b64_tr_b16 v[190:191], v210 offset:22784
    v_mfma_f32_16x16x32_bf16 v[8:11], v[160:163], a[88:91], v[8:11]
    buffer_load_dwordx4 v214, s[16:19], s61 offen lds
    s_add_u32 s61, s61, 221184
    v_mfma_f32_16x16x32_bf16 v[16:19], v[160:163], a[160:163], v[16:19]
    s_add_u32 m0, s97, 73728
    v_rcp_f32 v198, v198
    v_mfma_f32_16x16x32_bf16 v[24:27], v[160:163], a[232:235], v[24:27]
    v_rcp_f32 v199, v199
    v_mfma_f32_16x16x32_bf16 v[28:31], v[164:167], a[232:235], v[28:31]
    ds_read_b64_tr_b16 v[160:161], v209 offset:24576
    ds_read_b64_tr_b16 v[162:163], v209 offset:24832
    v_mfma_f32_16x16x32_bf16 v[20:23], v[164:167], a[160:163], v[20:23]
    v_mul_f32 v68, v68, v192
    v_mul_f32 v69, v69, v193
    v_mfma_f32_16x16x32_bf16 v[12:15], v[164:167], a[88:91], v[12:15]
    v_mul_f32 v70, v70, v194
    v_mul_f32 v71, v71, v195
    v_mfma_f32_16x16x32_bf16 v[4:7], v[164:167], a[16:19], v[4:7]
    s_waitcnt lgkmcnt(10)
    v_mul_f32 v100, v100, v196
    v_mul_f32 v101, v101, v197
    v_mfma_f32_16x16x32_bf16 v[32:35], v[168:171], a[16:19], v[32:35]
    ds_read_b64_tr_b16 v[164:165], v209 offset:36864
    ds_read_b64_tr_b16 v[166:167], v209 offset:37120
    v_mfma_f32_16x16x32_bf16 v[40:43], v[168:171], a[88:91], v[40:43]
    buffer_load_dwordx4 v225, s[80:83], s96 offen lds
    v_mul_f32 v102, v102, v198
    v_mfma_f32_16x16x32_bf16 v[48:51], v[168:171], a[160:163], v[48:51]
    s_add_u32 m0, s97, 75776
    v_mul_f32 v103, v103, v199
    v_cvt_pk_bf16_f32 v192, v68, v69
    v_mfma_f32_16x16x32_bf16 v[56:59], v[168:171], a[232:235], v[56:59]
    v_cvt_pk_bf16_f32 v193, v70, v71
    v_cvt_pk_bf16_f32 v194, v100, v101
    v_mfma_f32_16x16x32_bf16 v[60:63], v[172:175], a[232:235], v[60:63]
    ds_read_b64_tr_b16 v[168:169], v210 offset:24576
    ds_read_b64_tr_b16 v[170:171], v210 offset:24832
    v_mfma_f32_16x16x32_bf16 v[52:55], v[172:175], a[160:163], v[52:55]
    v_cvt_pk_bf16_f32 v195, v102, v103
    v_mfma_f32_16x16x32_bf16 v[44:47], v[172:175], a[88:91], v[44:47]
    buffer_store_dwordx4 v[192:195], v222, s[24:27], s48 offen sc0 sc1
    v_mul_f32 v200, v72, v72
    v_mfma_f32_16x16x32_bf16 v[36:39], v[172:175], a[16:19], v[36:39]
    s_waitcnt lgkmcnt(10)
    v_mul_f32 v201, v73, v73
    v_mul_f32 v202, v74, v74
    v_mfma_f32_16x16x32_bf16 v[0:3], v[176:179], a[20:23], v[0:3]
    ds_read_b64_tr_b16 v[172:173], v210 offset:36864
    ds_read_b64_tr_b16 v[174:175], v210 offset:37120
    v_mfma_f32_16x16x32_bf16 v[8:11], v[176:179], a[92:95], v[8:11]
    buffer_load_dwordx4 v226, s[80:83], s96 offen lds
    v_mul_f32 v203, v75, v75
    v_mfma_f32_16x16x32_bf16 v[16:19], v[176:179], a[164:167], v[16:19]
    s_add_u32 m0, s97, 77824
    v_mul_f32 v204, v104, v104
    v_mul_f32 v205, v105, v105
    v_mfma_f32_16x16x32_bf16 v[24:27], v[176:179], a[236:239], v[24:27]
    v_mul_f32 v206, v106, v106
    v_mul_f32 v207, v107, v107
    v_mfma_f32_16x16x32_bf16 v[28:31], v[180:183], a[236:239], v[28:31]
    ds_read_b64_tr_b16 v[176:177], v209 offset:26624
    ds_read_b64_tr_b16 v[178:179], v209 offset:26880
    v_mfma_f32_16x16x32_bf16 v[20:23], v[180:183], a[164:167], v[20:23]
    buffer_load_dwordx4 v227, s[80:83], s96 offen lds
    v_mul_f32 v76, v72, v76
    v_mfma_f32_16x16x32_bf16 v[12:15], v[180:183], a[92:95], v[12:15]
    s_add_u32 m0, s97, 79872
    v_mul_f32 v77, v73, v77
    v_mul_f32 v78, v74, v78
    v_mfma_f32_16x16x32_bf16 v[4:7], v[180:183], a[20:23], v[4:7]
    s_waitcnt lgkmcnt(10)
    v_mul_f32 v79, v75, v79
    v_mul_f32 v108, v104, v108
    v_mfma_f32_16x16x32_bf16 v[32:35], v[184:187], a[20:23], v[32:35]
    ds_read_b64_tr_b16 v[180:181], v209 offset:38912
    ds_read_b64_tr_b16 v[182:183], v209 offset:39168
    v_mfma_f32_16x16x32_bf16 v[40:43], v[184:187], a[92:95], v[40:43]
    v_mul_f32 v109, v105, v109
    v_mul_f32 v110, v106, v110
    v_mfma_f32_16x16x32_bf16 v[48:51], v[184:187], a[164:167], v[48:51]
    v_mul_f32 v111, v107, v111
    v_fmaak_f32 v200, v218, v200, 0xc0135761
    v_mfma_f32_16x16x32_bf16 v[56:59], v[184:187], a[236:239], v[56:59]
    v_fmaak_f32 v201, v218, v201, 0xc0135761
    v_fmaak_f32 v202, v218, v202, 0xc0135761
    v_mfma_f32_16x16x32_bf16 v[60:63], v[188:191], a[236:239], v[60:63]
    ds_read_b64_tr_b16 v[184:185], v210 offset:26624
    ds_read_b64_tr_b16 v[186:187], v210 offset:26880
    v_mfma_f32_16x16x32_bf16 v[52:55], v[188:191], a[164:167], v[52:55]
    buffer_load_dwordx4 v228, s[80:83], s96 offen lds
    v_fmaak_f32 v203, v218, v203, 0xc0135761
    v_mfma_f32_16x16x32_bf16 v[44:47], v[188:191], a[92:95], v[44:47]
    s_mul_i32 m0, s89, 0x2400
    s_add_u32 m0, m0, s97
    s_add_u32 m0, m0, 81920
    v_mfma_f32_16x16x32_bf16 v[36:39], v[188:191], a[20:23], v[36:39]
    s_waitcnt lgkmcnt(10)
    v_fmaak_f32 v204, v218, v204, 0xc0135761
    v_fmaak_f32 v205, v218, v205, 0xc0135761
    v_mfma_f32_16x16x32_bf16 v[0:3], v[160:163], a[24:27], v[0:3]
    ds_read_b64_tr_b16 v[188:189], v210 offset:38912
    ds_read_b64_tr_b16 v[190:191], v210 offset:39168
    v_mfma_f32_16x16x32_bf16 v[8:11], v[160:163], a[96:99], v[8:11]
    v_fmaak_f32 v206, v218, v206, 0xc0135761
    v_fmaak_f32 v207, v218, v207, 0xc0135761
    v_mfma_f32_16x16x32_bf16 v[16:19], v[160:163], a[168:171], v[16:19]
    v_mul_f32 v200, v200, v72
    v_mul_f32 v201, v201, v73
    v_mfma_f32_16x16x32_bf16 v[24:27], v[160:163], a[240:243], v[24:27]
    v_mul_f32 v202, v202, v74
    v_mul_f32 v203, v203, v75
    v_mfma_f32_16x16x32_bf16 v[28:31], v[164:167], a[240:243], v[28:31]
    ds_read_b64_tr_b16 v[160:161], v209 offset:28672
    ds_read_b64_tr_b16 v[162:163], v209 offset:28928
    v_mfma_f32_16x16x32_bf16 v[20:23], v[164:167], a[168:171], v[20:23]
    buffer_load_dwordx4 v229, s[80:83], s96 offen lds
    v_mul_f32 v204, v204, v104
    v_mfma_f32_16x16x32_bf16 v[12:15], v[164:167], a[96:99], v[12:15]
    s_add_u32 m0, s97, 93184
    v_mul_f32 v205, v205, v105
    v_mul_f32 v206, v206, v106
    v_mfma_f32_16x16x32_bf16 v[4:7], v[164:167], a[24:27], v[4:7]
    s_waitcnt lgkmcnt(10)
    v_mul_f32 v207, v207, v107
    v_mfma_f32_16x16x32_bf16 v[32:35], v[168:171], a[24:27], v[32:35]
    ds_read_b64_tr_b16 v[164:165], v209 offset:40960
    ds_read_b64_tr_b16 v[166:167], v209 offset:41216
    v_mfma_f32_16x16x32_bf16 v[40:43], v[168:171], a[96:99], v[40:43]
    buffer_load_dwordx4 v230, s[80:83], s96 offen lds
    v_exp_f32 v200, v200
    v_exp_f32 v201, v201
    v_mfma_f32_16x16x32_bf16 v[48:51], v[168:171], a[168:171], v[48:51]
    s_add_u32 m0, s97, 95232
    v_exp_f32 v202, v202
    v_mfma_f32_16x16x32_bf16 v[56:59], v[168:171], a[240:243], v[56:59]
    v_exp_f32 v203, v203
    v_mfma_f32_16x16x32_bf16 v[60:63], v[172:175], a[240:243], v[60:63]
    ds_read_b64_tr_b16 v[168:169], v210 offset:28672
    ds_read_b64_tr_b16 v[170:171], v210 offset:28928
    v_mfma_f32_16x16x32_bf16 v[52:55], v[172:175], a[168:171], v[52:55]
    v_exp_f32 v204, v204
    v_mfma_f32_16x16x32_bf16 v[44:47], v[172:175], a[96:99], v[44:47]
    v_exp_f32 v205, v205
    v_mfma_f32_16x16x32_bf16 v[36:39], v[172:175], a[24:27], v[36:39]
    s_waitcnt lgkmcnt(10)
    v_exp_f32 v206, v206
    s_waitcnt vmcnt(18)
    s_barrier
    v_mfma_f32_16x16x32_bf16 v[0:3], v[176:179], a[28:31], v[0:3]
    ds_read_b64_tr_b16 v[172:173], v210 offset:40960
    ds_read_b64_tr_b16 v[174:175], v210 offset:41216
    v_mfma_f32_16x16x32_bf16 v[8:11], v[176:179], a[100:103], v[8:11]
    buffer_load_dwordx4 v231, s[80:83], s96 offen lds
    v_mfma_f32_16x16x32_bf16 v[16:19], v[176:179], a[172:175], v[16:19]
    s_add_u32 m0, s97, 97280
    v_exp_f32 v207, v207
    v_mfma_f32_16x16x32_bf16 v[24:27], v[176:179], a[244:247], v[24:27]
    v_add_f32 v200, 1.0, v200
    v_add_f32 v201, 1.0, v201
    v_mfma_f32_16x16x32_bf16 v[28:31], v[180:183], a[244:247], v[28:31]
    ds_read_b64_tr_b16 v[176:177], v209 offset:30720
    ds_read_b64_tr_b16 v[178:179], v209 offset:30976
    v_mfma_f32_16x16x32_bf16 v[20:23], v[180:183], a[172:175], v[20:23]
    v_add_f32 v202, 1.0, v202
    v_add_f32 v203, 1.0, v203
    v_mfma_f32_16x16x32_bf16 v[12:15], v[180:183], a[100:103], v[12:15]
    v_add_f32 v204, 1.0, v204
    v_add_f32 v205, 1.0, v205
    v_mfma_f32_16x16x32_bf16 v[4:7], v[180:183], a[28:31], v[4:7]
    s_waitcnt lgkmcnt(10)
    v_add_f32 v206, 1.0, v206
    v_add_f32 v207, 1.0, v207
    v_mfma_f32_16x16x32_bf16 v[32:35], v[184:187], a[28:31], v[32:35]
    ds_read_b64_tr_b16 v[180:181], v209 offset:43008
    ds_read_b64_tr_b16 v[182:183], v209 offset:43264
    v_mfma_f32_16x16x32_bf16 v[40:43], v[184:187], a[100:103], v[40:43]
    buffer_load_dwordx4 v232, s[80:83], s96 offen lds
    v_mfma_f32_16x16x32_bf16 v[48:51], v[184:187], a[172:175], v[48:51]
    s_add_u32 m0, s97, 99328
    v_rcp_f32 v200, v200
    v_mfma_f32_16x16x32_bf16 v[56:59], v[184:187], a[244:247], v[56:59]
    v_rcp_f32 v201, v201
    v_mfma_f32_16x16x32_bf16 v[60:63], v[188:191], a[244:247], v[60:63]
    ds_read_b64_tr_b16 v[184:185], v210 offset:30720
    ds_read_b64_tr_b16 v[186:187], v210 offset:30976
    v_mfma_f32_16x16x32_bf16 v[52:55], v[188:191], a[172:175], v[52:55]
    buffer_load_dwordx4 v233, s[80:83], s96 offen lds
    s_add_u32 s96, s96, 73728
    v_mfma_f32_16x16x32_bf16 v[44:47], v[188:191], a[100:103], v[44:47]
    v_rcp_f32 v202, v202
    v_mfma_f32_16x16x32_bf16 v[36:39], v[188:191], a[28:31], v[36:39]
    s_waitcnt lgkmcnt(10)
    v_rcp_f32 v203, v203
    v_mfma_f32_16x16x32_bf16 v[0:3], v[160:163], a[32:35], v[0:3]
    ds_read_b64_tr_b16 v[188:189], v210 offset:43008
    ds_read_b64_tr_b16 v[190:191], v210 offset:43264
    v_mfma_f32_16x16x32_bf16 v[8:11], v[160:163], a[104:107], v[8:11]
    v_rcp_f32 v204, v204
    v_mfma_f32_16x16x32_bf16 v[16:19], v[160:163], a[176:179], v[16:19]
    v_rcp_f32 v205, v205
    v_mfma_f32_16x16x32_bf16 v[24:27], v[160:163], a[248:251], v[24:27]
    v_rcp_f32 v206, v206
    v_mfma_f32_16x16x32_bf16 v[28:31], v[164:167], a[248:251], v[28:31]
    ds_read_b64_tr_b16 v[160:161], v209 offset:32768
    ds_read_b64_tr_b16 v[162:163], v209 offset:33024
    v_mfma_f32_16x16x32_bf16 v[20:23], v[164:167], a[176:179], v[20:23]
    v_rcp_f32 v207, v207
    v_mfma_f32_16x16x32_bf16 v[12:15], v[164:167], a[104:107], v[12:15]
    v_mul_f32 v76, v76, v200
    v_mul_f32 v77, v77, v201
    v_mfma_f32_16x16x32_bf16 v[4:7], v[164:167], a[32:35], v[4:7]
    s_waitcnt lgkmcnt(10)
    v_mul_f32 v78, v78, v202
    v_mul_f32 v79, v79, v203
    v_mfma_f32_16x16x32_bf16 v[32:35], v[168:171], a[32:35], v[32:35]
    ds_read_b64_tr_b16 v[164:165], v209 offset:45056
    ds_read_b64_tr_b16 v[166:167], v209 offset:45312
    v_mfma_f32_16x16x32_bf16 v[40:43], v[168:171], a[104:107], v[40:43]
    v_mul_f32 v108, v108, v204
    v_mul_f32 v109, v109, v205
    v_mfma_f32_16x16x32_bf16 v[48:51], v[168:171], a[176:179], v[48:51]
    v_mul_f32 v110, v110, v206
    v_mul_f32 v111, v111, v207
    v_mfma_f32_16x16x32_bf16 v[56:59], v[168:171], a[248:251], v[56:59]
    v_cvt_pk_bf16_f32 v200, v76, v77
    v_cvt_pk_bf16_f32 v201, v78, v79
    v_mfma_f32_16x16x32_bf16 v[60:63], v[172:175], a[248:251], v[60:63]
    ds_read_b64_tr_b16 v[168:169], v210 offset:32768
    ds_read_b64_tr_b16 v[170:171], v210 offset:33024
    v_mfma_f32_16x16x32_bf16 v[52:55], v[172:175], a[176:179], v[52:55]
    v_cvt_pk_bf16_f32 v202, v108, v109
    v_cvt_pk_bf16_f32 v203, v110, v111
    v_mfma_f32_16x16x32_bf16 v[44:47], v[172:175], a[104:107], v[44:47]
    buffer_store_dwordx4 v[200:203], v216, s[24:27], s48 offen sc0 sc1
    v_mul_f32 v192, v80, v80
    v_mfma_f32_16x16x32_bf16 v[36:39], v[172:175], a[32:35], v[36:39]
    s_waitcnt lgkmcnt(10)
    v_mul_f32 v193, v81, v81
    v_mul_f32 v194, v82, v82
    v_mfma_f32_16x16x32_bf16 v[0:3], v[176:179], a[36:39], v[0:3]
    ds_read_b64_tr_b16 v[172:173], v210 offset:45056
    ds_read_b64_tr_b16 v[174:175], v210 offset:45312
    v_mfma_f32_16x16x32_bf16 v[8:11], v[176:179], a[108:111], v[8:11]
    v_mul_f32 v195, v83, v83
    v_mul_f32 v196, v112, v112
    v_mfma_f32_16x16x32_bf16 v[16:19], v[176:179], a[180:183], v[16:19]
    v_mul_f32 v197, v113, v113
    v_mul_f32 v198, v114, v114
    v_mfma_f32_16x16x32_bf16 v[24:27], v[176:179], a[252:255], v[24:27]
    v_mul_f32 v199, v115, v115
    v_mul_f32 v84, v80, v84
    v_mfma_f32_16x16x32_bf16 v[28:31], v[180:183], a[252:255], v[28:31]
    ds_read_b64_tr_b16 v[176:177], v209 offset:34816
    ds_read_b64_tr_b16 v[178:179], v209 offset:35072
    v_mfma_f32_16x16x32_bf16 v[20:23], v[180:183], a[180:183], v[20:23]
    v_mul_f32 v85, v81, v85
    v_mul_f32 v86, v82, v86
    v_mfma_f32_16x16x32_bf16 v[12:15], v[180:183], a[108:111], v[12:15]
    v_mul_f32 v87, v83, v87
    v_mul_f32 v116, v112, v116
    v_mfma_f32_16x16x32_bf16 v[4:7], v[180:183], a[36:39], v[4:7]
    s_waitcnt lgkmcnt(10)
    v_mul_f32 v117, v113, v117
    v_mul_f32 v118, v114, v118
    v_mfma_f32_16x16x32_bf16 v[32:35], v[184:187], a[36:39], v[32:35]
    ds_read_b64_tr_b16 v[180:181], v209 offset:47104
    ds_read_b64_tr_b16 v[182:183], v209 offset:47360
    v_mfma_f32_16x16x32_bf16 v[40:43], v[184:187], a[108:111], v[40:43]
    v_mul_f32 v119, v115, v119
    v_fmaak_f32 v192, v218, v192, 0xc0135761
    v_mfma_f32_16x16x32_bf16 v[48:51], v[184:187], a[180:183], v[48:51]
    v_fmaak_f32 v193, v218, v193, 0xc0135761
    v_fmaak_f32 v194, v218, v194, 0xc0135761
    v_mfma_f32_16x16x32_bf16 v[56:59], v[184:187], a[252:255], v[56:59]
    v_fmaak_f32 v195, v218, v195, 0xc0135761
    v_fmaak_f32 v196, v218, v196, 0xc0135761
    v_mfma_f32_16x16x32_bf16 v[60:63], v[188:191], a[252:255], v[60:63]
    ds_read_b64_tr_b16 v[184:185], v210 offset:34816
    ds_read_b64_tr_b16 v[186:187], v210 offset:35072
    v_mfma_f32_16x16x32_bf16 v[52:55], v[188:191], a[180:183], v[52:55]
    v_fmaak_f32 v197, v218, v197, 0xc0135761
    v_fmaak_f32 v198, v218, v198, 0xc0135761
    v_mfma_f32_16x16x32_bf16 v[44:47], v[188:191], a[108:111], v[44:47]
    v_fmaak_f32 v199, v218, v199, 0xc0135761
    v_mul_f32 v192, v192, v80
    v_mfma_f32_16x16x32_bf16 v[36:39], v[188:191], a[36:39], v[36:39]
    s_waitcnt lgkmcnt(10)
    v_mul_f32 v193, v193, v81
    v_mul_f32 v194, v194, v82
    v_mfma_f32_16x16x32_bf16 v[0:3], v[160:163], a[40:43], v[0:3]
    ds_read_b64_tr_b16 v[188:189], v210 offset:47104
    ds_read_b64_tr_b16 v[190:191], v210 offset:47360
    v_mfma_f32_16x16x32_bf16 v[8:11], v[160:163], a[112:115], v[8:11]
    v_mul_f32 v195, v195, v83
    v_mul_f32 v196, v196, v112
    v_mfma_f32_16x16x32_bf16 v[16:19], v[160:163], a[184:187], v[16:19]
    v_mul_f32 v197, v197, v113
    v_mul_f32 v198, v198, v114
    v_mfma_f32_16x16x32_bf16 v[24:27], v[160:163], v[128:131], v[24:27]
    v_mul_f32 v199, v199, v115
    v_mfma_f32_16x16x32_bf16 v[28:31], v[164:167], v[128:131], v[28:31]
    ds_read_b64_tr_b16 v[160:161], v211 offset:0
    ds_read_b64_tr_b16 v[162:163], v211 offset:256
    v_mfma_f32_16x16x32_bf16 v[20:23], v[164:167], a[184:187], v[20:23]
    v_exp_f32 v192, v192
    v_mfma_f32_16x16x32_bf16 v[12:15], v[164:167], a[112:115], v[12:15]
    v_exp_f32 v193, v193
    v_mfma_f32_16x16x32_bf16 v[4:7], v[164:167], a[40:43], v[4:7]
    s_waitcnt lgkmcnt(10)
    v_exp_f32 v194, v194
    v_mfma_f32_16x16x32_bf16 v[32:35], v[168:171], a[40:43], v[32:35]
    ds_read_b64_tr_b16 v[164:165], v211 offset:12288
    ds_read_b64_tr_b16 v[166:167], v211 offset:12544
    v_mfma_f32_16x16x32_bf16 v[40:43], v[168:171], a[112:115], v[40:43]
    v_exp_f32 v195, v195
    v_mfma_f32_16x16x32_bf16 v[48:51], v[168:171], a[184:187], v[48:51]
    v_exp_f32 v196, v196
    v_mfma_f32_16x16x32_bf16 v[56:59], v[168:171], v[128:131], v[56:59]
    v_exp_f32 v197, v197
    v_mfma_f32_16x16x32_bf16 v[60:63], v[172:175], v[128:131], v[60:63]
    ds_read_b64_tr_b16 v[168:169], v212 offset:0
    ds_read_b64_tr_b16 v[170:171], v212 offset:256
    v_mfma_f32_16x16x32_bf16 v[52:55], v[172:175], a[184:187], v[52:55]
    v_exp_f32 v198, v198
    v_mfma_f32_16x16x32_bf16 v[44:47], v[172:175], a[112:115], v[44:47]
    v_exp_f32 v199, v199
    v_mfma_f32_16x16x32_bf16 v[36:39], v[172:175], a[40:43], v[36:39]
    s_waitcnt lgkmcnt(10)
    v_add_f32 v192, 1.0, v192
    v_add_f32 v193, 1.0, v193
    v_mfma_f32_16x16x32_bf16 v[0:3], v[176:179], a[44:47], v[0:3]
    ds_read_b64_tr_b16 v[172:173], v212 offset:12288
    ds_read_b64_tr_b16 v[174:175], v212 offset:12544
    v_mfma_f32_16x16x32_bf16 v[8:11], v[176:179], a[116:119], v[8:11]
    s_getpc_b64 s[72:73]
CT3:
    s_add_u32 s72, s72, K3_entry-CT3
    s_addc_u32 s73, s73, 0
    v_mfma_f32_16x16x32_bf16 v[16:19], v[176:179], a[188:191], v[16:19]
    s_mov_b32 s74, K3_end-K3_entry
    s_mov_b32 s75, 0x00020000
    v_lshlrev_b32 v242, 7, v208
    v_mfma_f32_16x16x32_bf16 v[24:27], v[176:179], v[132:135], v[24:27]
    v_lshl_add_u32 v242, s36, 13, v242
    v_mfma_f32_16x16x32_bf16 v[28:31], v[180:183], v[132:135], v[28:31]
    ds_read_b64_tr_b16 v[176:177], v211 offset:2048
    ds_read_b64_tr_b16 v[178:179], v211 offset:2304
    v_mfma_f32_16x16x32_bf16 v[20:23], v[180:183], a[188:191], v[20:23]
    buffer_load_dword v224, v242, s[72:75], 0 offen
    v_add_f32 v194, 1.0, v194
    v_mfma_f32_16x16x32_bf16 v[12:15], v[180:183], a[116:119], v[12:15]
    v_add_f32 v195, 1.0, v195
    v_add_f32 v196, 1.0, v196
    v_mfma_f32_16x16x32_bf16 v[4:7], v[180:183], a[44:47], v[4:7]
    s_waitcnt lgkmcnt(10)
    v_add_f32 v197, 1.0, v197
    v_add_f32 v198, 1.0, v198
    v_mfma_f32_16x16x32_bf16 v[32:35], v[184:187], a[44:47], v[32:35]
    ds_read_b64_tr_b16 v[180:181], v211 offset:14336
    ds_read_b64_tr_b16 v[182:183], v211 offset:14592
    v_mfma_f32_16x16x32_bf16 v[40:43], v[184:187], a[116:119], v[40:43]
    v_add_f32 v199, 1.0, v199
    v_mfma_f32_16x16x32_bf16 v[48:51], v[184:187], a[188:191], v[48:51]
    v_rcp_f32 v192, v192
    v_mfma_f32_16x16x32_bf16 v[56:59], v[184:187], v[132:135], v[56:59]
    v_rcp_f32 v193, v193
    v_mfma_f32_16x16x32_bf16 v[60:63], v[188:191], v[132:135], v[60:63]
    ds_read_b64_tr_b16 v[184:185], v212 offset:2048
    ds_read_b64_tr_b16 v[186:187], v212 offset:2304
    v_mfma_f32_16x16x32_bf16 v[52:55], v[188:191], a[188:191], v[52:55]
    v_rcp_f32 v194, v194
    v_mfma_f32_16x16x32_bf16 v[44:47], v[188:191], a[116:119], v[44:47]
    v_rcp_f32 v195, v195
    v_mfma_f32_16x16x32_bf16 v[36:39], v[188:191], a[44:47], v[36:39]
    s_waitcnt lgkmcnt(10)
    v_rcp_f32 v196, v196
    v_mfma_f32_16x16x32_bf16 v[0:3], v[160:163], a[48:51], v[0:3]
    ds_read_b64_tr_b16 v[188:189], v212 offset:14336
    ds_read_b64_tr_b16 v[190:191], v212 offset:14592
    v_mfma_f32_16x16x32_bf16 v[8:11], v[160:163], a[120:123], v[8:11]
    v_rcp_f32 v197, v197
    v_mfma_f32_16x16x32_bf16 v[16:19], v[160:163], a[192:195], v[16:19]
    v_rcp_f32 v198, v198
    v_mfma_f32_16x16x32_bf16 v[24:27], v[160:163], v[136:139], v[24:27]
    v_rcp_f32 v199, v199
    v_mfma_f32_16x16x32_bf16 v[28:31], v[164:167], v[136:139], v[28:31]
    ds_read_b64_tr_b16 v[160:161], v211 offset:4096
    ds_read_b64_tr_b16 v[162:163], v211 offset:4352
    v_mfma_f32_16x16x32_bf16 v[20:23], v[164:167], a[192:195], v[20:23]
    v_mul_f32 v84, v84, v192
    v_mul_f32 v85, v85, v193
    v_mfma_f32_16x16x32_bf16 v[12:15], v[164:167], a[120:123], v[12:15]
    v_mul_f32 v86, v86, v194
    v_mul_f32 v87, v87, v195
    v_mfma_f32_16x16x32_bf16 v[4:7], v[164:167], a[48:51], v[4:7]
    s_waitcnt lgkmcnt(10)
    v_mul_f32 v116, v116, v196
    v_mul_f32 v117, v117, v197
    v_mfma_f32_16x16x32_bf16 v[32:35], v[168:171], a[48:51], v[32:35]
    ds_read_b64_tr_b16 v[164:165], v211 offset:16384
    ds_read_b64_tr_b16 v[166:167], v211 offset:16640
    v_mfma_f32_16x16x32_bf16 v[40:43], v[168:171], a[120:123], v[40:43]
    s_and_b32 s72, s2, 1
    s_lshl_b32 s72, s72, 3
    v_mfma_f32_16x16x32_bf16 v[48:51], v[168:171], a[192:195], v[48:51]
    s_lshr_b32 s73, s2, 5
    s_add_u32 s72, s72, s73
    v_mfma_f32_16x16x32_bf16 v[56:59], v[168:171], v[136:139], v[56:59]
    s_lshl_b32 s72, s72, 1
    s_add_u32 s72, s72, s64
    v_mfma_f32_16x16x32_bf16 v[60:63], v[172:175], v[136:139], v[60:63]
    ds_read_b64_tr_b16 v[168:169], v212 offset:4096
    ds_read_b64_tr_b16 v[170:171], v212 offset:4352
    v_mfma_f32_16x16x32_bf16 v[52:55], v[172:175], a[192:195], v[52:55]
    s_and_b32 s73, s2, 6
    s_lshr_b32 s88, s36, 1
    v_mfma_f32_16x16x32_bf16 v[44:47], v[172:175], a[120:123], v[44:47]
    s_add_u32 s73, s73, s88
    s_lshl_b32 s72, s72, 3
    v_mfma_f32_16x16x32_bf16 v[36:39], v[172:175], a[48:51], v[36:39]
    s_waitcnt lgkmcnt(10)
    s_add_u32 s88, s72, s73
    s_lshl_b32 s88, s88, 7
    s_waitcnt vmcnt(12)
    s_barrier
    v_mfma_f32_16x16x32_bf16 v[0:3], v[176:179], a[52:55], v[0:3]
    s_add_u32 m0, s97, 0
    ds_read_b64_tr_b16 v[172:173], v212 offset:16384
    ds_read_b64_tr_b16 v[174:175], v212 offset:16640
    v_mfma_f32_16x16x32_bf16 v[8:11], v[176:179], a[124:127], v[8:11]
    buffer_load_dwordx4 v225, s[80:83], s96 offen lds
    v_min_u32 v253, 96, v253
    v_mfma_f32_16x16x32_bf16 v[16:19], v[176:179], a[196:199], v[16:19]
    s_add_u32 m0, s97, 2048
    buffer_load_dword v254, v253, s[92:95], s88 offen sc1
    v_mul_f32 v118, v118, v198
    v_mfma_f32_16x16x32_bf16 v[24:27], v[176:179], v[140:143], v[24:27]
H1_S8_0:
    s_cbranch_execz H1_ret
    buffer_load_dwordx4 v226, s[80:83], s96 offen lds
    v_mul_f32 v119, v119, v199
    v_mfma_f32_16x16x32_bf16 v[28:31], v[180:183], v[140:143], v[28:31]
    s_add_u32 m0, s97, 4096
    ds_read_b64_tr_b16 v[176:177], v211 offset:6144
    ds_read_b64_tr_b16 v[178:179], v211 offset:6400
    v_mfma_f32_16x16x32_bf16 v[20:23], v[180:183], a[196:199], v[20:23]
    v_cvt_pk_bf16_f32 v192, v84, v85
    v_cvt_pk_bf16_f32 v193, v86, v87
    v_mfma_f32_16x16x32_bf16 v[12:15], v[180:183], a[124:127], v[12:15]
    v_cvt_pk_bf16_f32 v194, v116, v117
    v_cvt_pk_bf16_f32 v195, v118, v119
    v_mfma_f32_16x16x32_bf16 v[4:7], v[180:183], a[52:55], v[4:7]
    s_waitcnt lgkmcnt(10)
    buffer_store_dwordx4 v[192:195], v222, s[24:27], s49 offen sc0 sc1
    v_mul_f32 v200, v88, v88
    v_mfma_f32_16x16x32_bf16 v[32:35], v[184:187], a[52:55], v[32:35]
    ds_read_b64_tr_b16 v[180:181], v211 offset:18432
    ds_read_b64_tr_b16 v[182:183], v211 offset:18688
    v_mfma_f32_16x16x32_bf16 v[40:43], v[184:187], a[124:127], v[40:43]
    buffer_load_dwordx4 v227, s[80:83], s96 offen lds
    v_mul_f32 v201, v89, v89
    v_mfma_f32_16x16x32_bf16 v[48:51], v[184:187], a[196:199], v[48:51]
    s_add_u32 m0, s97, 6144
    v_mul_f32 v202, v90, v90
    v_mul_f32 v203, v91, v91
    v_mfma_f32_16x16x32_bf16 v[56:59], v[184:187], v[140:143], v[56:59]
    v_mul_f32 v204, v120, v120
    v_mul_f32 v205, v121, v121
    v_mfma_f32_16x16x32_bf16 v[60:63], v[188:191], v[140:143], v[60:63]
    ds_read_b64_tr_b16 v[184:185], v212 offset:6144
    ds_read_b64_tr_b16 v[186:187], v212 offset:6400
    v_mfma_f32_16x16x32_bf16 v[52:55], v[188:191], a[196:199], v[52:55]
    v_mul_f32 v206, v122, v122
    v_mul_f32 v207, v123, v123
    v_mfma_f32_16x16x32_bf16 v[44:47], v[188:191], a[124:127], v[44:47]
    buffer_store_dwordx4 v[236:239], v222, s[76:79], s3 offen offset:3072 sc0 sc1
    s_add_u32 s3, s3, 4096
    v_mfma_f32_16x16x32_bf16 v[36:39], v[188:191], a[52:55], v[36:39]
    s_waitcnt lgkmcnt(10)
    v_mul_f32 v92, v88, v92
    v_mul_f32 v93, v89, v93
    v_mfma_f32_16x16x32_bf16 v[0:3], v[160:163], a[56:59], v[0:3]
    ds_read_b64_tr_b16 v[188:189], v212 offset:18432
    ds_read_b64_tr_b16 v[190:191], v212 offset:18688
    v_mfma_f32_16x16x32_bf16 v[8:11], v[160:163], a[128:131], v[8:11]
    buffer_load_dwordx4 v228, s[80:83], s96 offen lds
    v_mul_f32 v94, v90, v94
    v_mul_f32 v95, v91, v95
    v_mfma_f32_16x16x32_bf16 v[16:19], v[160:163], a[200:203], v[16:19]
    s_mul_i32 m0, s89, 0x2400
    s_add_u32 m0, m0, s97
    s_add_u32 m0, m0, 8192
    v_mul_f32 v124, v120, v124
    v_mfma_f32_16x16x32_bf16 v[24:27], v[160:163], v[144:147], v[24:27]
    v_mul_f32 v125, v121, v125
    v_mul_f32 v126, v122, v126
    v_mfma_f32_16x16x32_bf16 v[28:31], v[164:167], v[144:147], v[28:31]
    ds_read_b64_tr_b16 v[160:161], v211 offset:8192
    ds_read_b64_tr_b16 v[162:163], v211 offset:8448
    v_mfma_f32_16x16x32_bf16 v[20:23], v[164:167], a[200:203], v[20:23]
    v_mul_f32 v127, v123, v127
    v_fmaak_f32 v200, v218, v200, 0xc0135761
    v_mfma_f32_16x16x32_bf16 v[12:15], v[164:167], a[128:131], v[12:15]
    v_fmaak_f32 v201, v218, v201, 0xc0135761
    v_fmaak_f32 v202, v218, v202, 0xc0135761
    v_mfma_f32_16x16x32_bf16 v[4:7], v[164:167], a[56:59], v[4:7]
    s_waitcnt lgkmcnt(10)
    v_fmaak_f32 v203, v218, v203, 0xc0135761
    v_fmaak_f32 v204, v218, v204, 0xc0135761
    v_mfma_f32_16x16x32_bf16 v[32:35], v[168:171], a[56:59], v[32:35]
    ds_read_b64_tr_b16 v[164:165], v211 offset:20480
    ds_read_b64_tr_b16 v[166:167], v211 offset:20736
    v_mfma_f32_16x16x32_bf16 v[40:43], v[168:171], a[128:131], v[40:43]
    buffer_load_dwordx4 v229, s[80:83], s96 offen lds
    v_fmaak_f32 v205, v218, v205, 0xc0135761
    v_mfma_f32_16x16x32_bf16 v[48:51], v[168:171], a[200:203], v[48:51]
    s_add_u32 m0, s97, 19456
    v_fmaak_f32 v206, v218, v206, 0xc0135761
    v_fmaak_f32 v207, v218, v207, 0xc0135761
    v_mfma_f32_16x16x32_bf16 v[56:59], v[168:171], v[144:147], v[56:59]
    v_mul_f32 v200, v200, v88
    v_mul_f32 v201, v201, v89
    v_mfma_f32_16x16x32_bf16 v[60:63], v[172:175], v[144:147], v[60:63]
    ds_read_b64_tr_b16 v[168:169], v212 offset:8192
    ds_read_b64_tr_b16 v[170:171], v212 offset:8448
    v_mfma_f32_16x16x32_bf16 v[52:55], v[172:175], a[200:203], v[52:55]
    buffer_load_dwordx4 v230, s[80:83], s96 offen lds
    v_mul_f32 v202, v202, v90
    v_mfma_f32_16x16x32_bf16 v[44:47], v[172:175], a[128:131], v[44:47]
    s_add_u32 m0, s97, 21504
    v_mul_f32 v203, v203, v91
    v_mul_f32 v204, v204, v120
    v_mfma_f32_16x16x32_bf16 v[36:39], v[172:175], a[56:59], v[36:39]
    s_waitcnt lgkmcnt(10)
    v_mul_f32 v205, v205, v121
    v_mul_f32 v206, v206, v122
    v_mfma_f32_16x16x32_bf16 v[0:3], v[176:179], a[60:63], v[0:3]
    ds_read_b64_tr_b16 v[172:173], v212 offset:20480
    ds_read_b64_tr_b16 v[174:175], v212 offset:20736
    v_mfma_f32_16x16x32_bf16 v[8:11], v[176:179], a[132:135], v[8:11]
    v_mul_f32 v207, v207, v123
    v_mfma_f32_16x16x32_bf16 v[16:19], v[176:179], a[204:207], v[16:19]
    v_exp_f32 v200, v200
    v_mfma_f32_16x16x32_bf16 v[24:27], v[176:179], v[148:151], v[24:27]
    v_exp_f32 v201, v201
    v_mfma_f32_16x16x32_bf16 v[28:31], v[180:183], v[148:151], v[28:31]
    ds_read_b64_tr_b16 v[176:177], v211 offset:10240
    ds_read_b64_tr_b16 v[178:179], v211 offset:10496
    v_mfma_f32_16x16x32_bf16 v[20:23], v[180:183], a[204:207], v[20:23]
    buffer_load_dwordx4 v231, s[80:83], s96 offen lds
    v_exp_f32 v202, v202
    v_mfma_f32_16x16x32_bf16 v[12:15], v[180:183], a[132:135], v[12:15]
    s_add_u32 m0, s97, 23552
    v_exp_f32 v203, v203
    v_mfma_f32_16x16x32_bf16 v[4:7], v[180:183], a[60:63], v[4:7]
    s_waitcnt lgkmcnt(10)
    v_exp_f32 v204, v204
    v_mfma_f32_16x16x32_bf16 v[32:35], v[184:187], a[60:63], v[32:35]
    ds_read_b64_tr_b16 v[180:181], v211 offset:22528
    ds_read_b64_tr_b16 v[182:183], v211 offset:22784
    v_mfma_f32_16x16x32_bf16 v[40:43], v[184:187], a[132:135], v[40:43]
    v_exp_f32 v205, v205
    v_mfma_f32_16x16x32_bf16 v[48:51], v[184:187], a[204:207], v[48:51]
    v_exp_f32 v206, v206
    v_mfma_f32_16x16x32_bf16 v[56:59], v[184:187], v[148:151], v[56:59]
    v_exp_f32 v207, v207
    v_mfma_f32_16x16x32_bf16 v[60:63], v[188:191], v[148:151], v[60:63]
    ds_read_b64_tr_b16 v[184:185], v212 offset:10240
    ds_read_b64_tr_b16 v[186:187], v212 offset:10496
    v_mfma_f32_16x16x32_bf16 v[52:55], v[188:191], a[204:207], v[52:55]
    buffer_load_dwordx4 v232, s[80:83], s96 offen lds
    v_add_f32 v200, 1.0, v200
    v_mfma_f32_16x16x32_bf16 v[44:47], v[188:191], a[132:135], v[44:47]
    s_add_u32 m0, s97, 25600
    v_add_f32 v201, 1.0, v201
    v_add_f32 v202, 1.0, v202
    v_mfma_f32_16x16x32_bf16 v[36:39], v[188:191], a[60:63], v[36:39]
    s_waitcnt lgkmcnt(10)
    v_add_f32 v203, 1.0, v203
    v_add_f32 v204, 1.0, v204
    v_mfma_f32_16x16x32_bf16 v[0:3], v[160:163], a[64:67], v[0:3]
    ds_read_b64_tr_b16 v[188:189], v212 offset:22528
    ds_read_b64_tr_b16 v[190:191], v212 offset:22784
    v_mfma_f32_16x16x32_bf16 v[8:11], v[160:163], a[136:139], v[8:11]
    buffer_load_dwordx4 v233, s[80:83], s96 offen lds
    s_add_u32 s96, s96, 73728
    v_mfma_f32_16x16x32_bf16 v[16:19], v[160:163], a[208:211], v[16:19]
    v_add_f32 v205, 1.0, v205
    v_add_f32 v206, 1.0, v206
    v_mfma_f32_16x16x32_bf16 v[24:27], v[160:163], v[152:155], v[24:27]
    v_add_f32 v207, 1.0, v207
    v_mfma_f32_16x16x32_bf16 v[28:31], v[164:167], v[152:155], v[28:31]
    ds_read_b64_tr_b16 v[160:161], v244 offset:12288
    ds_read_b64_tr_b16 v[162:163], v244 offset:12544
    v_mfma_f32_16x16x32_bf16 v[20:23], v[164:167], a[208:211], v[20:23]
    v_rcp_f32 v200, v200
    v_mfma_f32_16x16x32_bf16 v[12:15], v[164:167], a[136:139], v[12:15]
    v_rcp_f32 v201, v201
    v_mfma_f32_16x16x32_bf16 v[4:7], v[164:167], a[64:67], v[4:7]
    s_waitcnt lgkmcnt(10)
    v_rcp_f32 v202, v202
    v_mfma_f32_16x16x32_bf16 v[32:35], v[168:171], a[64:67], v[32:35]
    ds_read_b64_tr_b16 v[164:165], v245 offset:12288
    ds_read_b64_tr_b16 v[166:167], v245 offset:12544
    v_mfma_f32_16x16x32_bf16 v[40:43], v[168:171], a[136:139], v[40:43]
    buffer_store_dwordx4 v[236:239], v222, s[76:79], s3 offen offset:0 sc0 sc1
    s_add_u32 s3, s3, 28672
    v_mfma_f32_16x16x32_bf16 v[48:51], v[168:171], a[208:211], v[48:51]
    v_rcp_f32 v203, v203
    v_mfma_f32_16x16x32_bf16 v[56:59], v[168:171], v[152:155], v[56:59]
    v_rcp_f32 v204, v204
    v_mfma_f32_16x16x32_bf16 v[60:63], v[172:175], v[152:155], v[60:63]
    ds_read_b64_tr_b16 v[168:169], v244 offset:14336
    ds_read_b64_tr_b16 v[170:171], v244 offset:14592
    v_mfma_f32_16x16x32_bf16 v[52:55], v[172:175], a[208:211], v[52:55]
    v_rcp_f32 v205, v205
    v_mfma_f32_16x16x32_bf16 v[44:47], v[172:175], a[136:139], v[44:47]
    v_rcp_f32 v206, v206
    v_mfma_f32_16x16x32_bf16 v[36:39], v[172:175], a[64:67], v[36:39]
    s_waitcnt lgkmcnt(10)
    v_rcp_f32 v207, v207
    v_mfma_f32_16x16x32_bf16 v[0:3], v[176:179], a[68:71], v[0:3]
    ds_read_b64_tr_b16 v[172:173], v245 offset:14336
    ds_read_b64_tr_b16 v[174:175], v245 offset:14592
    v_mfma_f32_16x16x32_bf16 v[8:11], v[176:179], a[140:143], v[8:11]
    v_mul_f32 v92, v92, v200
    v_mul_f32 v93, v93, v201
    v_mfma_f32_16x16x32_bf16 v[16:19], v[176:179], a[212:215], v[16:19]
    v_mul_f32 v94, v94, v202
    v_mul_f32 v95, v95, v203
    v_mfma_f32_16x16x32_bf16 v[24:27], v[176:179], v[156:159], v[24:27]
    v_mul_f32 v124, v124, v204
    v_mul_f32 v125, v125, v205
    v_mfma_f32_16x16x32_bf16 v[28:31], v[180:183], v[156:159], v[28:31]
    ds_read_b64_tr_b16 v[176:177], v244 offset:16384
    ds_read_b64_tr_b16 v[178:179], v244 offset:16640
    v_mfma_f32_16x16x32_bf16 v[20:23], v[180:183], a[212:215], v[20:23]
    v_mul_f32 v126, v126, v206
    v_mul_f32 v127, v127, v207
    v_mfma_f32_16x16x32_bf16 v[12:15], v[180:183], a[140:143], v[12:15]
    v_cvt_pk_bf16_f32 v200, v92, v93
    v_cvt_pk_bf16_f32 v201, v94, v95
    v_mfma_f32_16x16x32_bf16 v[4:7], v[180:183], a[68:71], v[4:7]
    s_waitcnt lgkmcnt(10)
    v_cvt_pk_bf16_f32 v202, v124, v125
    v_cvt_pk_bf16_f32 v203, v126, v127
    v_mfma_f32_16x16x32_bf16 v[32:35], v[184:187], a[68:71], v[32:35]
    ds_read_b64_tr_b16 v[180:181], v245 offset:16384
    ds_read_b64_tr_b16 v[182:183], v245 offset:16640
    v_mfma_f32_16x16x32_bf16 v[40:43], v[184:187], a[140:143], v[40:43]
    buffer_store_dwordx4 v[200:203], v216, s[24:27], s49 offen sc0 sc1
    s_add_u32 s48, s48, s69
    v_mfma_f32_16x16x32_bf16 v[48:51], v[184:187], a[212:215], v[48:51]
    s_add_u32 s49, s49, s69
    v_mfma_f32_16x16x32_bf16 v[56:59], v[184:187], v[156:159], v[56:59]
    v_mfma_f32_16x16x32_bf16 v[60:63], v[188:191], v[156:159], v[60:63]
    ds_read_b64_tr_b16 v[184:185], v244 offset:18432
    ds_read_b64_tr_b16 v[186:187], v244 offset:18688
    v_mfma_f32_16x16x32_bf16 v[52:55], v[188:191], a[212:215], v[52:55]
    v_mfma_f32_16x16x32_bf16 v[44:47], v[188:191], a[140:143], v[44:47]
    v_mfma_f32_16x16x32_bf16 v[36:39], v[188:191], a[68:71], v[36:39]
    s_waitcnt lgkmcnt(12)
    s_add_u32 s56, s50, s41
    s_add_u32 s57, s50, s42
    s_add_u32 s58, s56, 110592
    s_add_u32 s59, s57, 110592
    s_cmp_eq_u32 s47, 3
    s_cbranch_scc1 K1_B3
    v_mfma_f32_16x16x32_bf16 v[64:67], v[160:163], a[0:3], 0
    ds_read_b64_tr_b16 v[188:189], v244 offset:20480
    ds_read_b64_tr_b16 v[190:191], v244 offset:20736
    v_mfma_f32_16x16x32_bf16 v[72:75], v[160:163], a[72:75], 0
    v_mfma_f32_16x16x32_bf16 v[80:83], v[160:163], a[144:147], 0
    v_mfma_f32_16x16x32_bf16 v[88:91], v[160:163], a[216:219], 0
    s_waitcnt lgkmcnt(10)
    s_barrier
    ds_read_b64_tr_b16 v[160:161], v244 offset:22528
    ds_read_b64_tr_b16 v[162:163], v244 offset:22784
    v_mfma_f32_16x16x32_bf16 v[64:67], v[168:171], a[4:7], v[64:67]
    ds_read_b64_tr_b16 v[164:165], v244 offset:24576
    ds_read_b64_tr_b16 v[166:167], v244 offset:24832
    v_mfma_f32_16x16x32_bf16 v[72:75], v[168:171], a[76:79], v[72:75]
    s_waitcnt vmcnt(12)
    v_cmp_gt_u32 vcc, 1, v254
    s_nop 4
    s_cbranch_vccnz C1a_spin
C1a_ret:
    v_mfma_f32_16x16x32_bf16 v[80:83], v[168:171], a[148:151], v[80:83]
    s_add_u32 s16, s10, 20971520
    s_addc_u32 s17, s11, 0
    s_mov_b32 s19, 0x00020000
    v_mfma_f32_16x16x32_bf16 v[88:91], v[168:171], a[220:223], v[88:91]
    s_waitcnt lgkmcnt(10)
    s_cmp_ge_u32 s4, 256
    s_cselect_b32 s18, 0, 18874368
    v_and_b32 v240, 31, v208
    v_mul_u32_u24 v240, 3456, v240
    v_lshrrev_b32 v241, 5, v208
    v_lshl_add_u32 v240, v241, 4, v240
    s_cmp_eq_u32 s47, 1
    s_cselect_b32 s56, s56, 1073741824
    s_cselect_b32 s58, s58, 1073741824
    v_mul_f32 v192, v0, v0
    ds_read_b64_tr_b16 v[168:169], v244 offset:26624
    ds_read_b64_tr_b16 v[170:171], v244 offset:26880
    v_mfma_f32_16x16x32_bf16 v[64:67], v[176:179], a[8:11], v[64:67]
    ds_read_b64_tr_b16 v[172:173], v244 offset:28672
    ds_read_b64_tr_b16 v[174:175], v244 offset:28928
    v_mfma_f32_16x16x32_bf16 v[72:75], v[176:179], a[80:83], v[72:75]
    buffer_load_dwordx4 a[0:3], v222, s[16:19], s98 offen offset:0 sc1
    v_mul_f32 v193, v1, v1
    v_mul_f32 v194, v2, v2
    v_mul_f32 v195, v3, v3
    v_mul_f32 v196, v32, v32
    v_mul_f32 v197, v33, v33
    v_mul_f32 v198, v34, v34
    v_mul_f32 v199, v35, v35
    v_mul_f32 v4, v0, v4
    v_mul_f32 v5, v1, v5
    v_mul_f32 v6, v2, v6
    v_mfma_f32_16x16x32_bf16 v[80:83], v[176:179], a[152:155], v[80:83]
    buffer_load_dwordx4 a[72:75], v222, s[16:19], s99 offen offset:0 sc1
    v_mul_f32 v7, v3, v7
    v_mul_f32 v36, v32, v36
    v_mul_f32 v37, v33, v37
    v_mul_f32 v38, v34, v38
    v_mul_f32 v39, v35, v39
    v_fmaak_f32 v192, v218, v192, 0xc0135761
    v_mfma_f32_16x16x32_bf16 v[88:91], v[176:179], a[224:227], v[88:91]
    s_waitcnt lgkmcnt(10)
    v_fmaak_f32 v193, v218, v193, 0xc0135761
    v_fmaak_f32 v194, v218, v194, 0xc0135761
    v_fmaak_f32 v195, v218, v195, 0xc0135761
    v_fmaak_f32 v196, v218, v196, 0xc0135761
    v_fmaak_f32 v197, v218, v197, 0xc0135761
    ds_read_b64_tr_b16 v[176:177], v244 offset:30720
    ds_read_b64_tr_b16 v[178:179], v244 offset:30976
    v_mfma_f32_16x16x32_bf16 v[64:67], v[184:187], a[12:15], v[64:67]
    ds_read_b64_tr_b16 v[180:181], v244 offset:32768
    ds_read_b64_tr_b16 v[182:183], v244 offset:33024
    v_mfma_f32_16x16x32_bf16 v[72:75], v[184:187], a[84:87], v[72:75]
    buffer_load_dwordx4 a[144:147], v222, s[16:19], s100 offen offset:0 sc1
    v_fmaak_f32 v198, v218, v198, 0xc0135761
    v_fmaak_f32 v199, v218, v199, 0xc0135761
    v_mul_f32 v192, v192, v0
    v_mul_f32 v193, v193, v1
    v_mul_f32 v194, v194, v2
    v_mul_f32 v195, v195, v3
    v_mul_f32 v196, v196, v32
    v_mul_f32 v197, v197, v33
    v_mul_f32 v198, v198, v34
    v_mul_f32 v199, v199, v35
    v_mfma_f32_16x16x32_bf16 v[80:83], v[184:187], a[156:159], v[80:83]
    buffer_load_dwordx4 a[216:219], v222, s[16:19], s101 offen offset:0 sc1
    v_exp_f32 v192, v192
    v_exp_f32 v193, v193
    v_exp_f32 v194, v194
    v_mfma_f32_16x16x32_bf16 v[88:91], v[184:187], a[228:231], v[88:91]
    s_waitcnt lgkmcnt(12)
    v_exp_f32 v195, v195
    v_exp_f32 v196, v196
    v_exp_f32 v197, v197
    v_mfma_f32_16x16x32_bf16 v[64:67], v[188:191], a[16:19], v[64:67]
    ds_read_b64_tr_b16 v[184:185], v244 offset:34816
    ds_read_b64_tr_b16 v[186:187], v244 offset:35072
    v_mfma_f32_16x16x32_bf16 v[72:75], v[188:191], a[88:91], v[72:75]
    buffer_load_dwordx4 a[4:7], v222, s[16:19], s98 offen offset:1024 sc1
    v_exp_f32 v198, v198
    v_exp_f32 v199, v199
    v_add_f32 v192, 1.0, v192
    v_add_f32 v193, 1.0, v193
    v_add_f32 v194, 1.0, v194
    v_add_f32 v195, 1.0, v195
    v_add_f32 v196, 1.0, v196
    v_mfma_f32_16x16x32_bf16 v[80:83], v[188:191], a[160:163], v[80:83]
    buffer_load_dwordx4 a[76:79], v222, s[16:19], s99 offen offset:1024 sc1
    v_add_f32 v197, 1.0, v197
    v_add_f32 v198, 1.0, v198
    v_add_f32 v199, 1.0, v199
    v_rcp_f32 v192, v192
    v_rcp_f32 v193, v193
    v_mfma_f32_16x16x32_bf16 v[88:91], v[188:191], a[232:235], v[88:91]
    s_waitcnt lgkmcnt(12)
    v_rcp_f32 v194, v194
    v_rcp_f32 v195, v195
    v_mfma_f32_16x16x32_bf16 v[64:67], v[160:163], a[20:23], v[64:67]
    ds_read_b64_tr_b16 v[188:189], v244 offset:36864
    ds_read_b64_tr_b16 v[190:191], v244 offset:37120
    v_mfma_f32_16x16x32_bf16 v[72:75], v[160:163], a[92:95], v[72:75]
    buffer_load_dwordx4 a[148:151], v222, s[16:19], s100 offen offset:1024 sc1
    v_rcp_f32 v196, v196
    v_rcp_f32 v197, v197
    v_rcp_f32 v198, v198
    v_rcp_f32 v199, v199
    v_mul_f32 v4, v4, v192
    v_mul_f32 v5, v5, v193
    v_mfma_f32_16x16x32_bf16 v[80:83], v[160:163], a[164:167], v[80:83]
    buffer_load_dwordx4 a[220:223], v222, s[16:19], s101 offen offset:1024 sc1
    v_mul_f32 v6, v6, v194
    v_mul_f32 v7, v7, v195
    v_mul_f32 v36, v36, v196
    v_mul_f32 v37, v37, v197
    v_mul_f32 v38, v38, v198
    v_mul_f32 v39, v39, v199
    v_mfma_f32_16x16x32_bf16 v[88:91], v[160:163], a[236:239], v[88:91]
    s_waitcnt lgkmcnt(12)
    v_cvt_pk_bf16_f32 v192, v4, v5
    v_cvt_pk_bf16_f32 v193, v6, v7
    v_cvt_pk_bf16_f32 v194, v36, v37
    v_cvt_pk_bf16_f32 v195, v38, v39
    v_mfma_f32_16x16x32_bf16 v[64:67], v[164:167], a[24:27], v[64:67]
    ds_read_b64_tr_b16 v[160:161], v244 offset:38912
    ds_read_b64_tr_b16 v[162:163], v244 offset:39168
    v_mfma_f32_16x16x32_bf16 v[72:75], v[164:167], a[96:99], v[72:75]
    buffer_load_dwordx4 a[8:11], v222, s[16:19], s98 offen offset:2048 sc1
    buffer_store_dwordx4 v[192:195], v222, s[24:27], s48 offen sc0 sc1
    v_mul_f32 v200, v8, v8
    v_mul_f32 v201, v9, v9
    v_mul_f32 v202, v10, v10
    v_mul_f32 v203, v11, v11
    v_mul_f32 v204, v40, v40
    v_mul_f32 v205, v41, v41
    v_mul_f32 v206, v42, v42
    v_mul_f32 v207, v43, v43
    v_mul_f32 v12, v8, v12
    v_mul_f32 v13, v9, v13
    v_mfma_f32_16x16x32_bf16 v[80:83], v[164:167], a[168:171], v[80:83]
    buffer_load_dwordx4 a[80:83], v222, s[16:19], s99 offen offset:2048 sc1
    v_mul_f32 v14, v10, v14
    v_mul_f32 v15, v11, v15
    v_mul_f32 v44, v40, v44
    v_mul_f32 v45, v41, v45
    v_mul_f32 v46, v42, v46
    v_mul_f32 v47, v43, v47
    v_mfma_f32_16x16x32_bf16 v[88:91], v[164:167], a[240:243], v[88:91]
    s_waitcnt lgkmcnt(12)
    v_fmaak_f32 v200, v218, v200, 0xc0135761
    v_fmaak_f32 v201, v218, v201, 0xc0135761
    v_fmaak_f32 v202, v218, v202, 0xc0135761
    v_fmaak_f32 v203, v218, v203, 0xc0135761
    v_fmaak_f32 v204, v218, v204, 0xc0135761
    v_mfma_f32_16x16x32_bf16 v[64:67], v[168:171], a[28:31], v[64:67]
    ds_read_b64_tr_b16 v[164:165], v244 offset:40960
    ds_read_b64_tr_b16 v[166:167], v244 offset:41216
    v_mfma_f32_16x16x32_bf16 v[72:75], v[168:171], a[100:103], v[72:75]
    buffer_load_dwordx4 a[152:155], v222, s[16:19], s100 offen offset:2048 sc1
    v_fmaak_f32 v205, v218, v205, 0xc0135761
    v_fmaak_f32 v206, v218, v206, 0xc0135761
    v_fmaak_f32 v207, v218, v207, 0xc0135761
    v_mul_f32 v200, v200, v8
    v_mul_f32 v201, v201, v9
    v_mul_f32 v202, v202, v10
    v_mul_f32 v203, v203, v11
    v_mul_f32 v204, v204, v40
    v_mul_f32 v205, v205, v41
    v_mul_f32 v206, v206, v42
    v_mfma_f32_16x16x32_bf16 v[80:83], v[168:171], a[172:175], v[80:83]
    buffer_load_dwordx4 a[224:227], v222, s[16:19], s101 offen offset:2048 sc1
    v_mul_f32 v207, v207, v43
    v_exp_f32 v200, v200
    v_exp_f32 v201, v201
    v_exp_f32 v202, v202
    v_mfma_f32_16x16x32_bf16 v[88:91], v[168:171], a[244:247], v[88:91]
    s_waitcnt lgkmcnt(12)
    v_exp_f32 v203, v203
    v_exp_f32 v204, v204
    v_mfma_f32_16x16x32_bf16 v[64:67], v[172:175], a[32:35], v[64:67]
    ds_read_b64_tr_b16 v[168:169], v244 offset:43008
    ds_read_b64_tr_b16 v[170:171], v244 offset:43264
    v_mfma_f32_16x16x32_bf16 v[72:75], v[172:175], a[104:107], v[72:75]
    buffer_load_dwordx4 a[12:15], v222, s[16:19], s98 offen offset:3072 sc1
    s_add_u32 s98, s98, 4096
    v_exp_f32 v205, v205
    v_exp_f32 v206, v206
    v_exp_f32 v207, v207
    v_add_f32 v200, 1.0, v200
    v_add_f32 v201, 1.0, v201
    v_add_f32 v202, 1.0, v202
    v_add_f32 v203, 1.0, v203
    v_mfma_f32_16x16x32_bf16 v[80:83], v[172:175], a[176:179], v[80:83]
    buffer_load_dwordx4 a[84:87], v222, s[16:19], s99 offen offset:3072 sc1
    s_add_u32 s99, s99, 4096
    v_add_f32 v204, 1.0, v204
    v_add_f32 v205, 1.0, v205
    v_add_f32 v206, 1.0, v206
    v_add_f32 v207, 1.0, v207
    v_rcp_f32 v200, v200
    v_mfma_f32_16x16x32_bf16 v[88:91], v[172:175], a[248:251], v[88:91]
    s_waitcnt lgkmcnt(12)
    v_rcp_f32 v201, v201
    v_rcp_f32 v202, v202
    v_rcp_f32 v203, v203
    v_mfma_f32_16x16x32_bf16 v[64:67], v[176:179], a[36:39], v[64:67]
    ds_read_b64_tr_b16 v[172:173], v244 offset:45056
    ds_read_b64_tr_b16 v[174:175], v244 offset:45312
    v_mfma_f32_16x16x32_bf16 v[72:75], v[176:179], a[108:111], v[72:75]
    buffer_load_dwordx4 a[156:159], v222, s[16:19], s100 offen offset:3072 sc1
    s_add_u32 s100, s100, 4096
    v_rcp_f32 v204, v204
    v_rcp_f32 v205, v205
    v_rcp_f32 v206, v206
    v_rcp_f32 v207, v207
    v_mul_f32 v12, v12, v200
    v_mfma_f32_16x16x32_bf16 v[80:83], v[176:179], a[180:183], v[80:83]
    buffer_load_dwordx4 a[228:231], v222, s[16:19], s101 offen offset:3072 sc1
    s_add_u32 s101, s101, 4096
    v_mul_f32 v13, v13, v201
    v_mul_f32 v14, v14, v202
    v_mul_f32 v15, v15, v203
    v_mul_f32 v44, v44, v204
    v_mul_f32 v45, v45, v205
    v_mfma_f32_16x16x32_bf16 v[88:91], v[176:179], a[252:255], v[88:91]
    s_waitcnt lgkmcnt(12)
    v_mul_f32 v46, v46, v206
    v_mul_f32 v47, v47, v207
    v_cvt_pk_bf16_f32 v200, v12, v13
    v_cvt_pk_bf16_f32 v201, v14, v15
    v_cvt_pk_bf16_f32 v202, v44, v45
    v_cvt_pk_bf16_f32 v203, v46, v47
    v_mfma_f32_16x16x32_bf16 v[64:67], v[180:183], a[40:43], v[64:67]
    ds_read_b64_tr_b16 v[176:177], v244 offset:47104
    ds_read_b64_tr_b16 v[178:179], v244 offset:47360
    v_mfma_f32_16x16x32_bf16 v[72:75], v[180:183], a[112:115], v[72:75]
    buffer_store_dwordx4 v[200:203], v216, s[24:27], s48 offen sc0 sc1
    v_mul_f32 v192, v16, v16
    v_mul_f32 v193, v17, v17
    v_mul_f32 v194, v18, v18
    v_mul_f32 v195, v19, v19
    v_mul_f32 v196, v48, v48
    v_mul_f32 v197, v49, v49
    v_mul_f32 v198, v50, v50
    v_mul_f32 v199, v51, v51
    v_mul_f32 v20, v16, v20
    v_mfma_f32_16x16x32_bf16 v[80:83], v[180:183], a[184:187], v[80:83]
    v_mul_f32 v21, v17, v21
    v_mul_f32 v22, v18, v22
    v_mul_f32 v23, v19, v23
    v_mul_f32 v52, v48, v52
    v_mul_f32 v53, v49, v53
    v_mfma_f32_16x16x32_bf16 v[88:91], v[180:183], v[128:131], v[88:91]
    s_waitcnt lgkmcnt(12)
    v_mul_f32 v54, v50, v54
    v_mul_f32 v55, v51, v55
    v_fmaak_f32 v192, v218, v192, 0xc0135761
    v_fmaak_f32 v193, v218, v193, 0xc0135761
    v_fmaak_f32 v194, v218, v194, 0xc0135761
    v_fmaak_f32 v195, v218, v195, 0xc0135761
    v_mfma_f32_16x16x32_bf16 v[64:67], v[184:187], a[44:47], v[64:67]
    v_fmaak_f32 v196, v218, v196, 0xc0135761
    v_fmaak_f32 v197, v218, v197, 0xc0135761
    v_mfma_f32_16x16x32_bf16 v[72:75], v[184:187], a[116:119], v[72:75]
    v_fmaak_f32 v198, v218, v198, 0xc0135761
    v_fmaak_f32 v199, v218, v199, 0xc0135761
    v_mul_f32 v192, v192, v16
    v_mul_f32 v193, v193, v17
    v_mul_f32 v194, v194, v18
    v_mul_f32 v195, v195, v19
    v_mul_f32 v196, v196, v48
    v_mul_f32 v197, v197, v49
    v_mfma_f32_16x16x32_bf16 v[80:83], v[184:187], a[188:191], v[80:83]
    v_mul_f32 v198, v198, v50
    v_mul_f32 v199, v199, v51
    v_exp_f32 v192, v192
    v_exp_f32 v193, v193
    v_mfma_f32_16x16x32_bf16 v[88:91], v[184:187], v[132:135], v[88:91]
    s_waitcnt lgkmcnt(10)
    v_exp_f32 v194, v194
    v_exp_f32 v195, v195
    v_exp_f32 v196, v196
    v_mfma_f32_16x16x32_bf16 v[64:67], v[188:191], a[48:51], v[64:67]
    v_exp_f32 v197, v197
    v_mfma_f32_16x16x32_bf16 v[72:75], v[188:191], a[120:123], v[72:75]
    v_exp_f32 v198, v198
    v_exp_f32 v199, v199
    v_add_f32 v192, 1.0, v192
    v_add_f32 v193, 1.0, v193
    v_add_f32 v194, 1.0, v194
    v_mfma_f32_16x16x32_bf16 v[80:83], v[188:191], a[192:195], v[80:83]
    v_add_f32 v195, 1.0, v195
    v_add_f32 v196, 1.0, v196
    v_add_f32 v197, 1.0, v197
    v_add_f32 v198, 1.0, v198
    v_add_f32 v199, 1.0, v199
    v_mfma_f32_16x16x32_bf16 v[88:91], v[188:191], v[136:139], v[88:91]
    s_waitcnt lgkmcnt(8)
    v_rcp_f32 v192, v192
    v_rcp_f32 v193, v193
    v_rcp_f32 v194, v194
    v_mfma_f32_16x16x32_bf16 v[64:67], v[160:163], a[52:55], v[64:67]
    v_rcp_f32 v195, v195
    v_mfma_f32_16x16x32_bf16 v[72:75], v[160:163], a[124:127], v[72:75]
    v_rcp_f32 v196, v196
    v_rcp_f32 v197, v197
    v_rcp_f32 v198, v198
    v_rcp_f32 v199, v199
    v_mfma_f32_16x16x32_bf16 v[80:83], v[160:163], a[196:199], v[80:83]
    v_mul_f32 v20, v20, v192
    s_waitcnt vmcnt(18)
    v_mov_b32 v255, 2
    v_mfma_f32_16x16x32_bf16 v[88:91], v[160:163], v[140:143], v[88:91]
    s_waitcnt lgkmcnt(6)
    s_mov_b64 exec, 1
    buffer_store_dword v255, off, s[92:95], s5 sc0 sc1
    s_mov_b64 exec, -1
    v_mul_f32 v21, v21, v193
    v_mul_f32 v22, v22, v194
    v_mul_f32 v23, v23, v195
    v_mul_f32 v52, v52, v196
    v_mul_f32 v53, v53, v197
    v_mul_f32 v54, v54, v198
    v_mul_f32 v55, v55, v199
    v_cvt_pk_bf16_f32 v192, v20, v21
    v_mfma_f32_16x16x32_bf16 v[64:67], v[164:167], a[56:59], v[64:67]
    v_cvt_pk_bf16_f32 v193, v22, v23
    v_cvt_pk_bf16_f32 v194, v52, v53
    v_mfma_f32_16x16x32_bf16 v[72:75], v[164:167], a[128:131], v[72:75]
    v_cvt_pk_bf16_f32 v195, v54, v55
    v_mfma_f32_16x16x32_bf16 v[80:83], v[164:167], a[200:203], v[80:83]
    buffer_store_dwordx4 v[192:195], v222, s[24:27], s49 offen sc0 sc1
    v_mul_f32 v200, v24, v24
    v_mul_f32 v201, v25, v25
    v_mul_f32 v202, v26, v26
    v_mul_f32 v203, v27, v27
    v_mul_f32 v204, v56, v56
    v_mul_f32 v205, v57, v57
    v_mul_f32 v206, v58, v58
    v_mul_f32 v207, v59, v59
    v_mul_f32 v28, v24, v28
    v_mul_f32 v29, v25, v29
    v_mul_f32 v30, v26, v30
    v_mfma_f32_16x16x32_bf16 v[88:91], v[164:167], v[144:147], v[88:91]
    s_waitcnt lgkmcnt(4)
    v_mul_f32 v31, v27, v31
    v_mul_f32 v60, v56, v60
    v_mul_f32 v61, v57, v61
    v_mul_f32 v62, v58, v62
    v_mul_f32 v63, v59, v63
    v_fmaak_f32 v200, v218, v200, 0xc0135761
    v_mfma_f32_16x16x32_bf16 v[64:67], v[168:171], a[60:63], v[64:67]
    v_fmaak_f32 v201, v218, v201, 0xc0135761
    v_fmaak_f32 v202, v218, v202, 0xc0135761
    v_mfma_f32_16x16x32_bf16 v[72:75], v[168:171], a[132:135], v[72:75]
    v_fmaak_f32 v203, v218, v203, 0xc0135761
    v_fmaak_f32 v204, v218, v204, 0xc0135761
    v_fmaak_f32 v205, v218, v205, 0xc0135761
    v_fmaak_f32 v206, v218, v206, 0xc0135761
    v_fmaak_f32 v207, v218, v207, 0xc0135761
    v_mul_f32 v200, v200, v24
    v_mul_f32 v201, v201, v25
    v_mul_f32 v202, v202, v26
    v_mfma_f32_16x16x32_bf16 v[80:83], v[168:171], a[204:207], v[80:83]
    v_mul_f32 v203, v203, v27
    v_mul_f32 v204, v204, v56
    v_mul_f32 v205, v205, v57
    v_mul_f32 v206, v206, v58
    v_mul_f32 v207, v207, v59
    v_mfma_f32_16x16x32_bf16 v[88:91], v[168:171], v[148:151], v[88:91]
    s_waitcnt lgkmcnt(2)
    v_exp_f32 v200, v200
    v_exp_f32 v201, v201
    v_exp_f32 v202, v202
    v_mfma_f32_16x16x32_bf16 v[64:67], v[172:175], a[64:67], v[64:67]
    v_exp_f32 v203, v203
    v_mfma_f32_16x16x32_bf16 v[72:75], v[172:175], a[136:139], v[72:75]
    v_exp_f32 v204, v204
    v_exp_f32 v205, v205
    v_exp_f32 v206, v206
    v_exp_f32 v207, v207
    v_mfma_f32_16x16x32_bf16 v[80:83], v[172:175], a[208:211], v[80:83]
    v_add_f32 v200, 1.0, v200
    v_add_f32 v201, 1.0, v201
    v_add_f32 v202, 1.0, v202
    v_add_f32 v203, 1.0, v203
    v_add_f32 v204, 1.0, v204
    v_mfma_f32_16x16x32_bf16 v[88:91], v[172:175], v[152:155], v[88:91]
    s_waitcnt lgkmcnt(0)
    v_add_f32 v205, 1.0, v205
    v_add_f32 v206, 1.0, v206
    v_add_f32 v207, 1.0, v207
    v_rcp_f32 v200, v200
    v_rcp_f32 v201, v201
    v_mfma_f32_16x16x32_bf16 v[64:67], v[176:179], a[68:71], v[64:67]
    v_rcp_f32 v202, v202
    v_mfma_f32_16x16x32_bf16 v[72:75], v[176:179], a[140:143], v[72:75]
    v_rcp_f32 v203, v203
    v_rcp_f32 v204, v204
    v_rcp_f32 v205, v205
    v_rcp_f32 v206, v206
    v_mfma_f32_16x16x32_bf16 v[80:83], v[176:179], a[212:215], v[80:83]
    v_rcp_f32 v207, v207
    v_mul_f32 v28, v28, v200
    v_mul_f32 v29, v29, v201
    v_mfma_f32_16x16x32_bf16 v[88:91], v[176:179], v[156:159], v[88:91]
    v_mul_f32 v30, v30, v202
    v_mul_f32 v31, v31, v203
    v_mul_f32 v60, v60, v204
    v_mul_f32 v61, v61, v205
    v_mul_f32 v62, v62, v206
    v_mul_f32 v63, v63, v207
    v_cvt_pk_bf16_f32 v200, v28, v29
    v_cvt_pk_bf16_f32 v201, v30, v31
    v_cvt_pk_bf16_f32 v202, v60, v61
    v_cvt_pk_bf16_f32 v203, v62, v63
    buffer_store_dwordx4 v[200:203], v216, s[24:27], s49 offen sc0 sc1
    s_nop 15
    v_cvt_pk_bf16_f32 v192, v64, v65
    v_cvt_pk_bf16_f32 v193, v66, v67
    v_cvt_pk_bf16_f32 v194, v72, v73
    v_cvt_pk_bf16_f32 v195, v74, v75
    v_cvt_pk_bf16_f32 v196, v80, v81
    v_cvt_pk_bf16_f32 v197, v82, v83
    v_cvt_pk_bf16_f32 v198, v88, v89
    v_cvt_pk_bf16_f32 v199, v90, v91
    v_permlane16_swap_b32 v192, v194
    v_permlane16_swap_b32 v193, v195
    v_permlane16_swap_b32 v196, v198
    v_permlane16_swap_b32 v197, v199
    s_nop 1
    buffer_store_dwordx4 v[192:195], v240, s[28:31], s56 offen sc1
    buffer_store_dwordx4 v[196:199], v240, s[28:31], s58 offen sc1
H1_S9_0:
    s_cbranch_execz H1_ret
    s_branch K1_fuse
K1_B3:
    s_waitcnt lgkmcnt(10)
    v_mfma_f32_16x16x32_bf16 v[64:67], v[160:163], a[0:3], 0
    ds_read_b64_tr_b16 v[188:189], v245 offset:18432
    ds_read_b64_tr_b16 v[190:191], v245 offset:18688
    v_mfma_f32_16x16x32_bf16 v[72:75], v[160:163], a[72:75], 0
    v_mfma_f32_16x16x32_bf16 v[80:83], v[160:163], a[144:147], 0
    v_mfma_f32_16x16x32_bf16 v[88:91], v[160:163], a[216:219], 0
    v_mfma_f32_16x16x32_bf16 v[92:95], v[164:167], a[216:219], 0
    ds_read_b64_tr_b16 v[160:161], v244 offset:20480
    ds_read_b64_tr_b16 v[162:163], v244 offset:20736
    v_mfma_f32_16x16x32_bf16 v[84:87], v[164:167], a[144:147], 0
    v_bfe_u32 v240, v208, 3, 1
    v_mul_u32_u24 v240, 27584, v240
    v_mfma_f32_16x16x32_bf16 v[76:79], v[164:167], a[72:75], 0
    v_sub_u32 v240, v217, v240
    v_cvt_pk_bf16_f32 v192, v0, v1
    v_mfma_f32_16x16x32_bf16 v[68:71], v[164:167], a[0:3], 0
    s_waitcnt lgkmcnt(10)
    v_cvt_pk_bf16_f32 v193, v2, v3
    v_cvt_pk_bf16_f32 v194, v32, v33
    s_barrier
    v_mfma_f32_16x16x32_bf16 v[64:67], v[168:171], a[4:7], v[64:67]
    ds_read_b64_tr_b16 v[164:165], v245 offset:20480
    ds_read_b64_tr_b16 v[166:167], v245 offset:20736
    v_mfma_f32_16x16x32_bf16 v[72:75], v[168:171], a[76:79], v[72:75]
    v_cvt_pk_bf16_f32 v195, v34, v35
    v_cvt_pk_bf16_f32 v196, v4, v5
    s_waitcnt vmcnt(12)
    v_cmp_gt_u32 vcc, 1, v254
    s_nop 4
    s_cbranch_vccnz C1b_spin
C1b_ret:
    v_mfma_f32_16x16x32_bf16 v[80:83], v[168:171], a[148:151], v[80:83]
    s_add_u32 s16, s10, 20971520
    s_addc_u32 s17, s11, 0
    s_mov_b32 s19, 0x00020000
    v_mfma_f32_16x16x32_bf16 v[88:91], v[168:171], a[220:223], v[88:91]
    s_cmp_ge_u32 s4, 256
    s_cselect_b32 s18, 0, 18874368
    v_cvt_pk_bf16_f32 v197, v6, v7
    v_mfma_f32_16x16x32_bf16 v[92:95], v[172:175], a[220:223], v[92:95]
    ds_read_b64_tr_b16 v[168:169], v244 offset:22528
    ds_read_b64_tr_b16 v[170:171], v244 offset:22784
    v_mfma_f32_16x16x32_bf16 v[84:87], v[172:175], a[148:151], v[84:87]
    buffer_load_dwordx4 a[0:3], v222, s[16:19], s98 offen offset:0 sc1
    v_cvt_pk_bf16_f32 v198, v36, v37
    v_mfma_f32_16x16x32_bf16 v[76:79], v[172:175], a[76:79], v[76:79]
    buffer_load_dwordx4 a[72:75], v222, s[16:19], s99 offen offset:0 sc1
    v_cvt_pk_bf16_f32 v199, v38, v39
    s_nop 1
    v_permlane16_swap_b32 v192, v194
    v_mfma_f32_16x16x32_bf16 v[68:71], v[172:175], a[4:7], v[68:71]
    s_waitcnt lgkmcnt(10)
    v_permlane16_swap_b32 v193, v195
    v_mfma_f32_16x16x32_bf16 v[64:67], v[176:179], a[8:11], v[64:67]
    ds_read_b64_tr_b16 v[172:173], v245 offset:22528
    ds_read_b64_tr_b16 v[174:175], v245 offset:22784
    v_mfma_f32_16x16x32_bf16 v[72:75], v[176:179], a[80:83], v[72:75]
    buffer_load_dwordx4 a[144:147], v222, s[16:19], s100 offen offset:0 sc1
    v_mfma_f32_16x16x32_bf16 v[80:83], v[176:179], a[152:155], v[80:83]
    v_permlane16_swap_b32 v196, v198
    v_mfma_f32_16x16x32_bf16 v[88:91], v[176:179], a[224:227], v[88:91]
    v_permlane16_swap_b32 v197, v199
    v_mfma_f32_16x16x32_bf16 v[92:95], v[180:183], a[224:227], v[92:95]
    ds_read_b64_tr_b16 v[176:177], v244 offset:24576
    ds_read_b64_tr_b16 v[178:179], v244 offset:24832
    v_mfma_f32_16x16x32_bf16 v[84:87], v[180:183], a[152:155], v[84:87]
    buffer_load_dwordx4 a[216:219], v222, s[16:19], s101 offen offset:0 sc1
    v_mov_b32 v0, v192
    v_mfma_f32_16x16x32_bf16 v[76:79], v[180:183], a[80:83], v[76:79]
    v_mov_b32 v1, v193
    v_mov_b32 v2, v194
    v_mfma_f32_16x16x32_bf16 v[68:71], v[180:183], a[8:11], v[68:71]
    s_waitcnt lgkmcnt(10)
    v_mov_b32 v3, v195
    v_mov_b32_dpp v192, v196 row_ror:8 row_mask:0xf bank_mask:0xc
    v_mfma_f32_16x16x32_bf16 v[64:67], v[184:187], a[12:15], v[64:67]
    ds_read_b64_tr_b16 v[180:181], v245 offset:24576
    ds_read_b64_tr_b16 v[182:183], v245 offset:24832
    v_mfma_f32_16x16x32_bf16 v[72:75], v[184:187], a[84:87], v[72:75]
    buffer_load_dwordx4 a[4:7], v222, s[16:19], s98 offen offset:1024 sc1
    v_mov_b32_dpp v193, v197 row_ror:8 row_mask:0xf bank_mask:0xc
    v_mfma_f32_16x16x32_bf16 v[80:83], v[184:187], a[156:159], v[80:83]
    v_mov_b32_dpp v194, v198 row_ror:8 row_mask:0xf bank_mask:0xc
    v_mov_b32_dpp v195, v199 row_ror:8 row_mask:0xf bank_mask:0xc
    v_mfma_f32_16x16x32_bf16 v[88:91], v[184:187], a[228:231], v[88:91]
    v_mfma_f32_16x16x32_bf16 v[92:95], v[188:191], a[228:231], v[92:95]
    ds_read_b64_tr_b16 v[184:185], v244 offset:26624
    ds_read_b64_tr_b16 v[186:187], v244 offset:26880
    v_mfma_f32_16x16x32_bf16 v[84:87], v[188:191], a[156:159], v[84:87]
    buffer_load_dwordx4 a[76:79], v222, s[16:19], s99 offen offset:1024 sc1
    v_mov_b32_dpp v196, v0 row_ror:8 row_mask:0xf bank_mask:0x3
    v_mfma_f32_16x16x32_bf16 v[76:79], v[188:191], a[84:87], v[76:79]
    v_mov_b32_dpp v197, v1 row_ror:8 row_mask:0xf bank_mask:0x3
    v_mov_b32_dpp v198, v2 row_ror:8 row_mask:0xf bank_mask:0x3
    v_mfma_f32_16x16x32_bf16 v[68:71], v[188:191], a[12:15], v[68:71]
    s_waitcnt lgkmcnt(10)
    v_mov_b32_dpp v199, v3 row_ror:8 row_mask:0xf bank_mask:0x3
    v_mfma_f32_16x16x32_bf16 v[64:67], v[160:163], a[16:19], v[64:67]
    ds_read_b64_tr_b16 v[188:189], v245 offset:26624
    ds_read_b64_tr_b16 v[190:191], v245 offset:26880
    v_mfma_f32_16x16x32_bf16 v[72:75], v[160:163], a[88:91], v[72:75]
    buffer_load_dwordx4 a[148:151], v222, s[16:19], s100 offen offset:1024 sc1
    buffer_store_dwordx4 v[192:195], v240, s[28:31], s56 offen sc1
    v_mfma_f32_16x16x32_bf16 v[80:83], v[160:163], a[160:163], v[80:83]
    s_add_u32 s56, s56, 27648
    buffer_store_dwordx4 v[196:199], v240, s[28:31], s56 offen sc1
    s_add_u32 s56, s56, 27648
    v_mfma_f32_16x16x32_bf16 v[88:91], v[160:163], a[232:235], v[88:91]
    v_cvt_pk_bf16_f32 v200, v8, v9
    v_cvt_pk_bf16_f32 v201, v10, v11
    v_mfma_f32_16x16x32_bf16 v[92:95], v[164:167], a[232:235], v[92:95]
    ds_read_b64_tr_b16 v[160:161], v244 offset:28672
    ds_read_b64_tr_b16 v[162:163], v244 offset:28928
    v_mfma_f32_16x16x32_bf16 v[84:87], v[164:167], a[160:163], v[84:87]
    buffer_load_dwordx4 a[220:223], v222, s[16:19], s101 offen offset:1024 sc1
    v_cvt_pk_bf16_f32 v202, v40, v41
    v_mfma_f32_16x16x32_bf16 v[76:79], v[164:167], a[88:91], v[76:79]
    v_cvt_pk_bf16_f32 v203, v42, v43
    v_cvt_pk_bf16_f32 v204, v12, v13
    v_mfma_f32_16x16x32_bf16 v[68:71], v[164:167], a[16:19], v[68:71]
    s_waitcnt lgkmcnt(10)
    v_cvt_pk_bf16_f32 v205, v14, v15
    v_cvt_pk_bf16_f32 v206, v44, v45
    v_mfma_f32_16x16x32_bf16 v[64:67], v[168:171], a[20:23], v[64:67]
    ds_read_b64_tr_b16 v[164:165], v245 offset:28672
    ds_read_b64_tr_b16 v[166:167], v245 offset:28928
    v_mfma_f32_16x16x32_bf16 v[72:75], v[168:171], a[92:95], v[72:75]
    buffer_load_dwordx4 a[8:11], v222, s[16:19], s98 offen offset:2048 sc1
    v_cvt_pk_bf16_f32 v207, v46, v47
    s_nop 1
    v_permlane16_swap_b32 v200, v202
    v_mfma_f32_16x16x32_bf16 v[80:83], v[168:171], a[164:167], v[80:83]
    v_mfma_f32_16x16x32_bf16 v[88:91], v[168:171], a[236:239], v[88:91]
    v_permlane16_swap_b32 v201, v203
    v_mfma_f32_16x16x32_bf16 v[92:95], v[172:175], a[236:239], v[92:95]
    ds_read_b64_tr_b16 v[168:169], v244 offset:30720
    ds_read_b64_tr_b16 v[170:171], v244 offset:30976
    v_mfma_f32_16x16x32_bf16 v[84:87], v[172:175], a[164:167], v[84:87]
    buffer_load_dwordx4 a[80:83], v222, s[16:19], s99 offen offset:2048 sc1
    v_mfma_f32_16x16x32_bf16 v[76:79], v[172:175], a[92:95], v[76:79]
    v_permlane16_swap_b32 v204, v206
    v_mfma_f32_16x16x32_bf16 v[68:71], v[172:175], a[20:23], v[68:71]
    s_waitcnt lgkmcnt(10)
    v_permlane16_swap_b32 v205, v207
    v_mfma_f32_16x16x32_bf16 v[64:67], v[176:179], a[24:27], v[64:67]
    ds_read_b64_tr_b16 v[172:173], v245 offset:30720
    ds_read_b64_tr_b16 v[174:175], v245 offset:30976
    v_mfma_f32_16x16x32_bf16 v[72:75], v[176:179], a[96:99], v[72:75]
    buffer_load_dwordx4 a[152:155], v222, s[16:19], s100 offen offset:2048 sc1
    v_mov_b32 v8, v200
    v_mfma_f32_16x16x32_bf16 v[80:83], v[176:179], a[168:171], v[80:83]
    v_mov_b32 v9, v201
    v_mov_b32 v10, v202
    v_mfma_f32_16x16x32_bf16 v[88:91], v[176:179], a[240:243], v[88:91]
    v_mfma_f32_16x16x32_bf16 v[92:95], v[180:183], a[240:243], v[92:95]
    ds_read_b64_tr_b16 v[176:177], v244 offset:32768
    ds_read_b64_tr_b16 v[178:179], v244 offset:33024
    v_mfma_f32_16x16x32_bf16 v[84:87], v[180:183], a[168:171], v[84:87]
    buffer_load_dwordx4 a[224:227], v222, s[16:19], s101 offen offset:2048 sc1
    v_mov_b32 v11, v203
    v_mfma_f32_16x16x32_bf16 v[76:79], v[180:183], a[96:99], v[76:79]
    v_mov_b32_dpp v200, v204 row_ror:8 row_mask:0xf bank_mask:0xc
    v_mov_b32_dpp v201, v205 row_ror:8 row_mask:0xf bank_mask:0xc
    v_mfma_f32_16x16x32_bf16 v[68:71], v[180:183], a[24:27], v[68:71]
    s_waitcnt lgkmcnt(10)
    v_mov_b32_dpp v202, v206 row_ror:8 row_mask:0xf bank_mask:0xc
    v_mov_b32_dpp v203, v207 row_ror:8 row_mask:0xf bank_mask:0xc
    v_mfma_f32_16x16x32_bf16 v[64:67], v[184:187], a[28:31], v[64:67]
    ds_read_b64_tr_b16 v[180:181], v245 offset:32768
    ds_read_b64_tr_b16 v[182:183], v245 offset:33024
    v_mfma_f32_16x16x32_bf16 v[72:75], v[184:187], a[100:103], v[72:75]
    buffer_load_dwordx4 a[12:15], v222, s[16:19], s98 offen offset:3072 sc1
    s_add_u32 s98, s98, 4096
    v_mfma_f32_16x16x32_bf16 v[80:83], v[184:187], a[172:175], v[80:83]
    v_mov_b32_dpp v204, v8 row_ror:8 row_mask:0xf bank_mask:0x3
    v_mov_b32_dpp v205, v9 row_ror:8 row_mask:0xf bank_mask:0x3
    v_mfma_f32_16x16x32_bf16 v[88:91], v[184:187], a[244:247], v[88:91]
    v_mov_b32_dpp v206, v10 row_ror:8 row_mask:0xf bank_mask:0x3
    v_mov_b32_dpp v207, v11 row_ror:8 row_mask:0xf bank_mask:0x3
    v_mfma_f32_16x16x32_bf16 v[92:95], v[188:191], a[244:247], v[92:95]
    ds_read_b64_tr_b16 v[184:185], v244 offset:34816
    ds_read_b64_tr_b16 v[186:187], v244 offset:35072
    v_mfma_f32_16x16x32_bf16 v[84:87], v[188:191], a[172:175], v[84:87]
    buffer_load_dwordx4 a[84:87], v222, s[16:19], s99 offen offset:3072 sc1
    buffer_store_dwordx4 v[200:203], v240, s[28:31], s56 offen sc1
    v_mfma_f32_16x16x32_bf16 v[76:79], v[188:191], a[100:103], v[76:79]
    s_add_u32 s99, s99, 4096
    s_add_u32 s56, s56, 27648
    buffer_store_dwordx4 v[204:207], v240, s[28:31], s56 offen sc1
    v_mfma_f32_16x16x32_bf16 v[68:71], v[188:191], a[28:31], v[68:71]
    s_waitcnt lgkmcnt(10)
    s_add_u32 s56, s56, 27648
    v_cvt_pk_bf16_f32 v192, v16, v17
    v_mfma_f32_16x16x32_bf16 v[64:67], v[160:163], a[32:35], v[64:67]
    ds_read_b64_tr_b16 v[188:189], v245 offset:34816
    ds_read_b64_tr_b16 v[190:191], v245 offset:35072
    v_mfma_f32_16x16x32_bf16 v[72:75], v[160:163], a[104:107], v[72:75]
    buffer_load_dwordx4 a[156:159], v222, s[16:19], s100 offen offset:3072 sc1
    s_add_u32 s100, s100, 4096
    v_mfma_f32_16x16x32_bf16 v[80:83], v[160:163], a[176:179], v[80:83]
    v_cvt_pk_bf16_f32 v193, v18, v19
    v_cvt_pk_bf16_f32 v194, v48, v49
    v_mfma_f32_16x16x32_bf16 v[88:91], v[160:163], a[248:251], v[88:91]
    v_cvt_pk_bf16_f32 v195, v50, v51
    v_cvt_pk_bf16_f32 v196, v20, v21
    v_mfma_f32_16x16x32_bf16 v[92:95], v[164:167], a[248:251], v[92:95]
    ds_read_b64_tr_b16 v[160:161], v244 offset:36864
    ds_read_b64_tr_b16 v[162:163], v244 offset:37120
    v_mfma_f32_16x16x32_bf16 v[84:87], v[164:167], a[176:179], v[84:87]
    buffer_load_dwordx4 a[228:231], v222, s[16:19], s101 offen offset:3072 sc1
    s_add_u32 s101, s101, 4096
    v_mfma_f32_16x16x32_bf16 v[76:79], v[164:167], a[104:107], v[76:79]
    v_cvt_pk_bf16_f32 v197, v22, v23
    v_cvt_pk_bf16_f32 v198, v52, v53
    v_mfma_f32_16x16x32_bf16 v[68:71], v[164:167], a[32:35], v[68:71]
    s_waitcnt lgkmcnt(10)
    v_cvt_pk_bf16_f32 v199, v54, v55
    s_nop 1
    v_permlane16_swap_b32 v192, v194
    v_mfma_f32_16x16x32_bf16 v[64:67], v[168:171], a[36:39], v[64:67]
    ds_read_b64_tr_b16 v[164:165], v245 offset:36864
    ds_read_b64_tr_b16 v[166:167], v245 offset:37120
    v_mfma_f32_16x16x32_bf16 v[72:75], v[168:171], a[108:111], v[72:75]
    v_permlane16_swap_b32 v193, v195
    v_mfma_f32_16x16x32_bf16 v[80:83], v[168:171], a[180:183], v[80:83]
    v_permlane16_swap_b32 v196, v198
    v_mfma_f32_16x16x32_bf16 v[88:91], v[168:171], a[252:255], v[88:91]
    v_mfma_f32_16x16x32_bf16 v[92:95], v[172:175], a[252:255], v[92:95]
    ds_read_b64_tr_b16 v[168:169], v244 offset:38912
    ds_read_b64_tr_b16 v[170:171], v244 offset:39168
    v_mfma_f32_16x16x32_bf16 v[84:87], v[172:175], a[180:183], v[84:87]
    v_permlane16_swap_b32 v197, v199
    v_mfma_f32_16x16x32_bf16 v[76:79], v[172:175], a[108:111], v[76:79]
    s_nop 0
    v_mov_b32 v16, v192
    v_mov_b32 v17, v193
    v_mfma_f32_16x16x32_bf16 v[68:71], v[172:175], a[36:39], v[68:71]
    s_waitcnt lgkmcnt(10)
    v_mov_b32 v18, v194
    v_mov_b32 v19, v195
    v_mfma_f32_16x16x32_bf16 v[64:67], v[176:179], a[40:43], v[64:67]
    ds_read_b64_tr_b16 v[172:173], v245 offset:38912
    ds_read_b64_tr_b16 v[174:175], v245 offset:39168
    v_mfma_f32_16x16x32_bf16 v[72:75], v[176:179], a[112:115], v[72:75]
    v_mov_b32_dpp v192, v196 row_ror:8 row_mask:0xf bank_mask:0xc
    v_mov_b32_dpp v193, v197 row_ror:8 row_mask:0xf bank_mask:0xc
    v_mfma_f32_16x16x32_bf16 v[80:83], v[176:179], a[184:187], v[80:83]
    v_mfma_f32_16x16x32_bf16 v[88:91], v[176:179], v[128:131], v[88:91]
    v_mov_b32_dpp v194, v198 row_ror:8 row_mask:0xf bank_mask:0xc
    v_mov_b32_dpp v195, v199 row_ror:8 row_mask:0xf bank_mask:0xc
    v_mfma_f32_16x16x32_bf16 v[92:95], v[180:183], v[128:131], v[92:95]
    ds_read_b64_tr_b16 v[176:177], v244 offset:40960
    ds_read_b64_tr_b16 v[178:179], v244 offset:41216
    v_mfma_f32_16x16x32_bf16 v[84:87], v[180:183], a[184:187], v[84:87]
    v_mov_b32_dpp v196, v16 row_ror:8 row_mask:0xf bank_mask:0x3
    v_mov_b32_dpp v197, v17 row_ror:8 row_mask:0xf bank_mask:0x3
    v_mfma_f32_16x16x32_bf16 v[76:79], v[180:183], a[112:115], v[76:79]
    v_mfma_f32_16x16x32_bf16 v[68:71], v[180:183], a[40:43], v[68:71]
    s_waitcnt lgkmcnt(10)
    v_mov_b32_dpp v198, v18 row_ror:8 row_mask:0xf bank_mask:0x3
    v_mov_b32_dpp v199, v19 row_ror:8 row_mask:0xf bank_mask:0x3
    v_mfma_f32_16x16x32_bf16 v[64:67], v[184:187], a[44:47], v[64:67]
    ds_read_b64_tr_b16 v[180:181], v245 offset:40960
    ds_read_b64_tr_b16 v[182:183], v245 offset:41216
    v_mfma_f32_16x16x32_bf16 v[72:75], v[184:187], a[116:119], v[72:75]
    buffer_store_dwordx4 v[192:195], v240, s[28:31], s56 offen sc1
    s_waitcnt vmcnt(21)
    v_mfma_f32_16x16x32_bf16 v[80:83], v[184:187], a[188:191], v[80:83]
    v_mov_b32 v255, 2
    v_mfma_f32_16x16x32_bf16 v[88:91], v[184:187], v[132:135], v[88:91]
    s_mov_b64 exec, 1
    buffer_store_dword v255, off, s[92:95], s5 sc0 sc1
    s_mov_b64 exec, -1
    v_mfma_f32_16x16x32_bf16 v[92:95], v[188:191], v[132:135], v[92:95]
    s_add_u32 s56, s56, 27648
    ds_read_b64_tr_b16 v[184:185], v244 offset:43008
    ds_read_b64_tr_b16 v[186:187], v244 offset:43264
    v_mfma_f32_16x16x32_bf16 v[84:87], v[188:191], a[188:191], v[84:87]
    buffer_store_dwordx4 v[196:199], v240, s[28:31], s56 offen sc1
    s_add_u32 s56, s56, 27648
    v_mfma_f32_16x16x32_bf16 v[76:79], v[188:191], a[116:119], v[76:79]
    v_cvt_pk_bf16_f32 v200, v24, v25
    v_cvt_pk_bf16_f32 v201, v26, v27
    v_mfma_f32_16x16x32_bf16 v[68:71], v[188:191], a[44:47], v[68:71]
    s_waitcnt lgkmcnt(10)
    v_cvt_pk_bf16_f32 v202, v56, v57
    v_cvt_pk_bf16_f32 v203, v58, v59
    v_mfma_f32_16x16x32_bf16 v[64:67], v[160:163], a[48:51], v[64:67]
    ds_read_b64_tr_b16 v[188:189], v245 offset:43008
    ds_read_b64_tr_b16 v[190:191], v245 offset:43264
    v_mfma_f32_16x16x32_bf16 v[72:75], v[160:163], a[120:123], v[72:75]
    v_cvt_pk_bf16_f32 v204, v28, v29
    v_cvt_pk_bf16_f32 v205, v30, v31
    v_mfma_f32_16x16x32_bf16 v[80:83], v[160:163], a[192:195], v[80:83]
    v_mfma_f32_16x16x32_bf16 v[88:91], v[160:163], v[136:139], v[88:91]
    v_cvt_pk_bf16_f32 v206, v60, v61
    v_cvt_pk_bf16_f32 v207, v62, v63
    s_nop 1
    v_permlane16_swap_b32 v200, v202
    v_mfma_f32_16x16x32_bf16 v[92:95], v[164:167], v[136:139], v[92:95]
    ds_read_b64_tr_b16 v[160:161], v244 offset:45056
    ds_read_b64_tr_b16 v[162:163], v244 offset:45312
    v_mfma_f32_16x16x32_bf16 v[84:87], v[164:167], a[192:195], v[84:87]
    v_mfma_f32_16x16x32_bf16 v[76:79], v[164:167], a[120:123], v[76:79]
    v_permlane16_swap_b32 v201, v203
    v_mfma_f32_16x16x32_bf16 v[68:71], v[164:167], a[48:51], v[68:71]
    s_waitcnt lgkmcnt(10)
    v_mfma_f32_16x16x32_bf16 v[64:67], v[168:171], a[52:55], v[64:67]
    ds_read_b64_tr_b16 v[164:165], v245 offset:45056
    ds_read_b64_tr_b16 v[166:167], v245 offset:45312
    v_mfma_f32_16x16x32_bf16 v[72:75], v[168:171], a[124:127], v[72:75]
    v_permlane16_swap_b32 v204, v206
    v_mfma_f32_16x16x32_bf16 v[80:83], v[168:171], a[196:199], v[80:83]
    v_permlane16_swap_b32 v205, v207
    v_mfma_f32_16x16x32_bf16 v[88:91], v[168:171], v[140:143], v[88:91]
    v_mfma_f32_16x16x32_bf16 v[92:95], v[172:175], v[140:143], v[92:95]
    ds_read_b64_tr_b16 v[168:169], v244 offset:47104
    ds_read_b64_tr_b16 v[170:171], v244 offset:47360
    v_mfma_f32_16x16x32_bf16 v[84:87], v[172:175], a[196:199], v[84:87]
    v_mov_b32 v24, v200
    v_mov_b32 v25, v201
    v_mfma_f32_16x16x32_bf16 v[76:79], v[172:175], a[124:127], v[76:79]
    v_mov_b32 v26, v202
    v_mov_b32 v27, v203
    v_mfma_f32_16x16x32_bf16 v[68:71], v[172:175], a[52:55], v[68:71]
    s_waitcnt lgkmcnt(10)
    v_mfma_f32_16x16x32_bf16 v[64:67], v[176:179], a[56:59], v[64:67]
    ds_read_b64_tr_b16 v[172:173], v245 offset:47104
    ds_read_b64_tr_b16 v[174:175], v245 offset:47360
    v_mfma_f32_16x16x32_bf16 v[72:75], v[176:179], a[128:131], v[72:75]
    v_mov_b32_dpp v200, v204 row_ror:8 row_mask:0xf bank_mask:0xc
    v_mov_b32_dpp v201, v205 row_ror:8 row_mask:0xf bank_mask:0xc
    v_mfma_f32_16x16x32_bf16 v[80:83], v[176:179], a[200:203], v[80:83]
    v_mov_b32_dpp v202, v206 row_ror:8 row_mask:0xf bank_mask:0xc
    v_mov_b32_dpp v203, v207 row_ror:8 row_mask:0xf bank_mask:0xc
    v_mfma_f32_16x16x32_bf16 v[88:91], v[176:179], v[144:147], v[88:91]
    v_mfma_f32_16x16x32_bf16 v[92:95], v[180:183], v[144:147], v[92:95]
    v_mov_b32_dpp v204, v24 row_ror:8 row_mask:0xf bank_mask:0x3
    v_mov_b32_dpp v205, v25 row_ror:8 row_mask:0xf bank_mask:0x3
    v_mfma_f32_16x16x32_bf16 v[84:87], v[180:183], a[200:203], v[84:87]
    v_mfma_f32_16x16x32_bf16 v[76:79], v[180:183], a[128:131], v[76:79]
    v_mov_b32_dpp v206, v26 row_ror:8 row_mask:0xf bank_mask:0x3
    v_mov_b32_dpp v207, v27 row_ror:8 row_mask:0xf bank_mask:0x3
    v_mfma_f32_16x16x32_bf16 v[68:71], v[180:183], a[56:59], v[68:71]
    s_waitcnt lgkmcnt(8)
    v_mfma_f32_16x16x32_bf16 v[64:67], v[184:187], a[60:63], v[64:67]
    buffer_store_dwordx4 v[200:203], v240, s[28:31], s56 offen sc1
    s_add_u32 s56, s56, 27648
    v_mfma_f32_16x16x32_bf16 v[72:75], v[184:187], a[132:135], v[72:75]
    buffer_store_dwordx4 v[204:207], v240, s[28:31], s56 offen sc1
    s_add_u32 s56, s56, 27648
    v_mfma_f32_16x16x32_bf16 v[80:83], v[184:187], a[204:207], v[80:83]
    v_mfma_f32_16x16x32_bf16 v[88:91], v[184:187], v[148:151], v[88:91]
    v_mfma_f32_16x16x32_bf16 v[92:95], v[188:191], v[148:151], v[92:95]
    v_mfma_f32_16x16x32_bf16 v[84:87], v[188:191], a[204:207], v[84:87]
    v_mfma_f32_16x16x32_bf16 v[76:79], v[188:191], a[132:135], v[76:79]
    v_mfma_f32_16x16x32_bf16 v[68:71], v[188:191], a[60:63], v[68:71]
    s_waitcnt lgkmcnt(4)
    v_mfma_f32_16x16x32_bf16 v[64:67], v[160:163], a[64:67], v[64:67]
    v_mfma_f32_16x16x32_bf16 v[72:75], v[160:163], a[136:139], v[72:75]
    v_mfma_f32_16x16x32_bf16 v[80:83], v[160:163], a[208:211], v[80:83]
    v_mfma_f32_16x16x32_bf16 v[88:91], v[160:163], v[152:155], v[88:91]
    v_mfma_f32_16x16x32_bf16 v[92:95], v[164:167], v[152:155], v[92:95]
    v_mfma_f32_16x16x32_bf16 v[84:87], v[164:167], a[208:211], v[84:87]
    v_mfma_f32_16x16x32_bf16 v[76:79], v[164:167], a[136:139], v[76:79]
    v_mfma_f32_16x16x32_bf16 v[68:71], v[164:167], a[64:67], v[68:71]
    s_waitcnt lgkmcnt(0)
    v_mfma_f32_16x16x32_bf16 v[64:67], v[168:171], a[68:71], v[64:67]
    v_mfma_f32_16x16x32_bf16 v[72:75], v[168:171], a[140:143], v[72:75]
    v_mfma_f32_16x16x32_bf16 v[80:83], v[168:171], a[212:215], v[80:83]
    v_mfma_f32_16x16x32_bf16 v[88:91], v[168:171], v[156:159], v[88:91]
    v_mfma_f32_16x16x32_bf16 v[92:95], v[172:175], v[156:159], v[92:95]
    v_mfma_f32_16x16x32_bf16 v[84:87], v[172:175], a[212:215], v[84:87]
    v_mfma_f32_16x16x32_bf16 v[76:79], v[172:175], a[140:143], v[76:79]
    v_mfma_f32_16x16x32_bf16 v[68:71], v[172:175], a[68:71], v[68:71]
    s_add_u32 s56, s50, s43
    s_add_u32 s57, s50, s44
    s_add_u32 s58, s56, 110592
    s_add_u32 s59, s57, 110592
K1_tailS:
    s_nop 15
    v_cvt_pk_bf16_f32 v192, v64, v65
    v_cvt_pk_bf16_f32 v193, v66, v67
    v_cvt_pk_bf16_f32 v194, v68, v69
    v_cvt_pk_bf16_f32 v195, v70, v71
    s_nop 1
    v_permlane16_swap_b32 v192, v194
    v_permlane16_swap_b32 v193, v195
    s_nop 1
    buffer_store_dwordx4 v[192:195], v217, s[28:31], s56 offen sc1
    v_cvt_pk_bf16_f32 v196, v72, v73
    v_cvt_pk_bf16_f32 v197, v74, v75
    v_cvt_pk_bf16_f32 v198, v76, v77
    v_cvt_pk_bf16_f32 v199, v78, v79
    s_nop 1
    v_permlane16_swap_b32 v196, v198
    v_permlane16_swap_b32 v197, v199
    s_nop 1
    buffer_store_dwordx4 v[196:199], v247, s[28:31], s56 offen sc1
    v_cvt_pk_bf16_f32 v200, v80, v81
    v_cvt_pk_bf16_f32 v201, v82, v83
    v_cvt_pk_bf16_f32 v202, v84, v85
    v_cvt_pk_bf16_f32 v203, v86, v87
    s_nop 1
    v_permlane16_swap_b32 v200, v202
    v_permlane16_swap_b32 v201, v203
    s_nop 1
    buffer_store_dwordx4 v[200:203], v217, s[28:31], s58 offen sc1
    v_cvt_pk_bf16_f32 v204, v88, v89
    v_cvt_pk_bf16_f32 v205, v90, v91
    v_cvt_pk_bf16_f32 v206, v92, v93
    v_cvt_pk_bf16_f32 v207, v94, v95
    s_nop 1
    v_permlane16_swap_b32 v204, v206
    v_permlane16_swap_b32 v205, v207
    s_nop 1
    buffer_store_dwordx4 v[204:207], v247, s[28:31], s58 offen sc1
K1_fuse:
    s_lshl_b32 s51, s36, 6
    v_add_u32 v0, s51, v208
    s_bitcmp1_b32 s4, 8
    s_cbranch_scc1 K1_solo1
    s_branch K3_entry
K1_solo1:
    s_waitcnt vmcnt(0)
    s_barrier
    s_add_u32 s2, s2, 1
    s_cmp_lt_u32 s2, 256
    s_cbranch_scc1 K1_task
    s_add_u32 s2, s4, 1
    s_and_b32 s2, s2, 255
    s_branch K3_solo
C0_spin:
    s_movk_i32 s72, 4000
    s_cmp_ge_u32 s4, 256
    s_cbranch_scc1 C0_ret
C0_loop:
    s_sleep 2
    buffer_load_dword v254, v253, s[96:99], 0 offen sc1
    s_waitcnt vmcnt(0)
    v_cmp_gt_u32 vcc, 32, v254
    s_sub_u32 s72, s72, 1
    s_nop 3
    s_cbranch_vccz C0_ret
    s_cbranch_scc0 C0_loop
    s_bitset1_b32 s4, 9
    s_branch C0_ret
C1a_spin:
    s_movk_i32 s72, 4000
    s_cmp_ge_u32 s4, 256
    s_cbranch_scc1 C1a_ret
C1a_loop:
    s_sleep 2
    buffer_load_dword v254, v253, s[92:95], s88 offen sc1
    s_waitcnt vmcnt(0)
    v_cmp_gt_u32 vcc, 1, v254
    s_sub_u32 s72, s72, 1
    s_nop 3
    s_cbranch_vccz C1a_ret
    s_cbranch_scc0 C1a_loop
    s_bitset1_b32 s4, 9
    s_branch C1a_ret
C1b_spin:
    s_movk_i32 s72, 4000
    s_cmp_ge_u32 s4, 256
    s_cbranch_scc1 C1b_ret
C1b_loop:
    s_sleep 2
    buffer_load_dword v254, v253, s[92:95], s88 offen sc1
    s_waitcnt vmcnt(0)
    v_cmp_gt_u32 vcc, 1, v254
    s_sub_u32 s72, s72, 1
    s_nop 3
    s_cbranch_vccz C1b_ret
    s_cbranch_scc0 C1b_loop
    s_bitset1_b32 s4, 9
    s_branch C1b_ret
K1_done:
    s_endpgm
K1_solo0:
    s_cmp_lg_u32 s38, 0
    s_cbranch_scc1 K1_polled0
K1_fallback:
    s_mov_b64 exec, -1
    s_lshl_b32 s56, s37, 8
    s_add_u32 s57, s56, 256
K1_fbloop:
    v_lshrrev_b32 v4, 4, v208
    v_add_u32 v3, s56, v4
    v_and_b32 v4, 15, v208
    v_mul_u32_u24 v7, 1152, v3
    v_lshl_add_u32 v5, v4, 4, v7
    v_lshl_add_u32 v7, v4, 3, v7
    buffer_load_dwordx4 v[12:15], v5, s[92:95], 0 offen offset:0
    buffer_load_dwordx4 v[16:19], v5, s[92:95], 0 offen offset:256
    buffer_load_dwordx4 v[20:23], v5, s[92:95], 0 offen offset:512
    buffer_load_dwordx4 v[24:27], v5, s[92:95], 0 offen offset:768
    buffer_load_dwordx2 v[28:29], v7, s[92:95], 0 offen offset:1024
    v_lshrrev_b32 v6, 4, v3
    v_mul_u32_u24 v6, 18432, v6
    v_and_b32 v2, 15, v3
    v_lshl_add_u32 v6, v2, 4, v6
    v_lshrrev_b32 v2, 1, v4
    v_lshl_add_u32 v2, v2, 8, v6
    v_and_b32 v1, 1, v4
    v_lshl_add_u32 v2, v1, 3, v2
    v_lshl_add_u32 v6, v4, 8, v6
    s_mov_b32 s51, 0x3f803f80
    s_mov_b32 s52, 0x3f80
    s_mov_b32 s62, 0x3f800000
    s_waitcnt vmcnt(4)
    v_dot2_f32_bf16 v8, v12, s51, 0
    v_dot2_f32_bf16 v10, v12, v12, 0
    v_dot2_f32_bf16 v9, v13, s51, 0
    v_dot2_f32_bf16 v11, v13, v13, 0
    v_dot2_f32_bf16 v8, v14, s51, v8
    v_dot2_f32_bf16 v10, v14, v14, v10
    v_dot2_f32_bf16 v9, v15, s51, v9
    v_dot2_f32_bf16 v11, v15, v15, v11
    s_waitcnt vmcnt(3)
    v_dot2_f32_bf16 v8, v16, s51, v8
    v_dot2_f32_bf16 v10, v16, v16, v10
    v_dot2_f32_bf16 v9, v17, s51, v9
    v_dot2_f32_bf16 v11, v17, v17, v11
    v_dot2_f32_bf16 v8, v18, s51, v8
    v_dot2_f32_bf16 v10, v18, v18, v10
    v_dot2_f32_bf16 v9, v19, s51, v9
    v_dot2_f32_bf16 v11, v19, v19, v11
    s_waitcnt vmcnt(2)
    v_dot2_f32_bf16 v8, v20, s51, v8
    v_dot2_f32_bf16 v10, v20, v20, v10
    v_dot2_f32_bf16 v9, v21, s51, v9
    v_dot2_f32_bf16 v11, v21, v21, v11
    v_dot2_f32_bf16 v8, v22, s51, v8
    v_dot2_f32_bf16 v10, v22, v22, v10
    v_dot2_f32_bf16 v9, v23, s51, v9
    v_dot2_f32_bf16 v11, v23, v23, v11
    s_waitcnt vmcnt(1)
    v_dot2_f32_bf16 v8, v24, s51, v8
    v_dot2_f32_bf16 v10, v24, v24, v10
    v_dot2_f32_bf16 v9, v25, s51, v9
    v_dot2_f32_bf16 v11, v25, v25, v11
    v_dot2_f32_bf16 v8, v26, s51, v8
    v_dot2_f32_bf16 v10, v26, v26, v10
    v_dot2_f32_bf16 v9, v27, s51, v9
    v_dot2_f32_bf16 v11, v27, v27, v11
    s_waitcnt vmcnt(0)
    v_dot2_f32_bf16 v8, v28, s51, v8
    v_dot2_f32_bf16 v10, v28, v28, v10
    v_dot2_f32_bf16 v9, v29, s51, v9
    v_dot2_f32_bf16 v11, v29, v29, v11
    s_nop 1
    v_add_f32 v8, v8, v9
    v_add_f32 v10, v10, v11
    s_nop 0
    v_add_f32_dpp v8, v8, v8 quad_perm:[1,0,3,2] row_mask:0xf bank_mask:0xf
    v_add_f32_dpp v10, v10, v10 quad_perm:[1,0,3,2] row_mask:0xf bank_mask:0xf
    s_nop 0
    v_add_f32_dpp v8, v8, v8 quad_perm:[2,3,0,1] row_mask:0xf bank_mask:0xf
    v_add_f32_dpp v10, v10, v10 quad_perm:[2,3,0,1] row_mask:0xf bank_mask:0xf
    s_nop 0
    v_add_f32_dpp v8, v8, v8 row_half_mirror row_mask:0xf bank_mask:0xf
    v_add_f32_dpp v10, v10, v10 row_half_mirror row_mask:0xf bank_mask:0xf
    s_nop 0
    v_add_f32_dpp v8, v8, v8 row_mirror row_mask:0xf bank_mask:0xf
    v_add_f32_dpp v10, v10, v10 row_mirror row_mask:0xf bank_mask:0xf
    v_mul_f32 v8, 0x3ae38e39, v8
    v_mul_f32 v10, 0x3ae38e39, v10
    v_fma_f32 v10, -v8, v8, v10
    v_max_f32 v10, 0, v10
    v_cvt_pk_bf16_f32 v9, v8, v10
    v_and_b32 v10, 0xffff0000, v9
    v_lshlrev_b32 v8, 16, v9
    v_add_f32 v10, 0x3727c5ac, v10
    v_xor_b32 v8, 0x80000000, v8
    v_cvt_pk_bf16_f32 v10, v10, v10
    v_lshlrev_b32 v10, 16, v10
    v_sqrt_f32 v10, v10
    v_dot2_f32_bf16 v32, v12, s52, v8
    v_dot2_f32_bf16 v33, v12, s62, v8
    v_dot2_f32_bf16 v34, v13, s52, v8
    v_dot2_f32_bf16 v35, v13, s62, v8
    v_cvt_pk_bf16_f32 v10, v10, v10
    v_lshlrev_b32 v10, 16, v10
    v_rcp_f32 v10, v10
    v_dot2_f32_bf16 v36, v14, s52, v8
    v_dot2_f32_bf16 v37, v14, s62, v8
    v_dot2_f32_bf16 v38, v15, s52, v8
    v_dot2_f32_bf16 v39, v15, s62, v8
    v_dot2_f32_bf16 v40, v16, s52, v8
    v_dot2_f32_bf16 v41, v16, s62, v8
    v_dot2_f32_bf16 v42, v17, s52, v8
    v_dot2_f32_bf16 v43, v17, s62, v8
    v_dot2_f32_bf16 v44, v18, s52, v8
    v_dot2_f32_bf16 v45, v18, s62, v8
    v_dot2_f32_bf16 v46, v19, s52, v8
    v_dot2_f32_bf16 v47, v19, s62, v8
    v_dot2_f32_bf16 v48, v20, s52, v8
    v_dot2_f32_bf16 v49, v20, s62, v8
    v_dot2_f32_bf16 v50, v21, s52, v8
    v_dot2_f32_bf16 v51, v21, s62, v8
    v_dot2_f32_bf16 v52, v22, s52, v8
    v_dot2_f32_bf16 v53, v22, s62, v8
    v_dot2_f32_bf16 v54, v23, s52, v8
    v_dot2_f32_bf16 v55, v23, s62, v8
    v_dot2_f32_bf16 v56, v24, s52, v8
    v_dot2_f32_bf16 v57, v24, s62, v8
    v_dot2_f32_bf16 v58, v25, s52, v8
    v_dot2_f32_bf16 v59, v25, s62, v8
    v_dot2_f32_bf16 v60, v26, s52, v8
    v_dot2_f32_bf16 v61, v26, s62, v8
    v_dot2_f32_bf16 v62, v27, s52, v8
    v_dot2_f32_bf16 v63, v27, s62, v8
    v_dot2_f32_bf16 v64, v28, s52, v8
    v_dot2_f32_bf16 v65, v28, s62, v8
    v_dot2_f32_bf16 v66, v29, s52, v8
    v_dot2_f32_bf16 v67, v29, s62, v8
    v_cvt_pk_bf16_f32 v12, v32, v33
    v_cvt_pk_bf16_f32 v13, v34, v35
    v_cvt_pk_bf16_f32 v14, v36, v37
    v_cvt_pk_bf16_f32 v15, v38, v39
    v_cvt_pk_bf16_f32 v16, v40, v41
    v_cvt_pk_bf16_f32 v17, v42, v43
    v_cvt_pk_bf16_f32 v18, v44, v45
    v_cvt_pk_bf16_f32 v19, v46, v47
    v_cvt_pk_bf16_f32 v20, v48, v49
    v_cvt_pk_bf16_f32 v21, v50, v51
    v_cvt_pk_bf16_f32 v22, v52, v53
    v_cvt_pk_bf16_f32 v23, v54, v55
    v_cvt_pk_bf16_f32 v24, v56, v57
    v_cvt_pk_bf16_f32 v25, v58, v59
    v_cvt_pk_bf16_f32 v26, v60, v61
    v_cvt_pk_bf16_f32 v27, v62, v63
    v_cvt_pk_bf16_f32 v28, v64, v65
    v_cvt_pk_bf16_f32 v29, v66, v67
    v_lshlrev_b32 v32, 16, v12
    v_and_b32 v33, 0xffff0000, v12
    v_lshlrev_b32 v34, 16, v13
    v_and_b32 v35, 0xffff0000, v13
    v_lshlrev_b32 v36, 16, v14
    v_and_b32 v37, 0xffff0000, v14
    v_lshlrev_b32 v38, 16, v15
    v_and_b32 v39, 0xffff0000, v15
    v_lshlrev_b32 v40, 16, v16
    v_and_b32 v41, 0xffff0000, v16
    v_lshlrev_b32 v42, 16, v17
    v_and_b32 v43, 0xffff0000, v17
    v_lshlrev_b32 v44, 16, v18
    v_and_b32 v45, 0xffff0000, v18
    v_lshlrev_b32 v46, 16, v19
    v_and_b32 v47, 0xffff0000, v19
    v_lshlrev_b32 v48, 16, v20
    v_and_b32 v49, 0xffff0000, v20
    v_lshlrev_b32 v50, 16, v21
    v_and_b32 v51, 0xffff0000, v21
    v_lshlrev_b32 v52, 16, v22
    v_and_b32 v53, 0xffff0000, v22
    v_lshlrev_b32 v54, 16, v23
    v_and_b32 v55, 0xffff0000, v23
    v_lshlrev_b32 v56, 16, v24
    v_and_b32 v57, 0xffff0000, v24
    v_lshlrev_b32 v58, 16, v25
    v_and_b32 v59, 0xffff0000, v25
    v_lshlrev_b32 v60, 16, v26
    v_and_b32 v61, 0xffff0000, v26
    v_lshlrev_b32 v62, 16, v27
    v_and_b32 v63, 0xffff0000, v27
    v_lshlrev_b32 v64, 16, v28
    v_and_b32 v65, 0xffff0000, v28
    v_lshlrev_b32 v66, 16, v29
    v_and_b32 v67, 0xffff0000, v29
    v_pk_mul_f32 v[32:33], v[32:33], v[10:11] op_sel_hi:[1,0]
    v_pk_mul_f32 v[34:35], v[34:35], v[10:11] op_sel_hi:[1,0]
    v_pk_mul_f32 v[36:37], v[36:37], v[10:11] op_sel_hi:[1,0]
    v_pk_mul_f32 v[38:39], v[38:39], v[10:11] op_sel_hi:[1,0]
    v_pk_mul_f32 v[40:41], v[40:41], v[10:11] op_sel_hi:[1,0]
    v_pk_mul_f32 v[42:43], v[42:43], v[10:11] op_sel_hi:[1,0]
    v_pk_mul_f32 v[44:45], v[44:45], v[10:11] op_sel_hi:[1,0]
    v_pk_mul_f32 v[46:47], v[46:47], v[10:11] op_sel_hi:[1,0]
    v_pk_mul_f32 v[48:49], v[48:49], v[10:11] op_sel_hi:[1,0]
    v_pk_mul_f32 v[50:51], v[50:51], v[10:11] op_sel_hi:[1,0]
    v_pk_mul_f32 v[52:53], v[52:53], v[10:11] op_sel_hi:[1,0]
    v_pk_mul_f32 v[54:55], v[54:55], v[10:11] op_sel_hi:[1,0]
    v_pk_mul_f32 v[56:57], v[56:57], v[10:11] op_sel_hi:[1,0]
    v_pk_mul_f32 v[58:59], v[58:59], v[10:11] op_sel_hi:[1,0]
    v_pk_mul_f32 v[60:61], v[60:61], v[10:11] op_sel_hi:[1,0]
    v_pk_mul_f32 v[62:63], v[62:63], v[10:11] op_sel_hi:[1,0]
    v_pk_mul_f32 v[64:65], v[64:65], v[10:11] op_sel_hi:[1,0]
    v_pk_mul_f32 v[66:67], v[66:67], v[10:11] op_sel_hi:[1,0]
    v_cvt_pk_bf16_f32 v12, v32, v33
    v_cvt_pk_bf16_f32 v13, v34, v35
    v_cvt_pk_bf16_f32 v14, v36, v37
    v_cvt_pk_bf16_f32 v15, v38, v39
    v_cvt_pk_bf16_f32 v16, v40, v41
    v_cvt_pk_bf16_f32 v17, v42, v43
    v_cvt_pk_bf16_f32 v18, v44, v45
    v_cvt_pk_bf16_f32 v19, v46, v47
    v_cvt_pk_bf16_f32 v20, v48, v49
    v_cvt_pk_bf16_f32 v21, v50, v51
    v_cvt_pk_bf16_f32 v22, v52, v53
    v_cvt_pk_bf16_f32 v23, v54, v55
    v_cvt_pk_bf16_f32 v24, v56, v57
    v_cvt_pk_bf16_f32 v25, v58, v59
    v_cvt_pk_bf16_f32 v26, v60, v61
    v_cvt_pk_bf16_f32 v27, v62, v63
    v_cvt_pk_bf16_f32 v28, v64, v65
    v_cvt_pk_bf16_f32 v29, v66, v67
    s_mov_b32 s51, 0
    buffer_store_dwordx4 v[12:15], v6, s[20:23], s51 offen sc0 sc1
    s_mov_b32 s51, 4096
    buffer_store_dwordx4 v[16:19], v6, s[20:23], s51 offen sc0 sc1
    s_mov_b32 s51, 8192
    buffer_store_dwordx4 v[20:23], v6, s[20:23], s51 offen sc0 sc1
    s_mov_b32 s51, 12288
    buffer_store_dwordx4 v[24:27], v6, s[20:23], s51 offen sc0 sc1
    s_mov_b32 s51, 16384
    buffer_store_dwordx2 v[28:29], v2, s[20:23], s51 offen sc0 sc1
    s_waitcnt vmcnt(0)
    s_add_u32 s56, s56, 4
    s_cmp_lt_u32 s56, s57
    s_cbranch_scc1 K1_fbloop
    s_branch K1_polled0
K3_solo:
    v_and_b32 v1, 63, v0
    v_lshrrev_b32 v2, 6, v0
    v_lshlrev_b32 v5, 4, v1
    v_readfirstlane_b32 s32, v2
    s_and_b32 s38, s32, 1
    s_lshl_b32 s38, s38, 6
    v_add_u32 v3, s38, v1
    v_mul_u32_u24 v4, 3641, v3
    v_lshrrev_b32 v4, 16, v4
    v_mul_u32_u24 v225, 864, v4
    v_lshl_add_u32 v225, v3, 4, v225
    v_add_u32 v3, 128, v3
    v_mul_u32_u24 v4, 3641, v3
    v_lshrrev_b32 v4, 16, v4
    v_mul_u32_u24 v226, 864, v4
    v_lshl_add_u32 v226, v3, 4, v226
    v_add_u32 v3, 128, v3
    v_mul_u32_u24 v4, 3641, v3
    v_lshrrev_b32 v4, 16, v4
    v_mul_u32_u24 v227, 864, v4
    v_lshl_add_u32 v227, v3, 4, v227
    v_add_u32 v3, 128, v3
    v_mul_u32_u24 v4, 3641, v3
    v_lshrrev_b32 v4, 16, v4
    v_mul_u32_u24 v228, 864, v4
    v_lshl_add_u32 v228, v3, 4, v228
    v_add_u32 v3, 128, v3
    v_mul_u32_u24 v4, 3641, v3
    v_lshrrev_b32 v4, 16, v4
    v_mul_u32_u24 v229, 864, v4
    v_lshl_add_u32 v229, v3, 4, v229
    v_add_u32 v3, 128, v3
    v_mul_u32_u24 v4, 3641, v3
    v_lshrrev_b32 v4, 16, v4
    v_mul_u32_u24 v230, 864, v4
    v_lshl_add_u32 v230, v3, 4, v230
    v_add_u32 v3, 128, v3
    v_mul_u32_u24 v4, 3641, v3
    v_lshrrev_b32 v4, 16, v4
    v_mul_u32_u24 v231, 864, v4
    v_lshl_add_u32 v231, v3, 4, v231
    v_add_u32 v3, 128, v3
    v_mul_u32_u24 v4, 3641, v3
    v_lshrrev_b32 v4, 16, v4
    v_mul_u32_u24 v232, 864, v4
    v_lshl_add_u32 v232, v3, 4, v232
    v_add_u32 v3, 128, v3
    v_mul_u32_u24 v4, 3641, v3
    v_lshrrev_b32 v4, 16, v4
    v_mul_u32_u24 v233, 864, v4
    v_lshl_add_u32 v233, v3, 4, v233
    s_and_b32 s38, s2, 6
    s_lshr_b32 s39, s32, 1
    s_add_u32 s38, s38, s39
    s_mul_i32 s97, s39, 9216
    s_mul_i32 s96, s38, 663552
    s_mul_i32 s98, s38, 18432
    s_mul_i32 s100, s39, 294912
    s_bfe_u32 s38, s2, 0x20003
    s_mul_i32 s38, s38, 288
    s_add_u32 s96, s96, s38
    s_and_b32 s89, s32, 1
    s_lshl_b32 s39, s89, 10
    s_add_u32 s97, s97, s39
    s_and_b32 s39, s2, 1
    s_lshl_b32 s39, s39, 4
    s_add_u32 s38, s89, s39
    s_lshr_b32 s39, s2, 5
    s_lshl_b32 s39, s39, 1
    s_add_u32 s38, s38, s39
    s_mul_i32 s38, s38, 589824
    s_add_u32 s38, s98, s38
    s_add_u32 s98, s38, s100
    s_sub_u32 s100, s38, s100
    s_add_u32 s100, s100, 294912
    s_add_u32 s99, s98, 147456
    s_add_u32 s101, s100, 147456
    s_load_dwordx2 s[6:7], s[0:1], 0
    s_load_dwordx2 s[20:21], s[0:1], 56
    s_load_dwordx2 s[84:85], s[0:1], 64
    s_mov_b32 s86, 256
    s_mov_b32 s87, 0x00020000
    s_add_u32 s16, s10, 20971520
    s_addc_u32 s17, s11, 0
    s_mov_b32 s19, 0x00020000
    s_cmp_ge_u32 s4, 512
    s_cselect_b32 s18, 0, 18874368
    s_add_u32 m0, s97, 73728
    s_nop 0
    buffer_load_dwordx4 v225, s[80:83], s96 offen lds
    s_add_u32 m0, s97, 75776
    s_nop 0
    buffer_load_dwordx4 v226, s[80:83], s96 offen lds
    s_add_u32 m0, s97, 77824
    s_nop 0
    buffer_load_dwordx4 v227, s[80:83], s96 offen lds
    s_add_u32 m0, s97, 79872
    s_nop 0
    buffer_load_dwordx4 v228, s[80:83], s96 offen lds
    s_mul_i32 m0, s89, 0x2400
    s_add_u32 m0, m0, s97
    s_add_u32 m0, m0, 81920
    s_nop 0
    buffer_load_dwordx4 v229, s[80:83], s96 offen lds
    s_add_u32 m0, s97, 93184
    s_nop 0
    buffer_load_dwordx4 v230, s[80:83], s96 offen lds
    s_add_u32 m0, s97, 95232
    s_nop 0
    buffer_load_dwordx4 v231, s[80:83], s96 offen lds
    s_add_u32 m0, s97, 97280
    s_nop 0
    buffer_load_dwordx4 v232, s[80:83], s96 offen lds
    s_add_u32 m0, s97, 99328
    s_nop 0
    buffer_load_dwordx4 v233, s[80:83], s96 offen lds
    s_add_u32 s96, s96, 73728
    s_add_u32 m0, s97, 0
    s_nop 0
    buffer_load_dwordx4 v225, s[80:83], s96 offen lds
    s_add_u32 m0, s97, 2048
    s_nop 0
    buffer_load_dwordx4 v226, s[80:83], s96 offen lds
    s_add_u32 m0, s97, 4096
    s_nop 0
    buffer_load_dwordx4 v227, s[80:83], s96 offen lds
    s_add_u32 m0, s97, 6144
    s_nop 0
    buffer_load_dwordx4 v228, s[80:83], s96 offen lds
    s_mul_i32 m0, s89, 0x2400
    s_add_u32 m0, m0, s97
    s_add_u32 m0, m0, 8192
    s_nop 0
    buffer_load_dwordx4 v229, s[80:83], s96 offen lds
    s_add_u32 m0, s97, 19456
    s_nop 0
    buffer_load_dwordx4 v230, s[80:83], s96 offen lds
    s_add_u32 m0, s97, 21504
    s_nop 0
    buffer_load_dwordx4 v231, s[80:83], s96 offen lds
    s_add_u32 m0, s97, 23552
    s_nop 0
    buffer_load_dwordx4 v232, s[80:83], s96 offen lds
    s_add_u32 m0, s97, 25600
    s_nop 0
    buffer_load_dwordx4 v233, s[80:83], s96 offen lds
    s_add_u32 s96, s96, 73728
    buffer_load_dwordx4 a[0:3], v5, s[16:19], s98 offen offset:0 sc1
    buffer_load_dwordx4 a[72:75], v5, s[16:19], s99 offen offset:0 sc1
    buffer_load_dwordx4 a[144:147], v5, s[16:19], s100 offen offset:0 sc1
    buffer_load_dwordx4 a[216:219], v5, s[16:19], s101 offen offset:0 sc1
    buffer_load_dwordx4 a[4:7], v5, s[16:19], s98 offen offset:1024 sc1
    buffer_load_dwordx4 a[76:79], v5, s[16:19], s99 offen offset:1024 sc1
    buffer_load_dwordx4 a[148:151], v5, s[16:19], s100 offen offset:1024 sc1
    buffer_load_dwordx4 a[220:223], v5, s[16:19], s101 offen offset:1024 sc1
    buffer_load_dwordx4 a[8:11], v5, s[16:19], s98 offen offset:2048 sc1
    buffer_load_dwordx4 a[80:83], v5, s[16:19], s99 offen offset:2048 sc1
    buffer_load_dwordx4 a[152:155], v5, s[16:19], s100 offen offset:2048 sc1
    buffer_load_dwordx4 a[224:227], v5, s[16:19], s101 offen offset:2048 sc1
    buffer_load_dwordx4 a[12:15], v5, s[16:19], s98 offen offset:3072 sc1
    s_add_u32 s98, s98, 4096
    buffer_load_dwordx4 a[84:87], v5, s[16:19], s99 offen offset:3072 sc1
    s_add_u32 s99, s99, 4096
    buffer_load_dwordx4 a[156:159], v5, s[16:19], s100 offen offset:3072 sc1
    s_add_u32 s100, s100, 4096
    buffer_load_dwordx4 a[228:231], v5, s[16:19], s101 offen offset:3072 sc1
    s_add_u32 s101, s101, 4096
    s_waitcnt vmcnt(0) lgkmcnt(0)
K3_entry:
    v_and_b32 v144, 63, v0
    v_lshrrev_b32 v1, 6, v0
    s_nop 0
    v_readfirstlane_b32 s32, v1
    v_lshlrev_b32 v149, 4, v144
    s_lshr_b32 s37, s32, 1
    s_mul_i32 s44, s37, 9216
    v_lshrrev_b32 v1, 4, v144
    v_lshlrev_b32 v1, 2, v1
    v_bfe_u32 v2, v144, 2, 2
    v_add_u32 v1, v1, v2
    v_mul_u32_u24 v145, 288, v1
    v_and_b32 v2, 3, v144
    v_lshl_add_u32 v145, v2, 3, v145
    v_add_u32 v145, s44, v145
    v_add_u32 v146, 73728, v145
    s_waitcnt vmcnt(18)
    s_barrier
    ds_read_b64_tr_b16 a[40:41], v146 offset:0
    ds_read_b64_tr_b16 a[42:43], v146 offset:4608
    ds_read_b64_tr_b16 a[44:45], v146 offset:32
    ds_read_b64_tr_b16 a[46:47], v146 offset:4640
    ds_read_b64_tr_b16 a[48:49], v146 offset:64
    ds_read_b64_tr_b16 a[50:51], v146 offset:4672
    ds_read_b64_tr_b16 a[52:53], v146 offset:96
    ds_read_b64_tr_b16 a[54:55], v146 offset:4704
    ds_read_b64_tr_b16 a[56:57], v146 offset:128
    ds_read_b64_tr_b16 a[58:59], v146 offset:4736
    ds_read_b64_tr_b16 a[60:61], v146 offset:160
    ds_read_b64_tr_b16 a[62:63], v146 offset:4768
    ds_read_b64_tr_b16 a[64:65], v146 offset:192
    ds_read_b64_tr_b16 a[66:67], v146 offset:4800
    ds_read_b64_tr_b16 a[68:69], v146 offset:224
    ds_read_b64_tr_b16 a[70:71], v146 offset:4832
    s_waitcnt vmcnt(14)
    s_waitcnt lgkmcnt(12)
    v_mfma_f32_16x16x32_bf16 v[0:3], a[40:43], a[0:3], 0
    s_add_u32 m0, s97, 36864
    ds_read_b64_tr_b16 a[112:113], v146 offset:256
    ds_read_b64_tr_b16 a[114:115], v146 offset:4864
    v_mfma_f32_16x16x32_bf16 v[4:7], a[40:43], a[72:75], 0
    buffer_load_dwordx4 v225, s[80:83], s96 offen lds
    v_mfma_f32_16x16x32_bf16 v[8:11], a[40:43], a[144:147], 0
    s_bfe_u32 s5, s2, 0x30003
    s_lshl_b32 s5, s5, 2
    v_mfma_f32_16x16x32_bf16 v[12:15], a[40:43], a[216:219], 0
    s_add_u32 s5, s5, s32
    s_lshl_b32 s5, s5, 3
    v_mfma_f32_16x16x32_bf16 v[28:31], a[44:47], a[216:219], 0
    s_add_u32 m0, s97, 38912
    ds_read_b64_tr_b16 a[116:117], v146 offset:18432
    ds_read_b64_tr_b16 a[118:119], v146 offset:23040
    v_mfma_f32_16x16x32_bf16 v[24:27], a[44:47], a[144:147], 0
    buffer_load_dwordx4 v226, s[80:83], s96 offen lds
    v_mfma_f32_16x16x32_bf16 v[20:23], a[44:47], a[72:75], 0
    s_and_b32 s39, s2, 7
    s_add_u32 s5, s5, s39
    v_mfma_f32_16x16x32_bf16 v[16:19], a[44:47], a[0:3], 0
    s_waitcnt lgkmcnt(12)
    s_lshl_b32 s5, s5, 2
    s_lshr_b32 s39, s2, 6
    v_mfma_f32_16x16x32_bf16 v[32:35], a[48:51], a[0:3], 0
    s_add_u32 m0, s97, 40960
    ds_read_b64_tr_b16 a[40:41], v146 offset:18464
    ds_read_b64_tr_b16 a[42:43], v146 offset:23072
    v_mfma_f32_16x16x32_bf16 v[36:39], a[48:51], a[72:75], 0
    buffer_load_dwordx4 v227, s[80:83], s96 offen lds
    v_mfma_f32_16x16x32_bf16 v[40:43], a[48:51], a[144:147], 0
    s_add_u32 s5, s5, s39
    s_lshl_b32 s5, s5, 5
    v_mfma_f32_16x16x32_bf16 v[44:47], a[48:51], a[216:219], 0
    s_and_b32 s39, s4, 255
    s_cmp_eq_u32 s39, s2
    s_cselect_b32 s5, s5, 1048576
    v_mfma_f32_16x16x32_bf16 v[60:63], a[52:55], a[216:219], 0
    s_add_u32 m0, s97, 43008
    ds_read_b64_tr_b16 a[44:45], v146 offset:18496
    ds_read_b64_tr_b16 a[46:47], v146 offset:23104
    v_mfma_f32_16x16x32_bf16 v[56:59], a[52:55], a[144:147], 0
    buffer_load_dwordx4 v228, s[80:83], s96 offen lds
    v_mov_b32 v252, 3
    v_mfma_f32_16x16x32_bf16 v[52:55], a[52:55], a[72:75], 0
    s_bfe_u32 s35, s2, 0x20001
    s_and_b32 s38, s2, 1
    v_mfma_f32_16x16x32_bf16 v[48:51], a[52:55], a[0:3], 0
    s_waitcnt lgkmcnt(12)
    s_lshl_b32 s33, s38, 3
    s_lshr_b32 s40, s2, 5
    v_mfma_f32_16x16x32_bf16 v[64:67], a[56:59], a[0:3], 0
    s_mul_i32 m0, s89, 0x2400
    ds_read_b64_tr_b16 a[48:49], v146 offset:18528
    ds_read_b64_tr_b16 a[50:51], v146 offset:23136
    v_mfma_f32_16x16x32_bf16 v[68:71], a[56:59], a[72:75], 0
    s_add_u32 m0, m0, s97
    s_add_u32 s33, s33, s40
    s_bfe_u32 s34, s2, 0x20003
    v_mfma_f32_16x16x32_bf16 v[72:75], a[56:59], a[144:147], 0
    s_add_u32 m0, m0, 45056
    s_lshl_b32 s38, s33, 1
    s_add_u32 s38, s38, s89
    v_mfma_f32_16x16x32_bf16 v[76:79], a[56:59], a[216:219], 0
    buffer_load_dwordx4 v229, s[80:83], s96 offen lds
    v_mfma_f32_16x16x32_bf16 v[92:95], a[60:63], a[216:219], 0
    s_add_u32 m0, s97, 56320
    ds_read_b64_tr_b16 a[52:53], v146 offset:18560
    ds_read_b64_tr_b16 a[54:55], v146 offset:23168
    v_mfma_f32_16x16x32_bf16 v[88:91], a[60:63], a[144:147], 0
    buffer_load_dwordx4 v230, s[80:83], s96 offen lds
    v_mfma_f32_16x16x32_bf16 v[84:87], a[60:63], a[72:75], 0
    s_add_u32 m0, s97, 58368
    s_lshl_b32 s64, s38, 3
    s_lshl_b32 s39, s35, 1
    v_mfma_f32_16x16x32_bf16 v[80:83], a[60:63], a[0:3], 0
    s_waitcnt lgkmcnt(12)
    buffer_load_dwordx4 v231, s[80:83], s96 offen lds
    s_waitcnt vmcnt(7)
    s_mov_b64 exec, 1
    buffer_store_dword v252, off, s[92:95], s5 sc0 sc1
    s_mov_b64 exec, -1
    v_mfma_f32_16x16x32_bf16 v[96:99], a[64:67], a[0:3], 0
    s_add_u32 m0, s97, 60416
    ds_read_b64_tr_b16 a[56:57], v146 offset:18592
    ds_read_b64_tr_b16 a[58:59], v146 offset:23200
    v_mfma_f32_16x16x32_bf16 v[100:103], a[64:67], a[72:75], 0
    buffer_load_dwordx4 v232, s[80:83], s96 offen lds
    v_mfma_f32_16x16x32_bf16 v[104:107], a[64:67], a[144:147], 0
    s_add_u32 s64, s64, s39
    s_add_u32 s64, s64, s37
    v_mfma_f32_16x16x32_bf16 v[108:111], a[64:67], a[216:219], 0
    s_lshl_b32 s64, s64, 7
    v_min_u32 v248, 3, v144
    v_lshlrev_b32 v248, 5, v248
    v_mfma_f32_16x16x32_bf16 v[124:127], a[68:71], a[216:219], 0
    s_add_u32 m0, s97, 62464
    ds_read_b64_tr_b16 a[60:61], v146 offset:18624
    ds_read_b64_tr_b16 a[62:63], v146 offset:23232
    v_mfma_f32_16x16x32_bf16 v[120:123], a[68:71], a[144:147], 0
    buffer_load_dwordx4 v233, s[80:83], s96 offen lds
    s_add_u32 s96, s96, 73728
    v_mfma_f32_16x16x32_bf16 v[116:119], a[68:71], a[72:75], 0
    s_lshl_b32 s38, s38, 1
    s_lshl_b32 s40, s35, 6
    v_mfma_f32_16x16x32_bf16 v[112:115], a[68:71], a[0:3], 0
    s_waitcnt lgkmcnt(12)
    v_mfma_f32_16x16x32_bf16 v[128:131], a[112:115], a[0:3], 0
    ds_read_b64_tr_b16 a[64:65], v146 offset:18656
    ds_read_b64_tr_b16 a[66:67], v146 offset:23264
    v_mfma_f32_16x16x32_bf16 v[132:135], a[112:115], a[72:75], 0
    buffer_load_dwordx4 a[16:19], v149, s[16:19], s98 offen offset:0 sc1
    v_mfma_f32_16x16x32_bf16 v[136:139], a[112:115], a[144:147], 0
    s_add_u32 s38, s38, s40
    s_add_u32 s38, s38, s37
    s_mul_i32 s41, s38, 36864
    v_mfma_f32_16x16x32_bf16 v[140:143], a[112:115], a[216:219], 0
    s_mul_i32 s40, s34, 9216
    s_add_u32 s41, s41, s40
    v_mfma_f32_16x16x32_bf16 v[0:3], a[116:119], a[4:7], v[0:3]
    ds_read_b64_tr_b16 a[68:69], v146 offset:18688
    ds_read_b64_tr_b16 a[70:71], v146 offset:23296
    v_mfma_f32_16x16x32_bf16 v[4:7], a[116:119], a[76:79], v[4:7]
    buffer_load_dwordx4 a[88:91], v149, s[16:19], s99 offen offset:0 sc1
    v_mfma_f32_16x16x32_bf16 v[8:11], a[116:119], a[148:151], v[8:11]
    s_add_u32 s36, s41, 36864
    v_add_u32 v169, 145408, v145
    v_mfma_f32_16x16x32_bf16 v[12:15], a[116:119], a[220:223], v[12:15]
    s_waitcnt lgkmcnt(12)
    s_lshl_b32 s52, s32, 10
    s_add_u32 s52, s52, 143360
    s_barrier
    v_mfma_f32_16x16x32_bf16 v[28:31], a[40:43], a[220:223], v[28:31]
    s_add_u32 m0, s97, 145408
    ds_read_b64_tr_b16 a[112:113], v145 offset:0
    ds_read_b64_tr_b16 a[114:115], v145 offset:4608
    v_mfma_f32_16x16x32_bf16 v[24:27], a[40:43], a[148:151], v[24:27]
    buffer_load_dwordx4 v225, s[80:83], s96 offen lds
    v_mfma_f32_16x16x32_bf16 v[20:23], a[40:43], a[76:79], v[20:23]
    s_cmp_lt_u32 s32, 2
    s_cselect_b32 s52, s52, 145216
    v_mfma_f32_16x16x32_bf16 v[16:19], a[40:43], a[4:7], v[16:19]
    s_mul_i32 s40, s32, 4096
    v_add_u32 v148, s40, v149
    v_xor_b32 v179, 8192, v148
    v_mfma_f32_16x16x32_bf16 v[32:35], a[44:47], a[4:7], v[32:35]
    ds_read_b64_tr_b16 a[116:117], v145 offset:32
    ds_read_b64_tr_b16 a[118:119], v145 offset:4640
    v_mfma_f32_16x16x32_bf16 v[36:39], a[44:47], a[76:79], v[36:39]
    buffer_load_dwordx4 a[160:163], v149, s[16:19], s100 offen offset:0 sc1
    v_mfma_f32_16x16x32_bf16 v[40:43], a[44:47], a[148:151], v[40:43]
    s_add_u32 m0, s97, 147456
    s_add_u32 s12, s10, 41943040
    s_addc_u32 s13, s11, 0
    v_mfma_f32_16x16x32_bf16 v[44:47], a[44:47], a[220:223], v[44:47]
    s_waitcnt lgkmcnt(12)
    buffer_load_dwordx4 v226, s[80:83], s96 offen lds
    v_mfma_f32_16x16x32_bf16 v[60:63], a[48:51], a[220:223], v[60:63]
    s_add_u32 m0, s97, 149504
    ds_read_b64_tr_b16 a[40:41], v145 offset:64
    ds_read_b64_tr_b16 a[42:43], v145 offset:4672
    v_mfma_f32_16x16x32_bf16 v[56:59], a[48:51], a[148:151], v[56:59]
    buffer_load_dwordx4 v227, s[80:83], s96 offen lds
    v_mfma_f32_16x16x32_bf16 v[52:55], a[48:51], a[76:79], v[52:55]
    s_mov_b32 s14, 9437184
    s_mov_b32 s15, 0x00020000
    v_mfma_f32_16x16x32_bf16 v[48:51], a[48:51], a[4:7], v[48:51]
    s_add_u32 s24, s10, 8388608
    s_addc_u32 s25, s11, 0
    buffer_load_dword v249, v248, s[92:95], s64 offen sc1
    v_mfma_f32_16x16x32_bf16 v[64:67], a[52:55], a[4:7], v[64:67]
    ds_read_b64_tr_b16 a[44:45], v145 offset:96
    ds_read_b64_tr_b16 a[46:47], v145 offset:4704
    v_mfma_f32_16x16x32_bf16 v[68:71], a[52:55], a[76:79], v[68:71]
    buffer_load_dwordx4 a[232:235], v149, s[16:19], s101 offen offset:0 sc1
    v_mfma_f32_16x16x32_bf16 v[72:75], a[52:55], a[148:151], v[72:75]
    s_mov_b32 s26, 7077888
    s_mov_b32 s27, 0x00020000
    v_mfma_f32_16x16x32_bf16 v[76:79], a[52:55], a[220:223], v[76:79]
    s_waitcnt lgkmcnt(12)
    s_bitcmp1_b32 s4, 9
    s_cselect_b32 s26, 0, s26
    v_mfma_f32_16x16x32_bf16 v[92:95], a[56:59], a[220:223], v[92:95]
    ds_read_b64_tr_b16 a[48:49], v145 offset:128
    ds_read_b64_tr_b16 a[50:51], v145 offset:4736
    v_mfma_f32_16x16x32_bf16 v[88:91], a[56:59], a[148:151], v[88:91]
    buffer_load_dwordx4 a[20:23], v149, s[16:19], s98 offen offset:1024 sc1
    v_mfma_f32_16x16x32_bf16 v[84:87], a[56:59], a[76:79], v[84:87]
    s_add_u32 s28, s10, 16777216
    s_addc_u32 s29, s11, 0
    v_mfma_f32_16x16x32_bf16 v[80:83], a[56:59], a[4:7], v[80:83]
    s_mov_b32 s30, 2359296
    s_mov_b32 s31, 0x00020000
    v_mfma_f32_16x16x32_bf16 v[96:99], a[60:63], a[4:7], v[96:99]
    s_add_u32 m0, s97, 151552
    ds_read_b64_tr_b16 a[52:53], v145 offset:160
    ds_read_b64_tr_b16 a[54:55], v145 offset:4768
    v_mfma_f32_16x16x32_bf16 v[100:103], a[60:63], a[76:79], v[100:103]
    buffer_load_dwordx4 v228, s[80:83], s96 offen lds
    v_mfma_f32_16x16x32_bf16 v[104:107], a[60:63], a[148:151], v[104:107]
    s_add_u32 s56, s10, 4194304
    s_addc_u32 s57, s11, 0
    v_mfma_f32_16x16x32_bf16 v[108:111], a[60:63], a[220:223], v[108:111]
    s_waitcnt lgkmcnt(12)
    s_mov_b32 s58, 663552
    s_mov_b32 s59, 0x00020000
    v_mfma_f32_16x16x32_bf16 v[124:127], a[64:67], a[220:223], v[124:127]
    ds_read_b64_tr_b16 a[56:57], v145 offset:192
    ds_read_b64_tr_b16 a[58:59], v145 offset:4800
    v_mfma_f32_16x16x32_bf16 v[120:123], a[64:67], a[148:151], v[120:123]
    buffer_load_dwordx4 a[92:95], v149, s[16:19], s99 offen offset:1024 sc1
    v_mfma_f32_16x16x32_bf16 v[116:119], a[64:67], a[76:79], v[116:119]
    s_and_b32 s42, s2, 7
    s_lshl_b32 s42, s42, 8
    v_mfma_f32_16x16x32_bf16 v[112:115], a[64:67], a[4:7], v[112:115]
    s_andn2_b32 s43, s2, 15
    s_add_u32 s42, s42, s43
    v_mfma_f32_16x16x32_bf16 v[128:131], a[68:71], a[4:7], v[128:131]
    s_mul_i32 m0, s89, 0xfffec400
    ds_read_b64_tr_b16 a[60:61], v145 offset:224
    ds_read_b64_tr_b16 a[62:63], v145 offset:4832
    v_mfma_f32_16x16x32_bf16 v[132:135], a[68:71], a[76:79], v[132:135]
    s_add_u32 m0, m0, s97
    s_bfe_u32 s43, s2, 0x10003
    s_add_u32 s42, s42, s43
    v_mfma_f32_16x16x32_bf16 v[136:139], a[68:71], a[148:151], v[136:139]
    s_add_u32 m0, m0, 153600
    v_mfma_f32_16x16x32_bf16 v[140:143], a[68:71], a[220:223], v[140:143]
    s_waitcnt lgkmcnt(12)
    buffer_load_dwordx4 v229, s[80:83], s96 offen lds
    v_mfma_f32_16x16x32_bf16 v[0:3], a[112:115], a[8:11], v[0:3]
    ds_read_b64_tr_b16 a[64:65], v145 offset:256
    ds_read_b64_tr_b16 a[66:67], v145 offset:4864
    v_mfma_f32_16x16x32_bf16 v[4:7], a[112:115], a[80:83], v[4:7]
    buffer_load_dwordx4 a[164:167], v149, s[16:19], s100 offen offset:1024 sc1
    v_mfma_f32_16x16x32_bf16 v[8:11], a[112:115], a[152:155], v[8:11]
    s_add_u32 m0, s97, 74752
    v_mfma_f32_16x16x32_bf16 v[12:15], a[112:115], a[224:227], v[12:15]
    buffer_load_dwordx4 v230, s[80:83], s96 offen lds
    v_mfma_f32_16x16x32_bf16 v[28:31], a[116:119], a[224:227], v[28:31]
    ds_read_b64_tr_b16 a[68:69], v145 offset:18432
    ds_read_b64_tr_b16 a[70:71], v145 offset:23040
    v_mfma_f32_16x16x32_bf16 v[24:27], a[116:119], a[152:155], v[24:27]
    buffer_load_dwordx4 a[236:239], v149, s[16:19], s101 offen offset:1024 sc1
    v_mfma_f32_16x16x32_bf16 v[20:23], a[116:119], a[80:83], v[20:23]
    s_cmp_lt_u32 s32, 2
    s_cselect_b32 s68, -1, 1
    s_cselect_b32 s69, 0xffff, 0
    v_mfma_f32_16x16x32_bf16 v[16:19], a[116:119], a[8:11], v[16:19]
    s_waitcnt lgkmcnt(12)
    s_cmp_eq_u32 s32, 0
    s_cselect_b32 s69, -1, s69
    v_mfma_f32_16x16x32_bf16 v[32:35], a[40:43], a[8:11], v[32:35]
    s_add_u32 m0, s97, 76800
    ds_read_b64_tr_b16 a[112:113], v145 offset:18464
    ds_read_b64_tr_b16 a[114:115], v145 offset:23072
    v_mfma_f32_16x16x32_bf16 v[36:39], a[40:43], a[80:83], v[36:39]
    buffer_load_dwordx4 v231, s[80:83], s96 offen lds
    v_mfma_f32_16x16x32_bf16 v[40:43], a[40:43], a[152:155], v[40:43]
    s_sub_u32 s43, s42, 14
    s_max_i32 s65, s43, 0
    v_mfma_f32_16x16x32_bf16 v[44:47], a[40:43], a[224:227], v[44:47]
    s_lshr_b32 s65, s65, 6
    s_lshr_b32 s38, s42, 6
    v_mfma_f32_16x16x32_bf16 v[60:63], a[44:47], a[224:227], v[60:63]
    s_add_u32 m0, s97, 78848
    ds_read_b64_tr_b16 a[116:117], v145 offset:18496
    ds_read_b64_tr_b16 a[118:119], v145 offset:23104
    v_mfma_f32_16x16x32_bf16 v[56:59], a[44:47], a[152:155], v[56:59]
    buffer_load_dwordx4 v232, s[80:83], s96 offen lds
    v_mfma_f32_16x16x32_bf16 v[52:55], a[44:47], a[80:83], v[52:55]
    s_sub_u32 s38, s38, s65
    s_lshl_b32 s38, s38, 5
    v_mfma_f32_16x16x32_bf16 v[48:51], a[44:47], a[8:11], v[48:51]
    s_waitcnt lgkmcnt(12)
    s_add_u32 s38, s38, 31
    v_and_b32 v250, s38, v144
    v_mfma_f32_16x16x32_bf16 v[64:67], a[48:51], a[8:11], v[64:67]
    s_add_u32 m0, s97, 80896
    ds_read_b64_tr_b16 a[40:41], v145 offset:18528
    ds_read_b64_tr_b16 a[42:43], v145 offset:23136
    v_mfma_f32_16x16x32_bf16 v[68:71], a[48:51], a[80:83], v[68:71]
    buffer_load_dwordx4 v233, s[80:83], s96 offen lds
    s_add_u32 s96, s96, 73728
    v_mfma_f32_16x16x32_bf16 v[72:75], a[48:51], a[152:155], v[72:75]
    v_lshlrev_b32 v250, 5, v250
    s_lshl_b32 s65, s65, 10
    v_mfma_f32_16x16x32_bf16 v[76:79], a[48:51], a[224:227], v[76:79]
    s_mul_i32 s39, s34, 9
    s_add_u32 s67, s39, s32
    v_mfma_f32_16x16x32_bf16 v[92:95], a[52:55], a[224:227], v[92:95]
    ds_read_b64_tr_b16 a[44:45], v145 offset:18560
    ds_read_b64_tr_b16 a[46:47], v145 offset:23168
    v_mfma_f32_16x16x32_bf16 v[88:91], a[52:55], a[152:155], v[88:91]
    buffer_load_dwordx4 a[24:27], v149, s[16:19], s98 offen offset:2048 sc1
    v_mfma_f32_16x16x32_bf16 v[84:87], a[52:55], a[80:83], v[84:87]
    s_mul_i32 s47, s67, 18432
    s_add_u32 s48, s47, 18432
    v_mfma_f32_16x16x32_bf16 v[80:83], a[52:55], a[8:11], v[80:83]
    s_waitcnt lgkmcnt(12)
    v_mfma_f32_16x16x32_bf16 v[96:99], a[56:59], a[8:11], v[96:99]
    ds_read_b64_tr_b16 a[48:49], v145 offset:18592
    ds_read_b64_tr_b16 a[50:51], v145 offset:23200
    v_mfma_f32_16x16x32_bf16 v[100:103], a[56:59], a[80:83], v[100:103]
    buffer_load_dwordx4 a[96:99], v149, s[16:19], s99 offen offset:2048 sc1
    v_mfma_f32_16x16x32_bf16 v[104:107], a[56:59], a[152:155], v[104:107]
    s_add_u32 s49, s47, 92160
    s_cmp_eq_u32 s32, 0
    s_cselect_b32 s47, s47, 1073741824
    v_mfma_f32_16x16x32_bf16 v[108:111], a[56:59], a[224:227], v[108:111]
    s_and_b32 s39, s4, 0x100
    s_or_b32 s39, s39, s32
    v_mfma_f32_16x16x32_bf16 v[124:127], a[60:63], a[224:227], v[124:127]
    ds_read_b64_tr_b16 a[52:53], v145 offset:18624
    ds_read_b64_tr_b16 a[54:55], v145 offset:23232
    v_mfma_f32_16x16x32_bf16 v[120:123], a[60:63], a[152:155], v[120:123]
    s_lshl_b32 s39, s39, 12
    s_and_b32 s40, s2, 0x38
    v_mfma_f32_16x16x32_bf16 v[116:119], a[60:63], a[80:83], v[116:119]
    s_lshl_b32 s40, s40, 2
    s_add_u32 s39, s39, s40
    v_mov_b32 v254, 1
    v_mfma_f32_16x16x32_bf16 v[112:115], a[60:63], a[8:11], v[112:115]
    s_waitcnt lgkmcnt(12)
    v_mfma_f32_16x16x32_bf16 v[128:131], a[64:67], a[8:11], v[128:131]
    ds_read_b64_tr_b16 a[56:57], v145 offset:18656
    ds_read_b64_tr_b16 a[58:59], v145 offset:23264
    v_mfma_f32_16x16x32_bf16 v[132:135], a[64:67], a[80:83], v[132:135]
    s_mov_b64 exec, 1
    buffer_atomic_add v254, off, s[84:87], s39 offset:4 sc1
    s_mov_b64 exec, -1
    v_mfma_f32_16x16x32_bf16 v[136:139], a[64:67], a[152:155], v[136:139]
    buffer_load_dwordx4 a[168:171], v149, s[16:19], s100 offen offset:2048 sc1
    v_mfma_f32_16x16x32_bf16 v[140:143], a[64:67], a[224:227], v[140:143]
    s_mul_i32 s43, s43, 3456
    s_add_u32 s43, s43, 1152
    s_waitcnt vmcnt(15)
    v_cmp_gt_u32 vcc, 2, v249
    s_nop 4
    s_cbranch_vccnz C2_spin
C2_ret:
    v_mfma_f32_16x16x32_bf16 v[0:3], a[68:71], a[12:15], v[0:3]
    ds_read_b64_tr_b16 a[60:61], v145 offset:18688
    ds_read_b64_tr_b16 a[62:63], v145 offset:23296
    v_mfma_f32_16x16x32_bf16 v[4:7], a[68:71], a[84:87], v[4:7]
    s_lshl_b32 s45, s32, 6
    v_add_u32 v244, s45, v144
    v_mfma_f32_16x16x32_bf16 v[8:11], a[68:71], a[156:159], v[8:11]
    s_lshl_b32 s45, s32, 10
    s_add_u32 s45, s45, 110592
    v_mul_u32_u24 v180, 7282, v244
    v_mfma_f32_16x16x32_bf16 v[12:15], a[68:71], a[228:231], v[12:15]
    s_waitcnt lgkmcnt(12)
    v_lshrrev_b32 v180, 20, v180
    v_mul_u32_u24 v180, 4608, v180
    s_barrier
    v_mfma_f32_16x16x32_bf16 v[28:31], a[112:115], a[228:231], v[28:31]
    ds_read_b64_tr_b16 a[64:65], v145 offset:36864
    ds_read_b64_tr_b16 a[66:67], v145 offset:41472
    v_mfma_f32_16x16x32_bf16 v[24:27], a[112:115], a[156:159], v[24:27]
    buffer_load_dwordx4 a[240:243], v149, s[16:19], s101 offen offset:2048 sc1
    v_lshl_add_u32 v180, v244, 4, v180
    v_mfma_f32_16x16x32_bf16 v[20:23], a[112:115], a[84:87], v[20:23]
    s_add_u32 m0, s97, 92160
    v_add_u32 v180, s43, v180
    v_add_u32 v244, 256, v244
    v_mfma_f32_16x16x32_bf16 v[16:19], a[112:115], a[12:15], v[16:19]
    buffer_load_dwordx4 v225, s[80:83], s96 offen lds
    v_mul_u32_u24 v181, 7282, v244
    v_mfma_f32_16x16x32_bf16 v[32:35], a[116:119], a[12:15], v[32:35]
    ds_read_b64_tr_b16 a[68:69], v145 offset:36896
    ds_read_b64_tr_b16 a[70:71], v145 offset:41504
    v_mfma_f32_16x16x32_bf16 v[36:39], a[116:119], a[84:87], v[36:39]
    buffer_load_dwordx4 a[28:31], v149, s[16:19], s98 offen offset:3072 sc1
    v_lshrrev_b32 v181, 20, v181
    v_mfma_f32_16x16x32_bf16 v[40:43], a[116:119], a[156:159], v[40:43]
    s_add_u32 s98, s98, 4096
    v_mul_u32_u24 v181, 4608, v181
    v_lshl_add_u32 v181, v244, 4, v181
    v_mfma_f32_16x16x32_bf16 v[44:47], a[116:119], a[228:231], v[44:47]
    s_waitcnt lgkmcnt(12)
    v_add_u32 v181, s43, v181
    v_add_u32 v244, 256, v244
    v_mfma_f32_16x16x32_bf16 v[60:63], a[40:43], a[228:231], v[60:63]
    s_add_u32 m0, s97, 94208
    ds_read_b64_tr_b16 a[112:113], v145 offset:36928
    ds_read_b64_tr_b16 a[114:115], v145 offset:41536
    v_mfma_f32_16x16x32_bf16 v[56:59], a[40:43], a[156:159], v[56:59]
    buffer_load_dwordx4 v226, s[80:83], s96 offen lds
    v_mul_u32_u24 v182, 7282, v244
    v_mfma_f32_16x16x32_bf16 v[52:55], a[40:43], a[84:87], v[52:55]
    v_lshrrev_b32 v182, 20, v182
    v_mul_u32_u24 v182, 4608, v182
    v_mfma_f32_16x16x32_bf16 v[48:51], a[40:43], a[12:15], v[48:51]
    v_lshl_add_u32 v182, v244, 4, v182
    v_add_u32 v182, s43, v182
    v_mfma_f32_16x16x32_bf16 v[64:67], a[44:47], a[12:15], v[64:67]
    ds_read_b64_tr_b16 a[116:117], v145 offset:36960
    ds_read_b64_tr_b16 a[118:119], v145 offset:41568
    v_mfma_f32_16x16x32_bf16 v[68:71], a[44:47], a[84:87], v[68:71]
    buffer_load_dwordx4 a[100:103], v149, s[16:19], s99 offen offset:3072 sc1
    v_add_u32 v244, 256, v244
    v_mfma_f32_16x16x32_bf16 v[72:75], a[44:47], a[156:159], v[72:75]
    s_add_u32 s99, s99, 4096
    v_mul_u32_u24 v183, 7282, v244
    v_lshrrev_b32 v183, 20, v183
    v_mfma_f32_16x16x32_bf16 v[76:79], a[44:47], a[228:231], v[76:79]
    s_waitcnt lgkmcnt(12)
    v_mul_u32_u24 v183, 4608, v183
    v_lshl_add_u32 v183, v244, 4, v183
    v_mfma_f32_16x16x32_bf16 v[92:95], a[48:51], a[228:231], v[92:95]
    s_add_u32 m0, s97, 96256
    ds_read_b64_tr_b16 a[40:41], v145 offset:36992
    ds_read_b64_tr_b16 a[42:43], v145 offset:41600
    v_mfma_f32_16x16x32_bf16 v[88:91], a[48:51], a[156:159], v[88:91]
    buffer_load_dwordx4 v227, s[80:83], s96 offen lds
    v_add_u32 v183, s43, v183
    v_mfma_f32_16x16x32_bf16 v[84:87], a[48:51], a[84:87], v[84:87]
    v_add_u32 v244, 256, v244
    v_mul_u32_u24 v184, 7282, v244
    v_mfma_f32_16x16x32_bf16 v[80:83], a[48:51], a[12:15], v[80:83]
    v_lshrrev_b32 v184, 20, v184
    v_mul_u32_u24 v184, 4608, v184
    v_mfma_f32_16x16x32_bf16 v[96:99], a[52:55], a[12:15], v[96:99]
    ds_read_b64_tr_b16 a[44:45], v145 offset:37024
    ds_read_b64_tr_b16 a[46:47], v145 offset:41632
    v_mfma_f32_16x16x32_bf16 v[100:103], a[52:55], a[84:87], v[100:103]
    buffer_load_dwordx4 a[172:175], v149, s[16:19], s100 offen offset:3072 sc1
    v_lshl_add_u32 v184, v244, 4, v184
    v_mfma_f32_16x16x32_bf16 v[104:107], a[52:55], a[156:159], v[104:107]
    s_add_u32 s100, s100, 4096
    v_add_u32 v184, s43, v184
    v_add_u32 v244, 256, v244
    v_mfma_f32_16x16x32_bf16 v[108:111], a[52:55], a[228:231], v[108:111]
    s_waitcnt lgkmcnt(12)
    v_mul_u32_u24 v185, 7282, v244
    v_lshrrev_b32 v185, 20, v185
    v_mfma_f32_16x16x32_bf16 v[124:127], a[56:59], a[228:231], v[124:127]
    ds_read_b64_tr_b16 a[48:49], v145 offset:37056
    ds_read_b64_tr_b16 a[50:51], v145 offset:41664
    v_mfma_f32_16x16x32_bf16 v[120:123], a[56:59], a[156:159], v[120:123]
    buffer_load_dwordx4 a[244:247], v149, s[16:19], s101 offen offset:3072 sc1
    v_mul_u32_u24 v185, 4608, v185
    v_mfma_f32_16x16x32_bf16 v[116:119], a[56:59], a[84:87], v[116:119]
    s_add_u32 s101, s101, 4096
    v_lshl_add_u32 v185, v244, 4, v185
    v_add_u32 v185, s43, v185
    v_mfma_f32_16x16x32_bf16 v[112:115], a[56:59], a[12:15], v[112:115]
    s_add_u32 m0, s97, 98304
    v_add_u32 v244, 256, v244
    v_mul_u32_u24 v186, 7282, v244
    v_mfma_f32_16x16x32_bf16 v[128:131], a[60:63], a[12:15], v[128:131]
    ds_read_b64_tr_b16 a[52:53], v145 offset:37088
    ds_read_b64_tr_b16 a[54:55], v145 offset:41696
    v_mfma_f32_16x16x32_bf16 v[132:135], a[60:63], a[84:87], v[132:135]
    buffer_load_dwordx4 v228, s[80:83], s96 offen lds
    v_lshrrev_b32 v186, 20, v186
    v_mfma_f32_16x16x32_bf16 v[136:139], a[60:63], a[156:159], v[136:139]
    s_mul_i32 m0, s89, 0xfffe7400
    v_mul_u32_u24 v186, 4608, v186
    v_lshl_add_u32 v186, v244, 4, v186
    v_mfma_f32_16x16x32_bf16 v[140:143], a[60:63], a[228:231], v[140:143]
    s_waitcnt vmcnt(23)
    s_waitcnt lgkmcnt(12)
    v_add_u32 v186, s43, v186
    v_mfma_f32_16x16x32_bf16 v[0:3], a[64:67], a[16:19], v[0:3]
    s_add_u32 m0, m0, s97
    ds_read_b64_tr_b16 a[56:57], v145 offset:37120
    ds_read_b64_tr_b16 a[58:59], v145 offset:41728
    v_mfma_f32_16x16x32_bf16 v[4:7], a[64:67], a[88:91], v[4:7]
    s_add_u32 m0, m0, 100352
    v_add_u32 v244, 256, v244
    v_mul_u32_u24 v187, 7282, v244
    v_mfma_f32_16x16x32_bf16 v[8:11], a[64:67], a[160:163], v[8:11]
    buffer_load_dwordx4 v229, s[80:83], s96 offen lds
    v_lshrrev_b32 v187, 20, v187
    v_mfma_f32_16x16x32_bf16 v[12:15], a[64:67], a[232:235], v[12:15]
    s_add_u32 m0, s97, 1024
    v_mul_u32_u24 v187, 4608, v187
    v_lshl_add_u32 v187, v244, 4, v187
    buffer_load_dword v249, v248, s[92:95], s64 offen sc1
    buffer_load_dword v251, v250, s[92:95], s65 offen sc1
    v_mfma_f32_16x16x32_bf16 v[28:31], a[68:71], a[232:235], v[28:31]
    ds_read_b64_tr_b16 a[60:61], v145 offset:55296
    ds_read_b64_tr_b16 a[62:63], v145 offset:59904
    v_mfma_f32_16x16x32_bf16 v[24:27], a[68:71], a[160:163], v[24:27]
    buffer_load_dwordx4 v230, s[80:83], s96 offen lds
    v_add_u32 v187, s43, v187
    v_mfma_f32_16x16x32_bf16 v[20:23], a[68:71], a[88:91], v[20:23]
    s_add_u32 m0, s97, 3072
    v_add_u32 v244, 256, v244
    v_min_u32 v244, 2159, v244
    v_mfma_f32_16x16x32_bf16 v[16:19], a[68:71], a[16:19], v[16:19]
    s_waitcnt lgkmcnt(12)
    buffer_load_dwordx4 v231, s[80:83], s96 offen lds
    v_mul_u32_u24 v188, 7282, v244
    v_mfma_f32_16x16x32_bf16 v[32:35], a[112:115], a[16:19], v[32:35]
    s_add_u32 m0, s97, 5120
    ds_read_b64_tr_b16 a[64:65], v145 offset:55328
    ds_read_b64_tr_b16 a[66:67], v145 offset:59936
    v_mfma_f32_16x16x32_bf16 v[36:39], a[112:115], a[88:91], v[36:39]
    buffer_load_dwordx4 v232, s[80:83], s96 offen lds
    v_lshrrev_b32 v188, 20, v188
    v_mfma_f32_16x16x32_bf16 v[40:43], a[112:115], a[160:163], v[40:43]
    v_mul_u32_u24 v188, 4608, v188
    v_lshl_add_u32 v188, v244, 4, v188
    v_mfma_f32_16x16x32_bf16 v[44:47], a[112:115], a[232:235], v[44:47]
    v_add_u32 v188, s43, v188
    v_mfma_f32_16x16x32_bf16 v[60:63], a[116:119], a[232:235], v[60:63]
    s_add_u32 m0, s97, 7168
    ds_read_b64_tr_b16 a[68:69], v145 offset:55360
    ds_read_b64_tr_b16 a[70:71], v145 offset:59968
    v_mfma_f32_16x16x32_bf16 v[56:59], a[116:119], a[160:163], v[56:59]
    buffer_load_dwordx4 v233, s[80:83], s96 offen lds
    s_add_u32 s96, s96, 73728
    v_mfma_f32_16x16x32_bf16 v[52:55], a[116:119], a[88:91], v[52:55]
    s_add_u32 s42, s42, s32
    s_add_u32 s42, s42, s32
    v_mfma_f32_16x16x32_bf16 v[48:51], a[116:119], a[16:19], v[48:51]
    s_waitcnt lgkmcnt(12)
    v_and_b32 v246, 31, v144
    s_mul_i32 s46, s42, 3456
    v_mfma_f32_16x16x32_bf16 v[64:67], a[40:43], a[16:19], v[64:67]
    ds_read_b64_tr_b16 a[112:113], v145 offset:55392
    ds_read_b64_tr_b16 a[114:115], v145 offset:60000
    v_mfma_f32_16x16x32_bf16 v[68:71], a[40:43], a[88:91], v[68:71]
    buffer_load_dwordx4 a[32:35], v149, s[16:19], s98 offen offset:0 sc1
    v_mul_u32_u24 v246, 36, v246
    v_mfma_f32_16x16x32_bf16 v[72:75], a[40:43], a[160:163], v[72:75]
    v_lshrrev_b32 v150, 5, v144
    v_mfma_f32_16x16x32_bf16 v[76:79], a[40:43], a[232:235], v[76:79]
    s_add_u32 s43, s32, 7
    s_mul_i32 s43, s43, 2304
    v_mfma_f32_16x16x32_bf16 v[92:95], a[44:47], a[232:235], v[92:95]
    ds_read_b64_tr_b16 a[116:117], v145 offset:55424
    ds_read_b64_tr_b16 a[118:119], v145 offset:60032
    v_mfma_f32_16x16x32_bf16 v[88:91], a[44:47], a[160:163], v[88:91]
    buffer_load_dwordx4 a[104:107], v149, s[16:19], s99 offen offset:0 sc1
    v_mfma_f32_16x16x32_bf16 v[84:87], a[44:47], a[88:91], v[84:87]
    s_add_u32 s43, s43, 110592
    v_mul_u32_u24 v189, 9216, v150
    v_sub_u32 v189, v246, v189
    v_mfma_f32_16x16x32_bf16 v[80:83], a[44:47], a[16:19], v[80:83]
    s_waitcnt lgkmcnt(12)
    v_add_u32 v189, s43, v189
    v_mfma_f32_16x16x32_bf16 v[96:99], a[48:51], a[16:19], v[96:99]
    ds_read_b64_tr_b16 a[40:41], v145 offset:55456
    ds_read_b64_tr_b16 a[42:43], v145 offset:60064
    v_mfma_f32_16x16x32_bf16 v[100:103], a[48:51], a[88:91], v[100:103]
    s_mul_i32 s61, s42, 1152
    s_add_u32 s62, s61, 9216
    s_mov_b32 s63, 0xffff0000
    v_mfma_f32_16x16x32_bf16 v[104:107], a[48:51], a[160:163], v[104:107]
    v_mfma_f32_16x16x32_bf16 v[108:111], a[48:51], a[232:235], v[108:111]
    v_mfma_f32_16x16x32_bf16 v[124:127], a[52:55], a[232:235], v[124:127]
    ds_read_b64_tr_b16 a[44:45], v145 offset:55488
    ds_read_b64_tr_b16 a[46:47], v145 offset:60096
    v_mfma_f32_16x16x32_bf16 v[120:123], a[52:55], a[160:163], v[120:123]
    buffer_load_dwordx4 a[176:179], v149, s[16:19], s100 offen offset:0 sc1
    v_mfma_f32_16x16x32_bf16 v[116:119], a[52:55], a[88:91], v[116:119]
    v_mfma_f32_16x16x32_bf16 v[112:115], a[52:55], a[16:19], v[112:115]
    s_waitcnt lgkmcnt(12)
    v_mfma_f32_16x16x32_bf16 v[128:131], a[56:59], a[16:19], v[128:131]
    ds_read_b64_tr_b16 a[48:49], v145 offset:55520
    ds_read_b64_tr_b16 a[50:51], v145 offset:60128
    v_mfma_f32_16x16x32_bf16 v[132:135], a[56:59], a[88:91], v[132:135]
    v_mfma_f32_16x16x32_bf16 v[136:139], a[56:59], a[160:163], v[136:139]
    v_mfma_f32_16x16x32_bf16 v[140:143], a[56:59], a[232:235], v[140:143]
    s_waitcnt vmcnt(26)
    v_mfma_f32_16x16x32_bf16 v[0:3], a[60:63], a[20:23], v[0:3]
    ds_read_b64_tr_b16 a[52:53], v145 offset:55552
    ds_read_b64_tr_b16 a[54:55], v145 offset:60160
    v_mfma_f32_16x16x32_bf16 v[4:7], a[60:63], a[92:95], v[4:7]
    buffer_load_dwordx4 a[248:251], v149, s[16:19], s101 offen offset:0 sc1
    v_mfma_f32_16x16x32_bf16 v[8:11], a[60:63], a[164:167], v[8:11]
    v_mfma_f32_16x16x32_bf16 v[12:15], a[60:63], a[236:239], v[12:15]
    s_waitcnt lgkmcnt(12)
    s_waitcnt vmcnt(24)
    s_barrier
    v_mfma_f32_16x16x32_bf16 v[28:31], a[64:67], a[236:239], v[28:31]
    ds_read_b64_tr_b16 a[56:57], v169 offset:0
    ds_read_b64_tr_b16 a[58:59], v169 offset:4608
    v_mfma_f32_16x16x32_bf16 v[24:27], a[64:67], a[164:167], v[24:27]
    buffer_load_dwordx4 a[36:39], v149, s[16:19], s98 offen offset:1024 sc1
    v_mfma_f32_16x16x32_bf16 v[20:23], a[64:67], a[92:95], v[20:23]
    s_add_u32 m0, s97, 18432
    v_mfma_f32_16x16x32_bf16 v[16:19], a[64:67], a[20:23], v[16:19]
    buffer_load_dwordx4 v225, s[80:83], s96 offen lds
    v_mfma_f32_16x16x32_bf16 v[32:35], a[68:71], a[20:23], v[32:35]
    s_add_u32 m0, s97, 20480
    ds_read_b64_tr_b16 a[60:61], v169 offset:32
    ds_read_b64_tr_b16 a[62:63], v169 offset:4640
    v_mfma_f32_16x16x32_bf16 v[36:39], a[68:71], a[92:95], v[36:39]
    buffer_load_dwordx4 v226, s[80:83], s96 offen lds
    v_mfma_f32_16x16x32_bf16 v[40:43], a[68:71], a[164:167], v[40:43]
    v_mfma_f32_16x16x32_bf16 v[44:47], a[68:71], a[236:239], v[44:47]
    s_waitcnt lgkmcnt(12)
    v_mfma_f32_16x16x32_bf16 v[60:63], a[112:115], a[236:239], v[60:63]
    ds_read_b64_tr_b16 a[64:65], v169 offset:64
    ds_read_b64_tr_b16 a[66:67], v169 offset:4672
    v_mfma_f32_16x16x32_bf16 v[56:59], a[112:115], a[164:167], v[56:59]
    buffer_load_dwordx4 a[108:111], v149, s[16:19], s99 offen offset:1024 sc1
    v_mfma_f32_16x16x32_bf16 v[52:55], a[112:115], a[92:95], v[52:55]
    v_mfma_f32_16x16x32_bf16 v[48:51], a[112:115], a[20:23], v[48:51]
    v_mfma_f32_16x16x32_bf16 v[64:67], a[116:119], a[20:23], v[64:67]
    s_add_u32 m0, s97, 22528
    ds_read_b64_tr_b16 a[68:69], v169 offset:96
    ds_read_b64_tr_b16 a[70:71], v169 offset:4704
    v_mfma_f32_16x16x32_bf16 v[68:71], a[116:119], a[92:95], v[68:71]
    buffer_load_dwordx4 v227, s[80:83], s96 offen lds
    v_mfma_f32_16x16x32_bf16 v[72:75], a[116:119], a[164:167], v[72:75]
    v_mfma_f32_16x16x32_bf16 v[76:79], a[116:119], a[236:239], v[76:79]
    s_waitcnt lgkmcnt(12)
    v_mfma_f32_16x16x32_bf16 v[92:95], a[40:43], a[236:239], v[92:95]
    ds_read_b64_tr_b16 a[112:113], v169 offset:128
    ds_read_b64_tr_b16 a[114:115], v169 offset:4736
    v_mfma_f32_16x16x32_bf16 v[88:91], a[40:43], a[164:167], v[88:91]
    buffer_load_dwordx4 a[180:183], v149, s[16:19], s100 offen offset:1024 sc1
    v_mfma_f32_16x16x32_bf16 v[84:87], a[40:43], a[92:95], v[84:87]
    v_mfma_f32_16x16x32_bf16 v[80:83], a[40:43], a[20:23], v[80:83]
    v_mfma_f32_16x16x32_bf16 v[96:99], a[44:47], a[20:23], v[96:99]
    ds_read_b64_tr_b16 a[116:117], v169 offset:160
    ds_read_b64_tr_b16 a[118:119], v169 offset:4768
    v_mfma_f32_16x16x32_bf16 v[100:103], a[44:47], a[92:95], v[100:103]
    buffer_load_dwordx4 a[252:255], v149, s[16:19], s101 offen offset:1024 sc1
    v_mfma_f32_16x16x32_bf16 v[104:107], a[44:47], a[164:167], v[104:107]
    v_mfma_f32_16x16x32_bf16 v[108:111], a[44:47], a[236:239], v[108:111]
    s_waitcnt lgkmcnt(12)
    v_mfma_f32_16x16x32_bf16 v[124:127], a[48:51], a[236:239], v[124:127]
    s_add_u32 m0, s97, 24576
    ds_read_b64_tr_b16 a[40:41], v169 offset:192
    ds_read_b64_tr_b16 a[42:43], v169 offset:4800
    v_mfma_f32_16x16x32_bf16 v[120:123], a[48:51], a[164:167], v[120:123]
    buffer_load_dwordx4 v228, s[80:83], s96 offen lds
    v_mfma_f32_16x16x32_bf16 v[116:119], a[48:51], a[92:95], v[116:119]
    s_mul_i32 m0, s89, 0x2400
    s_add_u32 m0, m0, s97
    s_add_u32 m0, m0, 26624
    v_mfma_f32_16x16x32_bf16 v[112:115], a[48:51], a[20:23], v[112:115]
    buffer_load_dwordx4 v229, s[80:83], s96 offen lds
    v_mfma_f32_16x16x32_bf16 v[128:131], a[52:55], a[20:23], v[128:131]
    s_add_u32 m0, s97, 37888
    ds_read_b64_tr_b16 a[44:45], v169 offset:224
    ds_read_b64_tr_b16 a[46:47], v169 offset:4832
    v_mfma_f32_16x16x32_bf16 v[132:135], a[52:55], a[92:95], v[132:135]
    buffer_load_dwordx4 v230, s[80:83], s96 offen lds
    v_mfma_f32_16x16x32_bf16 v[136:139], a[52:55], a[164:167], v[136:139]
    v_mfma_f32_16x16x32_bf16 v[140:143], a[52:55], a[236:239], v[140:143]
    s_waitcnt vmcnt(29)
    s_waitcnt lgkmcnt(12)
    s_waitcnt vmcnt(19)
    v_cmp_gt_u32 vcc, 3, v249
    s_nop 4
    s_cbranch_vccnz C3_spin
C3_ret:
    s_waitcnt vmcnt(18)
    v_cmp_gt_u32 vcc, 3, v251
    s_nop 4
    s_cbranch_vccnz C4_spin
C4_ret:
    v_mfma_f32_16x16x32_bf16 v[0:3], a[56:59], a[24:27], v[0:3]
    s_add_u32 m0, s45, 0
    ds_read_b64_tr_b16 a[48:49], v169 offset:256
    ds_read_b64_tr_b16 a[50:51], v169 offset:4864
    v_mfma_f32_16x16x32_bf16 v[4:7], a[56:59], a[96:99], v[4:7]
    buffer_load_dwordx4 v180, s[24:27], 0 offen sc1 lds
    v_mfma_f32_16x16x32_bf16 v[8:11], a[56:59], a[168:171], v[8:11]
    s_add_u32 m0, s45, 4096
    v_mfma_f32_16x16x32_bf16 v[12:15], a[56:59], a[240:243], v[12:15]
    buffer_load_dwordx4 v181, s[24:27], 0 offen sc1 lds
    v_mfma_f32_16x16x32_bf16 v[28:31], a[60:63], a[240:243], v[28:31]
    s_add_u32 m0, s45, 8192
    ds_read_b64_tr_b16 a[52:53], v146 offset:0
    ds_read_b64_tr_b16 a[54:55], v146 offset:4608
    v_mfma_f32_16x16x32_bf16 v[24:27], a[60:63], a[168:171], v[24:27]
    buffer_load_dwordx4 v182, s[24:27], 0 offen sc1 lds
    v_mfma_f32_16x16x32_bf16 v[20:23], a[60:63], a[96:99], v[20:23]
    s_add_u32 m0, s45, 12288
    v_mfma_f32_16x16x32_bf16 v[16:19], a[60:63], a[24:27], v[16:19]
    s_waitcnt lgkmcnt(12)
    buffer_load_dwordx4 v183, s[24:27], 0 offen sc1 lds
    v_mfma_f32_16x16x32_bf16 v[32:35], a[64:67], a[24:27], v[32:35]
    s_add_u32 m0, s45, 16384
    ds_read_b64_tr_b16 a[56:57], v146 offset:32
    ds_read_b64_tr_b16 a[58:59], v146 offset:4640
    v_mfma_f32_16x16x32_bf16 v[36:39], a[64:67], a[96:99], v[36:39]
    buffer_load_dwordx4 v184, s[24:27], 0 offen sc1 lds
    v_mfma_f32_16x16x32_bf16 v[40:43], a[64:67], a[168:171], v[40:43]
    s_add_u32 m0, s45, 20480
    v_mfma_f32_16x16x32_bf16 v[44:47], a[64:67], a[240:243], v[44:47]
    buffer_load_dwordx4 v185, s[24:27], 0 offen sc1 lds
    v_mfma_f32_16x16x32_bf16 v[60:63], a[68:71], a[240:243], v[60:63]
    s_add_u32 m0, s45, 24576
    ds_read_b64_tr_b16 a[60:61], v146 offset:64
    ds_read_b64_tr_b16 a[62:63], v146 offset:4672
    v_mfma_f32_16x16x32_bf16 v[56:59], a[68:71], a[168:171], v[56:59]
    buffer_load_dwordx4 v186, s[24:27], 0 offen sc1 lds
    v_mfma_f32_16x16x32_bf16 v[52:55], a[68:71], a[96:99], v[52:55]
    s_add_u32 m0, s45, 28672
    v_mfma_f32_16x16x32_bf16 v[48:51], a[68:71], a[24:27], v[48:51]
    s_waitcnt lgkmcnt(12)
    buffer_load_dwordx4 v187, s[24:27], 0 offen sc1 lds
    v_mfma_f32_16x16x32_bf16 v[64:67], a[112:115], a[24:27], v[64:67]
    s_mov_b32 m0, s52
    ds_read_b64_tr_b16 a[64:65], v146 offset:96
    ds_read_b64_tr_b16 a[66:67], v146 offset:4704
    v_mfma_f32_16x16x32_bf16 v[68:71], a[112:115], a[96:99], v[68:71]
    s_mov_b64 exec, s[68:69]
    buffer_load_dwordx4 v188, s[24:27], 0 offen sc1 lds
    s_mov_b64 exec, -1
    v_mfma_f32_16x16x32_bf16 v[72:75], a[112:115], a[168:171], v[72:75]
    v_mfma_f32_16x16x32_bf16 v[76:79], a[112:115], a[240:243], v[76:79]
    v_mfma_f32_16x16x32_bf16 v[92:95], a[116:119], a[240:243], v[92:95]
    ds_read_b64_tr_b16 a[68:69], v146 offset:128
    ds_read_b64_tr_b16 a[70:71], v146 offset:4736
    v_mfma_f32_16x16x32_bf16 v[88:91], a[116:119], a[168:171], v[88:91]
    v_mfma_f32_16x16x32_bf16 v[84:87], a[116:119], a[96:99], v[84:87]
    v_mfma_f32_16x16x32_bf16 v[80:83], a[116:119], a[24:27], v[80:83]
    s_waitcnt lgkmcnt(12)
    v_mfma_f32_16x16x32_bf16 v[96:99], a[40:43], a[24:27], v[96:99]
    ds_read_b64_tr_b16 a[112:113], v146 offset:160
    ds_read_b64_tr_b16 a[114:115], v146 offset:4768
    v_mfma_f32_16x16x32_bf16 v[100:103], a[40:43], a[96:99], v[100:103]
    v_mfma_f32_16x16x32_bf16 v[104:107], a[40:43], a[168:171], v[104:107]
    v_mfma_f32_16x16x32_bf16 v[108:111], a[40:43], a[240:243], v[108:111]
    v_mfma_f32_16x16x32_bf16 v[124:127], a[44:47], a[240:243], v[124:127]
    ds_read_b64_tr_b16 a[116:117], v146 offset:192
    ds_read_b64_tr_b16 a[118:119], v146 offset:4800
    v_mfma_f32_16x16x32_bf16 v[120:123], a[44:47], a[168:171], v[120:123]
    v_mfma_f32_16x16x32_bf16 v[116:119], a[44:47], a[96:99], v[116:119]
    v_mfma_f32_16x16x32_bf16 v[112:115], a[44:47], a[24:27], v[112:115]
    s_waitcnt lgkmcnt(12)
    v_mfma_f32_16x16x32_bf16 v[128:131], a[48:51], a[24:27], v[128:131]
    ds_read_b64_tr_b16 a[40:41], v146 offset:224
    ds_read_b64_tr_b16 a[42:43], v146 offset:4832
    v_mfma_f32_16x16x32_bf16 v[132:135], a[48:51], a[96:99], v[132:135]
    buffer_load_dwordx4 v[160:163], v246, s[24:27], s46 offen sc1
    v_mfma_f32_16x16x32_bf16 v[136:139], a[48:51], a[168:171], v[136:139]
    buffer_load_dwordx4 v[164:167], v246, s[24:27], s46 offen offset:16 sc1
    v_mfma_f32_16x16x32_bf16 v[140:143], a[48:51], a[240:243], v[140:143]
    v_mfma_f32_16x16x32_bf16 v[0:3], a[52:55], a[28:31], v[0:3]
    ds_read_b64_tr_b16 a[44:45], v146 offset:256
    ds_read_b64_tr_b16 a[46:47], v146 offset:4864
    v_mfma_f32_16x16x32_bf16 v[4:7], a[52:55], a[100:103], v[4:7]
    buffer_load_dword v168, v246, s[24:27], s46 offen offset:32 sc1
    s_add_u32 s46, s46, 27648
    v_mfma_f32_16x16x32_bf16 v[8:11], a[52:55], a[172:175], v[8:11]
    v_mfma_f32_16x16x32_bf16 v[12:15], a[52:55], a[244:247], v[12:15]
    s_waitcnt lgkmcnt(12)
    s_waitcnt vmcnt(26)
    s_barrier
    v_mfma_f32_16x16x32_bf16 v[28:31], a[56:59], a[244:247], v[28:31]
    s_add_u32 m0, s97, 39936
    ds_read_b64_tr_b16 a[48:49], v146 offset:18432
    ds_read_b64_tr_b16 a[50:51], v146 offset:23040
    v_mfma_f32_16x16x32_bf16 v[24:27], a[56:59], a[172:175], v[24:27]
    buffer_load_dwordx4 v231, s[80:83], s96 offen lds
    v_mfma_f32_16x16x32_bf16 v[20:23], a[56:59], a[100:103], v[20:23]
    v_mfma_f32_16x16x32_bf16 v[16:19], a[56:59], a[28:31], v[16:19]
    v_mfma_f32_16x16x32_bf16 v[32:35], a[60:63], a[28:31], v[32:35]
    s_add_u32 m0, s97, 41984
    ds_read_b64_tr_b16 a[52:53], v146 offset:18464
    ds_read_b64_tr_b16 a[54:55], v146 offset:23072
    v_mfma_f32_16x16x32_bf16 v[36:39], a[60:63], a[100:103], v[36:39]
    buffer_load_dwordx4 v232, s[80:83], s96 offen lds
    v_mfma_f32_16x16x32_bf16 v[40:43], a[60:63], a[172:175], v[40:43]
    v_mfma_f32_16x16x32_bf16 v[44:47], a[60:63], a[244:247], v[44:47]
    s_waitcnt lgkmcnt(12)
    v_mfma_f32_16x16x32_bf16 v[60:63], a[64:67], a[244:247], v[60:63]
    s_add_u32 m0, s97, 44032
    ds_read_b64_tr_b16 a[56:57], v146 offset:18496
    ds_read_b64_tr_b16 a[58:59], v146 offset:23104
    v_mfma_f32_16x16x32_bf16 v[56:59], a[64:67], a[172:175], v[56:59]
    buffer_load_dwordx4 v233, s[80:83], s96 offen lds
    s_add_u32 s96, s96, 73728
    v_mfma_f32_16x16x32_bf16 v[52:55], a[64:67], a[100:103], v[52:55]
    v_mfma_f32_16x16x32_bf16 v[48:51], a[64:67], a[28:31], v[48:51]
    v_mfma_f32_16x16x32_bf16 v[64:67], a[68:71], a[28:31], v[64:67]
    ds_read_b64_tr_b16 a[60:61], v146 offset:18528
    ds_read_b64_tr_b16 a[62:63], v146 offset:23136
    v_mfma_f32_16x16x32_bf16 v[68:71], a[68:71], a[100:103], v[68:71]
    buffer_load_dwordx4 a[0:3], v149, s[16:19], s98 offen offset:2048 sc1
    v_mfma_f32_16x16x32_bf16 v[72:75], a[68:71], a[172:175], v[72:75]
    v_mfma_f32_16x16x32_bf16 v[76:79], a[68:71], a[244:247], v[76:79]
    s_waitcnt lgkmcnt(12)
    v_mfma_f32_16x16x32_bf16 v[92:95], a[112:115], a[244:247], v[92:95]
    ds_read_b64_tr_b16 a[64:65], v146 offset:18560
    ds_read_b64_tr_b16 a[66:67], v146 offset:23168
    v_mfma_f32_16x16x32_bf16 v[88:91], a[112:115], a[172:175], v[88:91]
    buffer_load_dwordx4 a[72:75], v149, s[16:19], s99 offen offset:2048 sc1
    v_mfma_f32_16x16x32_bf16 v[84:87], a[112:115], a[100:103], v[84:87]
    s_add_u32 m0, s97, 55296
    v_mfma_f32_16x16x32_bf16 v[80:83], a[112:115], a[28:31], v[80:83]
    buffer_load_dwordx4 v225, s[80:83], s96 offen lds
    v_mfma_f32_16x16x32_bf16 v[96:99], a[116:119], a[28:31], v[96:99]
    s_add_u32 m0, s97, 57344
    ds_read_b64_tr_b16 a[68:69], v146 offset:18592
    ds_read_b64_tr_b16 a[70:71], v146 offset:23200
    v_mfma_f32_16x16x32_bf16 v[100:103], a[116:119], a[100:103], v[100:103]
    buffer_load_dwordx4 v226, s[80:83], s96 offen lds
    v_mfma_f32_16x16x32_bf16 v[104:107], a[116:119], a[172:175], v[104:107]
    v_mfma_f32_16x16x32_bf16 v[108:111], a[116:119], a[244:247], v[108:111]
    s_waitcnt lgkmcnt(12)
    v_mfma_f32_16x16x32_bf16 v[124:127], a[40:43], a[244:247], v[124:127]
    ds_read_b64_tr_b16 a[112:113], v146 offset:18624
    ds_read_b64_tr_b16 a[114:115], v146 offset:23232
    v_mfma_f32_16x16x32_bf16 v[120:123], a[40:43], a[172:175], v[120:123]
    buffer_load_dwordx4 a[144:147], v149, s[16:19], s100 offen offset:2048 sc1
    v_mfma_f32_16x16x32_bf16 v[116:119], a[40:43], a[100:103], v[116:119]
    v_mfma_f32_16x16x32_bf16 v[112:115], a[40:43], a[28:31], v[112:115]
    v_mfma_f32_16x16x32_bf16 v[128:131], a[44:47], a[28:31], v[128:131]
    s_add_u32 m0, s97, 59392
    ds_read_b64_tr_b16 a[116:117], v146 offset:18656
    ds_read_b64_tr_b16 a[118:119], v146 offset:23264
    v_mfma_f32_16x16x32_bf16 v[132:135], a[44:47], a[100:103], v[132:135]
    buffer_load_dwordx4 v227, s[80:83], s96 offen lds
    v_mfma_f32_16x16x32_bf16 v[136:139], a[44:47], a[172:175], v[136:139]
    v_mfma_f32_16x16x32_bf16 v[140:143], a[44:47], a[244:247], v[140:143]
    s_waitcnt vmcnt(31)
    s_waitcnt lgkmcnt(12)
    v_mfma_f32_16x16x32_bf16 v[0:3], a[48:51], a[32:35], v[0:3]
    ds_read_b64_tr_b16 a[40:41], v146 offset:18688
    ds_read_b64_tr_b16 a[42:43], v146 offset:23296
    v_mfma_f32_16x16x32_bf16 v[4:7], a[48:51], a[104:107], v[4:7]
    buffer_load_dwordx4 a[216:219], v149, s[16:19], s101 offen offset:2048 sc1
    v_mfma_f32_16x16x32_bf16 v[8:11], a[48:51], a[176:179], v[8:11]
    v_mfma_f32_16x16x32_bf16 v[12:15], a[48:51], a[248:251], v[12:15]
    s_waitcnt vmcnt(13)
    s_lshl_b32 s38, s32, 2
    s_add_u32 s38, s38, 145152
    v_mov_b32 v248, s38
    v_mov_b32 v249, s4
    ds_write_b32 v248, v249
    v_mov_b32 v250, 145152
    s_waitcnt lgkmcnt(0)
    s_barrier
    ds_read_b128 v[252:255], v250
    v_mfma_f32_16x16x32_bf16 v[28:31], a[52:55], a[248:251], v[28:31]
    ds_read_b64_tr_b16 a[44:45], v145 offset:0
    ds_read_b64_tr_b16 a[46:47], v145 offset:4608
    v_add_u32 v199, 0, v189
    v_lshlrev_b32 v245, 3, v150
    v_mfma_f32_16x16x32_bf16 v[24:27], a[52:55], a[176:179], v[24:27]
    buffer_load_dwordx4 a[4:7], v149, s[16:19], s98 offen offset:3072 sc1
    ds_read2_b32 v[180:181], v199 offset0:0 offset1:1
    ds_read2_b32 v[182:183], v199 offset0:2 offset1:3
    ds_read2_b32 v[184:185], v199 offset0:4 offset1:5
    v_mfma_f32_16x16x32_bf16 v[20:23], a[52:55], a[104:107], v[20:23]
    s_add_u32 s98, s98, 4096
    v_sub_u32 v245, s42, v245
    v_mov_b32 v244, 0xceabfb8f
    v_mfma_f32_16x16x32_bf16 v[16:19], a[52:55], a[32:35], v[16:19]
    v_mfma_f32_16x16x32_bf16 v[32:35], a[56:59], a[32:35], v[32:35]
    s_add_u32 m0, s97, 61440
    ds_read_b64_tr_b16 a[48:49], v145 offset:32
    ds_read_b64_tr_b16 a[50:51], v145 offset:4640
    ds_read2_b32 v[186:187], v199 offset0:6 offset1:7
    ds_read_b32 v188, v199 offset:32
    v_mfma_f32_16x16x32_bf16 v[36:39], a[56:59], a[104:107], v[36:39]
    buffer_load_dwordx4 v228, s[80:83], s96 offen lds
    v_add_u32 v209, 4294964992, v189
    v_mfma_f32_16x16x32_bf16 v[40:43], a[56:59], a[176:179], v[40:43]
    s_mul_i32 m0, s89, 0x13c00
    ds_read2_b32 v[190:191], v209 offset0:0 offset1:1
    s_add_u32 m0, m0, s97
    v_mfma_f32_16x16x32_bf16 v[44:47], a[56:59], a[248:251], v[44:47]
    s_add_u32 m0, m0, 63488
    s_waitcnt lgkmcnt(10)
    v_or3_b32 v252, v252, v253, v254
    v_or_b32 v252, v252, v255
    v_cmp_le_u32 vcc, 0x200, v252
    s_nop 4
    s_cbranch_vccnz K3_abort
    v_mfma_f32_16x16x32_bf16 v[60:63], a[60:63], a[248:251], v[60:63]
    ds_read_b64_tr_b16 a[52:53], v145 offset:64
    ds_read_b64_tr_b16 a[54:55], v145 offset:4672
    ds_read2_b32 v[192:193], v209 offset0:2 offset1:3
    ds_read2_b32 v[194:195], v209 offset0:4 offset1:5
    v_mfma_f32_16x16x32_bf16 v[56:59], a[60:63], a[176:179], v[56:59]
    buffer_load_dwordx4 v229, s[80:83], s96 offen lds
    ds_read2_b32 v[196:197], v209 offset0:6 offset1:7
    v_mfma_f32_16x16x32_bf16 v[52:55], a[60:63], a[104:107], v[52:55]
    buffer_load_dwordx4 a[76:79], v149, s[16:19], s99 offen offset:3072 sc1
    s_add_u32 s99, s99, 4096
    v_mfma_f32_16x16x32_bf16 v[48:51], a[60:63], a[32:35], v[48:51]
    v_mfma_f32_16x16x32_bf16 v[64:67], a[64:67], a[32:35], v[64:67]
    s_add_u32 m0, s97, 146432
    ds_read_b64_tr_b16 a[56:57], v145 offset:96
    ds_read_b64_tr_b16 a[58:59], v145 offset:4704
    ds_read_b32 v198, v209 offset:32
    v_add_u32 v199, 4294962688, v189
    v_mfma_f32_16x16x32_bf16 v[68:71], a[64:67], a[104:107], v[68:71]
    buffer_load_dwordx4 v230, s[80:83], s96 offen lds
    ds_read2_b32 v[200:201], v199 offset0:0 offset1:1
    ds_read2_b32 v[202:203], v199 offset0:2 offset1:3
    v_mfma_f32_16x16x32_bf16 v[72:75], a[64:67], a[176:179], v[72:75]
    v_mfma_f32_16x16x32_bf16 v[76:79], a[64:67], a[248:251], v[76:79]
    v_mfma_f32_16x16x32_bf16 v[92:95], a[68:71], a[248:251], v[92:95]
    ds_read_b64_tr_b16 a[60:61], v145 offset:128
    ds_read_b64_tr_b16 a[62:63], v145 offset:4736
    ds_read2_b32 v[204:205], v199 offset0:4 offset1:5
    ds_read2_b32 v[206:207], v199 offset0:6 offset1:7
    v_mfma_f32_16x16x32_bf16 v[88:91], a[68:71], a[176:179], v[88:91]
    buffer_load_dwordx4 a[148:151], v149, s[16:19], s100 offen offset:3072 sc1
    ds_read_b32 v208, v199 offset:32
    v_add_u32 v209, 4294960384, v189
    v_mfma_f32_16x16x32_bf16 v[84:87], a[68:71], a[104:107], v[84:87]
    s_add_u32 s100, s100, 4096
    v_mfma_f32_16x16x32_bf16 v[80:83], a[68:71], a[32:35], v[80:83]
    v_mfma_f32_16x16x32_bf16 v[96:99], a[112:115], a[32:35], v[96:99]
    ds_read_b64_tr_b16 a[64:65], v145 offset:160
    ds_read_b64_tr_b16 a[66:67], v145 offset:4768
    ds_read2_b32 v[210:211], v209 offset0:0 offset1:1
    ds_read2_b32 v[212:213], v209 offset0:2 offset1:3
    v_mfma_f32_16x16x32_bf16 v[100:103], a[112:115], a[104:107], v[100:103]
    buffer_load_dwordx4 a[220:223], v149, s[16:19], s101 offen offset:3072 sc1
    ds_read2_b32 v[214:215], v209 offset0:4 offset1:5
    v_mfma_f32_16x16x32_bf16 v[104:107], a[112:115], a[176:179], v[104:107]
    s_add_u32 s101, s101, 4096
    v_mfma_f32_16x16x32_bf16 v[108:111], a[112:115], a[248:251], v[108:111]
    v_mfma_f32_16x16x32_bf16 v[124:127], a[116:119], a[248:251], v[124:127]
    s_add_u32 m0, s97, 148480
    ds_read_b64_tr_b16 a[68:69], v145 offset:192
    ds_read_b64_tr_b16 a[70:71], v145 offset:4800
    ds_read2_b32 v[216:217], v209 offset0:6 offset1:7
    ds_read_b32 v218, v209 offset:32
    v_mfma_f32_16x16x32_bf16 v[120:123], a[116:119], a[176:179], v[120:123]
    buffer_load_dwordx4 v231, s[80:83], s96 offen lds
    v_add_u32 v199, 1152, v189
    v_mfma_f32_16x16x32_bf16 v[116:119], a[116:119], a[104:107], v[116:119]
    v_mfma_f32_16x16x32_bf16 v[112:115], a[116:119], a[32:35], v[112:115]
    s_waitcnt lgkmcnt(15)
    v_mfma_f32_16x16x32_bf16 v[128:131], a[40:43], a[32:35], v[128:131]
    s_add_u32 m0, s97, 150528
    ds_read_b64_tr_b16 a[112:113], v145 offset:224
    ds_read_b64_tr_b16 a[114:115], v145 offset:4832
    v_mfma_f32_16x16x32_bf16 v[132:135], a[40:43], a[104:107], v[132:135]
    buffer_load_dwordx4 v232, s[80:83], s96 offen lds
    v_mfma_f32_16x16x32_bf16 v[136:139], a[40:43], a[176:179], v[136:139]
    s_add_u32 m0, s97, 152576
    v_mfma_f32_16x16x32_bf16 v[140:143], a[40:43], a[248:251], v[140:143]
    buffer_load_dwordx4 v233, s[80:83], s96 offen lds
    s_add_u32 s96, s96, 73728
    v_mfma_f32_16x16x32_bf16 v[0:3], a[44:47], a[36:39], v[0:3]
    ds_read_b64_tr_b16 a[116:117], v145 offset:256
    ds_read_b64_tr_b16 a[118:119], v145 offset:4864
    v_mfma_f32_16x16x32_bf16 v[4:7], a[44:47], a[108:111], v[4:7]
    buffer_load_dwordx4 a[8:11], v149, s[16:19], s98 offen offset:0 sc1
    v_mfma_f32_16x16x32_bf16 v[8:11], a[44:47], a[180:183], v[8:11]
    s_waitcnt vmcnt(21)
    s_waitcnt lgkmcnt(4)
    v_dot2_f32_bf16 v220, v160, v180, 0
    v_dot2_f32_bf16 v221, v160, v190, 0
    v_dot2_f32_bf16 v222, v160, v200, 0
    v_dot2_f32_bf16 v223, v160, v210, 0
    v_dot2_f32_bf16 v220, v161, v181, v220
    v_dot2_f32_bf16 v221, v161, v191, v221
    v_dot2_f32_bf16 v222, v161, v201, v222
    v_dot2_f32_bf16 v223, v161, v211, v223
    v_dot2_f32_bf16 v220, v162, v182, v220
    v_dot2_f32_bf16 v221, v162, v192, v221
    v_dot2_f32_bf16 v222, v162, v202, v222
    v_dot2_f32_bf16 v223, v162, v212, v223
    v_dot2_f32_bf16 v220, v163, v183, v220
    v_dot2_f32_bf16 v221, v163, v193, v221
    v_dot2_f32_bf16 v222, v163, v203, v222
    v_dot2_f32_bf16 v223, v163, v213, v223
    v_dot2_f32_bf16 v220, v164, v184, v220
    v_dot2_f32_bf16 v221, v164, v194, v221
    v_dot2_f32_bf16 v222, v164, v204, v222
    v_dot2_f32_bf16 v223, v164, v214, v223
    v_dot2_f32_bf16 v220, v165, v185, v220
    v_dot2_f32_bf16 v221, v165, v195, v221
    v_dot2_f32_bf16 v222, v165, v205, v222
    v_dot2_f32_bf16 v223, v165, v215, v223
    v_dot2_f32_bf16 v220, v166, v186, v220
    v_dot2_f32_bf16 v221, v166, v196, v221
    v_dot2_f32_bf16 v222, v166, v206, v222
    v_dot2_f32_bf16 v223, v166, v216, v223
    v_dot2_f32_bf16 v220, v167, v187, v220
    v_dot2_f32_bf16 v221, v167, v197, v221
    v_dot2_f32_bf16 v222, v167, v207, v222
    v_dot2_f32_bf16 v223, v167, v217, v223
    v_dot2_f32_bf16 v220, v168, v188, v220
    v_dot2_f32_bf16 v221, v168, v198, v221
    v_dot2_f32_bf16 v222, v168, v208, v222
    v_dot2_f32_bf16 v223, v168, v218, v223
    v_mfma_f32_16x16x32_bf16 v[12:15], a[44:47], a[252:255], v[12:15]
    ds_read2_b32 v[180:181], v199 offset0:0 offset1:1
    ds_read2_b32 v[182:183], v199 offset0:2 offset1:3
    ds_read2_b32 v[184:185], v199 offset0:4 offset1:5
    s_waitcnt vmcnt(18)
    s_barrier
    v_mfma_f32_16x16x32_bf16 v[28:31], a[48:51], a[252:255], v[28:31]
    ds_read_b64_tr_b16 a[40:41], v145 offset:18432
    ds_read_b64_tr_b16 a[42:43], v145 offset:23040
    ds_read2_b32 v[186:187], v199 offset0:6 offset1:7
    ds_read_b32 v188, v199 offset:32
    v_mfma_f32_16x16x32_bf16 v[24:27], a[48:51], a[180:183], v[24:27]
    buffer_load_dwordx4 a[80:83], v149, s[16:19], s99 offen offset:0 sc1
    v_add_u32 v209, 4294966144, v189
    v_mul_f32 v220, 0x3eae1a93, v220
    v_mul_f32 v221, 0x3eae1a93, v221
    v_mfma_f32_16x16x32_bf16 v[20:23], a[48:51], a[108:111], v[20:23]
    ds_read2_b32 v[190:191], v209 offset0:0 offset1:1
    v_mul_f32 v222, 0x3eae1a93, v222
    v_mul_f32 v223, 0x3eae1a93, v223
    v_mfma_f32_16x16x32_bf16 v[16:19], a[48:51], a[36:39], v[16:19]
    v_cmp_le_i32 vcc, 0, v245
    v_cndmask_b32 v220, v244, v220, vcc
    v_cmp_le_i32 vcc, 2, v245
    v_cndmask_b32 v221, v244, v221, vcc
    v_mfma_f32_16x16x32_bf16 v[32:35], a[52:55], a[36:39], v[32:35]
    ds_read_b64_tr_b16 a[44:45], v145 offset:18464
    ds_read_b64_tr_b16 a[46:47], v145 offset:23072
    ds_read2_b32 v[192:193], v209 offset0:2 offset1:3
    ds_read2_b32 v[194:195], v209 offset0:4 offset1:5
    v_mfma_f32_16x16x32_bf16 v[36:39], a[52:55], a[108:111], v[36:39]
    buffer_load_dwordx4 v[170:173], v246, s[24:27], s46 offen sc1
    ds_read2_b32 v[196:197], v209 offset0:6 offset1:7
    v_cmp_le_i32 vcc, 4, v245
    v_cndmask_b32 v222, v244, v222, vcc
    v_mfma_f32_16x16x32_bf16 v[40:43], a[52:55], a[180:183], v[40:43]
    v_cmp_le_i32 vcc, 6, v245
    v_cndmask_b32 v223, v244, v223, vcc
    v_max_f32 v244, v220, v221
    v_max3_f32 v244, v244, v222, v223
    v_mfma_f32_16x16x32_bf16 v[44:47], a[52:55], a[252:255], v[44:47]
    v_mov_b32 v245, v244
    s_nop 1
    v_permlane32_swap_b32 v244, v245
    v_mfma_f32_16x16x32_bf16 v[60:63], a[56:59], a[252:255], v[60:63]
    ds_read_b64_tr_b16 a[48:49], v145 offset:18496
    ds_read_b64_tr_b16 a[50:51], v145 offset:23104
    ds_read_b32 v198, v209 offset:32
    v_add_u32 v199, 4294963840, v189
    v_mfma_f32_16x16x32_bf16 v[56:59], a[56:59], a[180:183], v[56:59]
    buffer_load_dwordx4 a[152:155], v149, s[16:19], s100 offen offset:0 sc1
    ds_read2_b32 v[200:201], v199 offset0:0 offset1:1
    ds_read2_b32 v[202:203], v199 offset0:2 offset1:3
    v_max_f32 v244, v244, v245
    v_mfma_f32_16x16x32_bf16 v[52:55], a[56:59], a[108:111], v[52:55]
    v_sub_f32 v220, v220, v244
    v_sub_f32 v221, v221, v244
    v_sub_f32 v222, v222, v244
    v_sub_f32 v223, v223, v244
    v_mfma_f32_16x16x32_bf16 v[48:51], a[56:59], a[36:39], v[48:51]
    v_exp_f32 v220, v220
    v_exp_f32 v221, v221
    v_mfma_f32_16x16x32_bf16 v[64:67], a[60:63], a[36:39], v[64:67]
    ds_read_b64_tr_b16 a[52:53], v145 offset:18528
    ds_read_b64_tr_b16 a[54:55], v145 offset:23136
    ds_read2_b32 v[204:205], v199 offset0:4 offset1:5
    ds_read2_b32 v[206:207], v199 offset0:6 offset1:7
    v_mfma_f32_16x16x32_bf16 v[68:71], a[60:63], a[108:111], v[68:71]
    buffer_load_dwordx4 v[174:177], v246, s[24:27], s46 offen offset:16 sc1
    ds_read_b32 v208, v199 offset:32
    v_add_u32 v209, 4294961536, v189
    v_mfma_f32_16x16x32_bf16 v[72:75], a[60:63], a[180:183], v[72:75]
    v_exp_f32 v222, v222
    v_exp_f32 v223, v223
    v_mfma_f32_16x16x32_bf16 v[76:79], a[60:63], a[252:255], v[76:79]
    v_add_f32 v244, v220, v221
    v_add_f32 v245, v222, v223
    v_add_f32 v244, v244, v245
    v_mov_b32 v245, v244
    s_nop 1
    v_permlane32_swap_b32 v244, v245
    v_mfma_f32_16x16x32_bf16 v[92:95], a[64:67], a[252:255], v[92:95]
    ds_read_b64_tr_b16 a[56:57], v145 offset:18560
    ds_read_b64_tr_b16 a[58:59], v145 offset:23168
    ds_read2_b32 v[210:211], v209 offset0:0 offset1:1
    ds_read2_b32 v[212:213], v209 offset0:2 offset1:3
    v_mfma_f32_16x16x32_bf16 v[88:91], a[64:67], a[180:183], v[88:91]
    buffer_load_dwordx4 a[224:227], v149, s[16:19], s101 offen offset:0 sc1
    ds_read2_b32 v[214:215], v209 offset0:4 offset1:5
    v_add_f32 v244, v244, v245
    v_mfma_f32_16x16x32_bf16 v[84:87], a[64:67], a[108:111], v[84:87]
    buffer_load_dword v178, v246, s[24:27], s46 offen offset:32 sc1
    v_rcp_f32 v244, v244
    v_mfma_f32_16x16x32_bf16 v[80:83], a[64:67], a[36:39], v[80:83]
    v_mul_f32 v220, v220, v244
    v_mul_f32 v221, v221, v244
    v_mul_f32 v222, v222, v244
    v_mul_f32 v223, v223, v244
    v_mfma_f32_16x16x32_bf16 v[96:99], a[68:71], a[36:39], v[96:99]
    ds_read_b64_tr_b16 a[60:61], v145 offset:18592
    ds_read_b64_tr_b16 a[62:63], v145 offset:23200
    ds_read2_b32 v[216:217], v209 offset0:6 offset1:7
    ds_read_b32 v218, v209 offset:32
    v_mfma_f32_16x16x32_bf16 v[100:103], a[68:71], a[108:111], v[100:103]
    buffer_load_dwordx4 a[12:15], v149, s[16:19], s98 offen offset:1024 sc1
    v_add_u32 v199, 9216, v189
    v_cvt_pk_bf16_f32 v248, v220, 0
    v_cvt_pk_bf16_f32 v249, 0, v220
    v_mfma_f32_16x16x32_bf16 v[104:107], a[68:71], a[180:183], v[104:107]
    v_cvt_pk_bf16_f32 v250, v221, 0
    v_cvt_pk_bf16_f32 v251, 0, v221
    v_cvt_pk_bf16_f32 v252, v222, 0
    v_cvt_pk_bf16_f32 v253, 0, v222
    v_mfma_f32_16x16x32_bf16 v[108:111], a[68:71], a[252:255], v[108:111]
    s_waitcnt lgkmcnt(15)
    v_cvt_pk_bf16_f32 v254, v223, 0
    v_cvt_pk_bf16_f32 v255, 0, v223
    v_mfma_f32_16x16x32_bf16 v[124:127], a[112:115], a[252:255], v[124:127]
    s_add_u32 m0, s97, 73728
    ds_read_b64_tr_b16 a[64:65], v145 offset:18624
    ds_read_b64_tr_b16 a[66:67], v145 offset:23232
    v_mfma_f32_16x16x32_bf16 v[120:123], a[112:115], a[180:183], v[120:123]
    buffer_load_dwordx4 v225, s[80:83], s96 offen lds
    v_mfma_f32_16x16x32_bf16 v[116:119], a[112:115], a[108:111], v[116:119]
    v_mfma_f32_16x16x32_bf16 v[112:115], a[112:115], a[36:39], v[112:115]
    v_mfma_f32_16x16x32_bf16 v[128:131], a[116:119], a[36:39], v[128:131]
    ds_read_b64_tr_b16 a[68:69], v145 offset:18656
    ds_read_b64_tr_b16 a[70:71], v145 offset:23264
    v_mfma_f32_16x16x32_bf16 v[132:135], a[116:119], a[108:111], v[132:135]
    buffer_load_dwordx4 a[84:87], v149, s[16:19], s99 offen offset:1024 sc1
    v_mfma_f32_16x16x32_bf16 v[136:139], a[116:119], a[180:183], v[136:139]
    s_waitcnt lgkmcnt(4)
    v_dot2_f32_bf16 v151, v180, v248, 0
    v_dot2_f32_bf16 v152, v180, v249, 0
    v_dot2_f32_bf16 v153, v181, v248, 0
    v_dot2_f32_bf16 v154, v181, v249, 0
    v_dot2_f32_bf16 v155, v182, v248, 0
    v_dot2_f32_bf16 v156, v182, v249, 0
    v_dot2_f32_bf16 v157, v183, v248, 0
    v_dot2_f32_bf16 v158, v183, v249, 0
    v_dot2_f32_bf16 v159, v184, v248, 0
    v_dot2_f32_bf16 v224, v184, v249, 0
    v_dot2_f32_bf16 v234, v185, v248, 0
    v_dot2_f32_bf16 v235, v185, v249, 0
    v_dot2_f32_bf16 v236, v186, v248, 0
    v_dot2_f32_bf16 v237, v186, v249, 0
    v_dot2_f32_bf16 v238, v187, v248, 0
    v_dot2_f32_bf16 v239, v187, v249, 0
    v_dot2_f32_bf16 v240, v188, v248, 0
    v_dot2_f32_bf16 v241, v188, v249, 0
    v_dot2_f32_bf16 v151, v190, v250, v151
    v_dot2_f32_bf16 v152, v190, v251, v152
    v_dot2_f32_bf16 v153, v191, v250, v153
    v_dot2_f32_bf16 v154, v191, v251, v154
    v_dot2_f32_bf16 v155, v192, v250, v155
    v_dot2_f32_bf16 v156, v192, v251, v156
    v_dot2_f32_bf16 v157, v193, v250, v157
    v_dot2_f32_bf16 v158, v193, v251, v158
    v_dot2_f32_bf16 v159, v194, v250, v159
    v_dot2_f32_bf16 v224, v194, v251, v224
    v_dot2_f32_bf16 v234, v195, v250, v234
    v_dot2_f32_bf16 v235, v195, v251, v235
    v_dot2_f32_bf16 v236, v196, v250, v236
    v_dot2_f32_bf16 v237, v196, v251, v237
    v_dot2_f32_bf16 v238, v197, v250, v238
    v_dot2_f32_bf16 v239, v197, v251, v239
    v_dot2_f32_bf16 v240, v198, v250, v240
    v_dot2_f32_bf16 v241, v198, v251, v241
    v_dot2_f32_bf16 v151, v200, v252, v151
    v_dot2_f32_bf16 v152, v200, v253, v152
    v_dot2_f32_bf16 v153, v201, v252, v153
    v_dot2_f32_bf16 v154, v201, v253, v154
    v_dot2_f32_bf16 v155, v202, v252, v155
    v_dot2_f32_bf16 v156, v202, v253, v156
    v_dot2_f32_bf16 v157, v203, v252, v157
    v_dot2_f32_bf16 v158, v203, v253, v158
    v_dot2_f32_bf16 v159, v204, v252, v159
    v_dot2_f32_bf16 v224, v204, v253, v224
    v_dot2_f32_bf16 v234, v205, v252, v234
    v_dot2_f32_bf16 v235, v205, v253, v235
    v_dot2_f32_bf16 v236, v206, v252, v236
    v_dot2_f32_bf16 v237, v206, v253, v237
    v_dot2_f32_bf16 v238, v207, v252, v238
    v_dot2_f32_bf16 v239, v207, v253, v239
    v_dot2_f32_bf16 v240, v208, v252, v240
    v_dot2_f32_bf16 v241, v208, v253, v241
    v_dot2_f32_bf16 v151, v210, v254, v151
    v_dot2_f32_bf16 v152, v210, v255, v152
    v_dot2_f32_bf16 v153, v211, v254, v153
    v_dot2_f32_bf16 v154, v211, v255, v154
    v_dot2_f32_bf16 v155, v212, v254, v155
    v_dot2_f32_bf16 v156, v212, v255, v156
    v_dot2_f32_bf16 v157, v213, v254, v157
    v_dot2_f32_bf16 v158, v213, v255, v158
    v_dot2_f32_bf16 v159, v214, v254, v159
    v_dot2_f32_bf16 v224, v214, v255, v224
    v_dot2_f32_bf16 v234, v215, v254, v234
    v_dot2_f32_bf16 v235, v215, v255, v235
    v_dot2_f32_bf16 v236, v216, v254, v236
    v_dot2_f32_bf16 v237, v216, v255, v237
    v_dot2_f32_bf16 v238, v217, v254, v238
    v_dot2_f32_bf16 v239, v217, v255, v239
    v_dot2_f32_bf16 v240, v218, v254, v240
    v_dot2_f32_bf16 v241, v218, v255, v241
    v_mfma_f32_16x16x32_bf16 v[140:143], a[116:119], a[252:255], v[140:143]
    s_waitcnt vmcnt(20)
    ds_read2_b32 v[180:181], v199 offset0:0 offset1:1
    ds_read2_b32 v[182:183], v199 offset0:2 offset1:3
    ds_read2_b32 v[184:185], v199 offset0:4 offset1:5
    v_mov_b32 v242, 0
    v_mfma_f32_16x16x32_bf16 v[0:3], a[40:43], a[0:3], v[0:3]
    s_add_u32 m0, s97, 75776
    ds_read_b64_tr_b16 a[112:113], v145 offset:18688
    ds_read_b64_tr_b16 a[114:115], v145 offset:23296
    ds_read2_b32 v[186:187], v199 offset0:6 offset1:7
    ds_read_b32 v188, v199 offset:32
    v_mfma_f32_16x16x32_bf16 v[4:7], a[40:43], a[72:75], v[4:7]
    buffer_load_dwordx4 v226, s[80:83], s96 offen lds
    v_add_u32 v209, 6912, v189
    v_mov_b32 v243, 0
    s_nop 3
    v_permlane32_swap_b32 v151, v234
    v_mfma_f32_16x16x32_bf16 v[8:11], a[40:43], a[144:147], v[8:11]
    ds_read2_b32 v[190:191], v209 offset0:0 offset1:1
    v_permlane32_swap_b32 v152, v235
    v_mfma_f32_16x16x32_bf16 v[12:15], a[40:43], a[216:219], v[12:15]
    v_permlane32_swap_b32 v153, v236
    v_permlane32_swap_b32 v154, v237
    v_mfma_f32_16x16x32_bf16 v[28:31], a[44:47], a[216:219], v[28:31]
    ds_read_b64_tr_b16 a[116:117], v145 offset:36864
    ds_read_b64_tr_b16 a[118:119], v145 offset:41472
    ds_read2_b32 v[192:193], v209 offset0:2 offset1:3
    ds_read2_b32 v[194:195], v209 offset0:4 offset1:5
    v_mfma_f32_16x16x32_bf16 v[24:27], a[44:47], a[144:147], v[24:27]
    buffer_load_dwordx4 a[156:159], v149, s[16:19], s100 offen offset:1024 sc1
    ds_read2_b32 v[196:197], v209 offset0:6 offset1:7
    v_permlane32_swap_b32 v155, v238
    v_mfma_f32_16x16x32_bf16 v[20:23], a[44:47], a[72:75], v[20:23]
    v_permlane32_swap_b32 v156, v239
    v_permlane32_swap_b32 v157, v240
    v_mfma_f32_16x16x32_bf16 v[16:19], a[44:47], a[0:3], v[16:19]
    v_permlane32_swap_b32 v158, v241
    v_permlane32_swap_b32 v159, v242
    v_mfma_f32_16x16x32_bf16 v[32:35], a[48:51], a[0:3], v[32:35]
    ds_read_b64_tr_b16 a[40:41], v145 offset:36896
    ds_read_b64_tr_b16 a[42:43], v145 offset:41504
    ds_read_b32 v198, v209 offset:32
    v_add_u32 v199, 4608, v189
    v_mfma_f32_16x16x32_bf16 v[36:39], a[48:51], a[72:75], v[36:39]
    buffer_load_dwordx4 a[228:231], v149, s[16:19], s101 offen offset:1024 sc1
    ds_read2_b32 v[200:201], v199 offset0:0 offset1:1
    ds_read2_b32 v[202:203], v199 offset0:2 offset1:3
    v_mfma_f32_16x16x32_bf16 v[40:43], a[48:51], a[144:147], v[40:43]
    s_add_u32 m0, s97, 77824
    v_permlane32_swap_b32 v224, v243
    v_mfma_f32_16x16x32_bf16 v[44:47], a[48:51], a[216:219], v[44:47]
    buffer_load_dwordx4 v227, s[80:83], s96 offen lds
    v_add_f32 v151, v151, v234
    v_add_f32 v152, v152, v235
    v_add_f32 v153, v153, v236
    v_mfma_f32_16x16x32_bf16 v[60:63], a[52:55], a[216:219], v[60:63]
    s_add_u32 m0, s97, 79872
    ds_read_b64_tr_b16 a[44:45], v145 offset:36928
    ds_read_b64_tr_b16 a[46:47], v145 offset:41536
    ds_read2_b32 v[204:205], v199 offset0:4 offset1:5
    ds_read2_b32 v[206:207], v199 offset0:6 offset1:7
    v_mfma_f32_16x16x32_bf16 v[56:59], a[52:55], a[144:147], v[56:59]
    buffer_load_dwordx4 v228, s[80:83], s96 offen lds
    ds_read_b32 v208, v199 offset:32
    v_add_u32 v209, 2304, v189
    v_add_f32 v154, v154, v237
    v_mfma_f32_16x16x32_bf16 v[52:55], a[52:55], a[72:75], v[52:55]
    v_add_f32 v155, v155, v238
    v_add_f32 v156, v156, v239
    v_add_f32 v157, v157, v240
    v_add_f32 v158, v158, v241
    v_mfma_f32_16x16x32_bf16 v[48:51], a[52:55], a[0:3], v[48:51]
    v_add_f32 v159, v159, v242
    v_add_f32 v224, v224, v243
    v_cvt_pk_bf16_f32 v160, v151, v152
    v_cvt_pk_bf16_f32 v161, v153, v154
    v_mfma_f32_16x16x32_bf16 v[64:67], a[56:59], a[0:3], v[64:67]
    s_mul_i32 m0, s89, 0x2400
    ds_read_b64_tr_b16 a[48:49], v145 offset:36960
    ds_read_b64_tr_b16 a[50:51], v145 offset:41568
    ds_read2_b32 v[210:211], v209 offset0:0 offset1:1
    ds_read2_b32 v[212:213], v209 offset0:2 offset1:3
    v_mfma_f32_16x16x32_bf16 v[68:71], a[56:59], a[72:75], v[68:71]
    s_add_u32 m0, m0, s97
    ds_read2_b32 v[214:215], v209 offset0:4 offset1:5
    v_cvt_pk_bf16_f32 v162, v155, v156
    v_cvt_pk_bf16_f32 v163, v157, v158
    v_cvt_pk_bf16_f32 v164, v159, v224
    v_mfma_f32_16x16x32_bf16 v[72:75], a[56:59], a[144:147], v[72:75]
    s_add_u32 m0, m0, 81920
    v_lshlrev_b32 v247, 2, v144
    v_lshl_add_u32 v247, v150, 31, v247
    s_add_u32 s42, s42, 8
    v_lshlrev_b32 v245, 3, v150
    v_mfma_f32_16x16x32_bf16 v[76:79], a[56:59], a[216:219], v[76:79]
    buffer_load_dwordx4 v229, s[80:83], s96 offen lds
    v_sub_u32 v245, s42, v245
    v_mov_b32 v244, 0xceabfb8f
    v_mfma_f32_16x16x32_bf16 v[92:95], a[60:63], a[216:219], v[92:95]
    ds_read_b64_tr_b16 a[52:53], v145 offset:36992
    ds_read_b64_tr_b16 a[54:55], v145 offset:41600
    ds_read2_b32 v[216:217], v209 offset0:6 offset1:7
    ds_read_b32 v218, v209 offset:32
    v_mfma_f32_16x16x32_bf16 v[88:91], a[60:63], a[144:147], v[88:91]
    buffer_store_dwordx4 v[160:163], v149, s[28:31], s61 offen sc0 sc1
    v_add_u32 v199, 10368, v189
    v_mfma_f32_16x16x32_bf16 v[84:87], a[60:63], a[72:75], v[84:87]
    buffer_store_dword v164, v247, s[28:31], s61 offen offset:1024 sc0 sc1
    v_mfma_f32_16x16x32_bf16 v[80:83], a[60:63], a[0:3], v[80:83]
    s_waitcnt lgkmcnt(15)
    v_mfma_f32_16x16x32_bf16 v[96:99], a[64:67], a[0:3], v[96:99]
    ds_read_b64_tr_b16 a[56:57], v145 offset:37024
    ds_read_b64_tr_b16 a[58:59], v145 offset:41632
    v_mfma_f32_16x16x32_bf16 v[100:103], a[64:67], a[72:75], v[100:103]
    v_mfma_f32_16x16x32_bf16 v[104:107], a[64:67], a[144:147], v[104:107]
    v_mfma_f32_16x16x32_bf16 v[108:111], a[64:67], a[216:219], v[108:111]
    v_mfma_f32_16x16x32_bf16 v[124:127], a[68:71], a[216:219], v[124:127]
    s_add_u32 m0, s97, 93184
    ds_read_b64_tr_b16 a[60:61], v145 offset:37056
    ds_read_b64_tr_b16 a[62:63], v145 offset:41664
    v_mfma_f32_16x16x32_bf16 v[120:123], a[68:71], a[144:147], v[120:123]
    buffer_load_dwordx4 v230, s[80:83], s96 offen lds
    v_mfma_f32_16x16x32_bf16 v[116:119], a[68:71], a[72:75], v[116:119]
    s_waitcnt vmcnt(12)
    s_waitcnt lgkmcnt(4)
    v_dot2_f32_bf16 v220, v170, v180, 0
    v_dot2_f32_bf16 v221, v170, v190, 0
    v_dot2_f32_bf16 v222, v170, v200, 0
    v_dot2_f32_bf16 v223, v170, v210, 0
    v_dot2_f32_bf16 v220, v171, v181, v220
    v_dot2_f32_bf16 v221, v171, v191, v221
    v_dot2_f32_bf16 v222, v171, v201, v222
    v_dot2_f32_bf16 v223, v171, v211, v223
    v_dot2_f32_bf16 v220, v172, v182, v220
    v_dot2_f32_bf16 v221, v172, v192, v221
    v_dot2_f32_bf16 v222, v172, v202, v222
    v_dot2_f32_bf16 v223, v172, v212, v223
    v_dot2_f32_bf16 v220, v173, v183, v220
    v_dot2_f32_bf16 v221, v173, v193, v221
    v_dot2_f32_bf16 v222, v173, v203, v222
    v_dot2_f32_bf16 v223, v173, v213, v223
    v_dot2_f32_bf16 v220, v174, v184, v220
    v_dot2_f32_bf16 v221, v174, v194, v221
    v_dot2_f32_bf16 v222, v174, v204, v222
    v_dot2_f32_bf16 v223, v174, v214, v223
    v_dot2_f32_bf16 v220, v175, v185, v220
    v_dot2_f32_bf16 v221, v175, v195, v221
    v_dot2_f32_bf16 v222, v175, v205, v222
    v_dot2_f32_bf16 v223, v175, v215, v223
    v_dot2_f32_bf16 v220, v176, v186, v220
    v_dot2_f32_bf16 v221, v176, v196, v221
    v_dot2_f32_bf16 v222, v176, v206, v222
    v_dot2_f32_bf16 v223, v176, v216, v223
    v_dot2_f32_bf16 v220, v177, v187, v220
    v_dot2_f32_bf16 v221, v177, v197, v221
    v_dot2_f32_bf16 v222, v177, v207, v222
    v_dot2_f32_bf16 v223, v177, v217, v223
    v_dot2_f32_bf16 v220, v178, v188, v220
    v_dot2_f32_bf16 v221, v178, v198, v221
    v_dot2_f32_bf16 v222, v178, v208, v222
    v_dot2_f32_bf16 v223, v178, v218, v223
    v_mfma_f32_16x16x32_bf16 v[112:115], a[68:71], a[0:3], v[112:115]
    ds_read2_b32 v[180:181], v199 offset0:0 offset1:1
    ds_read2_b32 v[182:183], v199 offset0:2 offset1:3
    ds_read2_b32 v[184:185], v199 offset0:4 offset1:5
    v_mfma_f32_16x16x32_bf16 v[128:131], a[112:115], a[0:3], v[128:131]
    s_add_u32 m0, s97, 95232
    ds_read_b64_tr_b16 a[64:65], v145 offset:37088
    ds_read_b64_tr_b16 a[66:67], v145 offset:41696
    ds_read2_b32 v[186:187], v199 offset0:6 offset1:7
    ds_read_b32 v188, v199 offset:32
    v_mfma_f32_16x16x32_bf16 v[132:135], a[112:115], a[72:75], v[132:135]
    buffer_load_dwordx4 v231, s[80:83], s96 offen lds
    v_add_u32 v209, 8064, v189
    v_mul_f32 v220, 0x3eae1a93, v220
    v_mul_f32 v221, 0x3eae1a93, v221
    v_mfma_f32_16x16x32_bf16 v[136:139], a[112:115], a[144:147], v[136:139]
    s_add_u32 m0, s97, 97280
    ds_read2_b32 v[190:191], v209 offset0:0 offset1:1
    v_mul_f32 v222, 0x3eae1a93, v222
    v_mul_f32 v223, 0x3eae1a93, v223
    v_mfma_f32_16x16x32_bf16 v[140:143], a[112:115], a[216:219], v[140:143]
    buffer_load_dwordx4 v232, s[80:83], s96 offen lds
    v_cmp_le_i32 vcc, 0, v245
    v_cndmask_b32 v220, v244, v220, vcc
    v_mfma_f32_16x16x32_bf16 v[0:3], a[116:119], a[4:7], v[0:3]
    s_add_u32 m0, s97, 99328
    ds_read_b64_tr_b16 a[68:69], v145 offset:37120
    ds_read_b64_tr_b16 a[70:71], v145 offset:41728
    ds_read2_b32 v[192:193], v209 offset0:2 offset1:3
    ds_read2_b32 v[194:195], v209 offset0:4 offset1:5
    v_mfma_f32_16x16x32_bf16 v[4:7], a[116:119], a[76:79], v[4:7]
    buffer_load_dwordx4 v233, s[80:83], s96 offen lds
    ds_read2_b32 v[196:197], v209 offset0:6 offset1:7
    v_cmp_le_i32 vcc, 2, v245
    v_cndmask_b32 v221, v244, v221, vcc
    v_mfma_f32_16x16x32_bf16 v[8:11], a[116:119], a[148:151], v[8:11]
    s_add_u32 s96, s96, 73728
    v_cmp_le_i32 vcc, 4, v245
    v_cndmask_b32 v222, v244, v222, vcc
    v_cmp_le_i32 vcc, 6, v245
    v_cndmask_b32 v223, v244, v223, vcc
    v_mfma_f32_16x16x32_bf16 v[12:15], a[116:119], a[220:223], v[12:15]
    v_max_f32 v244, v220, v221
    v_max3_f32 v244, v244, v222, v223
    v_mov_b32 v245, v244
    s_nop 1
    v_permlane32_swap_b32 v244, v245
    s_barrier
    v_mfma_f32_16x16x32_bf16 v[28:31], a[40:43], a[220:223], v[28:31]
    s_add_u32 m0, s97, 0
    ds_read_b64_tr_b16 a[112:113], v145 offset:55296
    ds_read_b64_tr_b16 a[114:115], v145 offset:59904
    ds_read_b32 v198, v209 offset:32
    v_add_u32 v199, 5760, v189
    v_mfma_f32_16x16x32_bf16 v[24:27], a[40:43], a[148:151], v[24:27]
    buffer_load_dwordx4 v225, s[80:83], s96 offen lds
    ds_read2_b32 v[200:201], v199 offset0:0 offset1:1
    ds_read2_b32 v[202:203], v199 offset0:2 offset1:3
    v_max_f32 v244, v244, v245
    v_mfma_f32_16x16x32_bf16 v[20:23], a[40:43], a[76:79], v[20:23]
    v_sub_f32 v220, v220, v244
    v_sub_f32 v221, v221, v244
    v_sub_f32 v222, v222, v244
    v_sub_f32 v223, v223, v244
    v_mfma_f32_16x16x32_bf16 v[16:19], a[40:43], a[4:7], v[16:19]
    v_exp_f32 v220, v220
    v_exp_f32 v221, v221
    v_mfma_f32_16x16x32_bf16 v[32:35], a[44:47], a[4:7], v[32:35]
    s_add_u32 m0, s97, 2048
    ds_read_b64_tr_b16 a[116:117], v145 offset:55328
    ds_read_b64_tr_b16 a[118:119], v145 offset:59936
    ds_read2_b32 v[204:205], v199 offset0:4 offset1:5
    ds_read2_b32 v[206:207], v199 offset0:6 offset1:7
    v_mfma_f32_16x16x32_bf16 v[36:39], a[44:47], a[76:79], v[36:39]
    buffer_load_dwordx4 v226, s[80:83], s96 offen lds
    ds_read_b32 v208, v199 offset:32
    v_add_u32 v209, 3456, v189
    v_mfma_f32_16x16x32_bf16 v[40:43], a[44:47], a[148:151], v[40:43]
    v_exp_f32 v222, v222
    v_exp_f32 v223, v223
    v_mfma_f32_16x16x32_bf16 v[44:47], a[44:47], a[220:223], v[44:47]
    v_add_f32 v244, v220, v221
    v_add_f32 v245, v222, v223
    v_add_f32 v244, v244, v245
    v_mov_b32 v245, v244
    s_nop 1
    v_permlane32_swap_b32 v244, v245
    v_mfma_f32_16x16x32_bf16 v[60:63], a[48:51], a[220:223], v[60:63]
    s_add_u32 m0, s97, 4096
    ds_read_b64_tr_b16 a[40:41], v145 offset:55360
    ds_read_b64_tr_b16 a[42:43], v145 offset:59968
    ds_read2_b32 v[210:211], v209 offset0:0 offset1:1
    ds_read2_b32 v[212:213], v209 offset0:2 offset1:3
    v_mfma_f32_16x16x32_bf16 v[56:59], a[48:51], a[148:151], v[56:59]
    buffer_load_dwordx4 v227, s[80:83], s96 offen lds
    ds_read2_b32 v[214:215], v209 offset0:4 offset1:5
    v_add_f32 v244, v244, v245
    v_mfma_f32_16x16x32_bf16 v[52:55], a[48:51], a[76:79], v[52:55]
    v_rcp_f32 v244, v244
    s_nop 0
    v_mul_f32 v220, v220, v244
    v_mfma_f32_16x16x32_bf16 v[48:51], a[48:51], a[4:7], v[48:51]
    v_mul_f32 v221, v221, v244
    v_mul_f32 v222, v222, v244
    v_mul_f32 v223, v223, v244
    v_cvt_pk_bf16_f32 v248, v220, 0
    v_mfma_f32_16x16x32_bf16 v[64:67], a[52:55], a[4:7], v[64:67]
    s_add_u32 m0, s97, 6144
    ds_read_b64_tr_b16 a[44:45], v145 offset:55392
    ds_read_b64_tr_b16 a[46:47], v145 offset:60000
    ds_read2_b32 v[216:217], v209 offset0:6 offset1:7
    ds_read_b32 v218, v209 offset:32
    v_mfma_f32_16x16x32_bf16 v[68:71], a[52:55], a[76:79], v[68:71]
    buffer_load_dwordx4 v228, s[80:83], s96 offen lds
    v_cvt_pk_bf16_f32 v249, 0, v220
    v_cvt_pk_bf16_f32 v250, v221, 0
    v_cvt_pk_bf16_f32 v251, 0, v221
    v_mfma_f32_16x16x32_bf16 v[72:75], a[52:55], a[148:151], v[72:75]
    s_mul_i32 m0, s89, 0x2400
    v_cvt_pk_bf16_f32 v252, v222, 0
    v_cvt_pk_bf16_f32 v253, 0, v222
    v_cvt_pk_bf16_f32 v254, v223, 0
    v_cvt_pk_bf16_f32 v255, 0, v223
    v_mfma_f32_16x16x32_bf16 v[76:79], a[52:55], a[220:223], v[76:79]
    s_waitcnt lgkmcnt(15)
    s_add_u32 m0, m0, s97
    s_add_u32 m0, m0, 8192
    v_mfma_f32_16x16x32_bf16 v[92:95], a[56:59], a[220:223], v[92:95]
    ds_read_b64_tr_b16 a[48:49], v145 offset:55424
    ds_read_b64_tr_b16 a[50:51], v145 offset:60032
    v_mfma_f32_16x16x32_bf16 v[88:91], a[56:59], a[148:151], v[88:91]
    buffer_load_dwordx4 v229, s[80:83], s96 offen lds
    v_mfma_f32_16x16x32_bf16 v[84:87], a[56:59], a[76:79], v[84:87]
    s_add_u32 m0, s97, 19456
    v_mfma_f32_16x16x32_bf16 v[80:83], a[56:59], a[4:7], v[80:83]
    buffer_load_dwordx4 v230, s[80:83], s96 offen lds
    v_mfma_f32_16x16x32_bf16 v[96:99], a[60:63], a[4:7], v[96:99]
    s_add_u32 m0, s97, 21504
    ds_read_b64_tr_b16 a[52:53], v145 offset:55456
    ds_read_b64_tr_b16 a[54:55], v145 offset:60064
    v_mfma_f32_16x16x32_bf16 v[100:103], a[60:63], a[76:79], v[100:103]
    buffer_load_dwordx4 v231, s[80:83], s96 offen lds
    v_mfma_f32_16x16x32_bf16 v[104:107], a[60:63], a[148:151], v[104:107]
    s_add_u32 m0, s97, 23552
    s_waitcnt lgkmcnt(4)
    v_dot2_f32_bf16 v151, v180, v248, 0
    v_dot2_f32_bf16 v152, v180, v249, 0
    v_dot2_f32_bf16 v153, v181, v248, 0
    v_dot2_f32_bf16 v154, v181, v249, 0
    v_dot2_f32_bf16 v155, v182, v248, 0
    v_dot2_f32_bf16 v156, v182, v249, 0
    v_dot2_f32_bf16 v157, v183, v248, 0
    v_dot2_f32_bf16 v158, v183, v249, 0
    v_dot2_f32_bf16 v159, v184, v248, 0
    v_dot2_f32_bf16 v224, v184, v249, 0
    v_dot2_f32_bf16 v234, v185, v248, 0
    v_dot2_f32_bf16 v235, v185, v249, 0
    v_dot2_f32_bf16 v236, v186, v248, 0
    v_dot2_f32_bf16 v237, v186, v249, 0
    v_dot2_f32_bf16 v238, v187, v248, 0
    v_dot2_f32_bf16 v239, v187, v249, 0
    v_dot2_f32_bf16 v240, v188, v248, 0
    v_dot2_f32_bf16 v241, v188, v249, 0
    v_dot2_f32_bf16 v151, v190, v250, v151
    v_dot2_f32_bf16 v152, v190, v251, v152
    v_dot2_f32_bf16 v153, v191, v250, v153
    v_dot2_f32_bf16 v154, v191, v251, v154
    v_dot2_f32_bf16 v155, v192, v250, v155
    v_dot2_f32_bf16 v156, v192, v251, v156
    v_dot2_f32_bf16 v157, v193, v250, v157
    v_dot2_f32_bf16 v158, v193, v251, v158
    v_dot2_f32_bf16 v159, v194, v250, v159
    v_dot2_f32_bf16 v224, v194, v251, v224
    v_dot2_f32_bf16 v234, v195, v250, v234
    v_dot2_f32_bf16 v235, v195, v251, v235
    v_dot2_f32_bf16 v236, v196, v250, v236
    v_dot2_f32_bf16 v237, v196, v251, v237
    v_dot2_f32_bf16 v238, v197, v250, v238
    v_dot2_f32_bf16 v239, v197, v251, v239
    v_dot2_f32_bf16 v240, v198, v250, v240
    v_dot2_f32_bf16 v241, v198, v251, v241
    v_dot2_f32_bf16 v151, v200, v252, v151
    v_dot2_f32_bf16 v152, v200, v253, v152
    v_dot2_f32_bf16 v153, v201, v252, v153
    v_dot2_f32_bf16 v154, v201, v253, v154
    v_dot2_f32_bf16 v155, v202, v252, v155
    v_dot2_f32_bf16 v156, v202, v253, v156
    v_dot2_f32_bf16 v157, v203, v252, v157
    v_dot2_f32_bf16 v158, v203, v253, v158
    v_dot2_f32_bf16 v159, v204, v252, v159
    v_dot2_f32_bf16 v224, v204, v253, v224
    v_dot2_f32_bf16 v234, v205, v252, v234
    v_dot2_f32_bf16 v235, v205, v253, v235
    v_dot2_f32_bf16 v236, v206, v252, v236
    v_dot2_f32_bf16 v237, v206, v253, v237
    v_dot2_f32_bf16 v238, v207, v252, v238
    v_dot2_f32_bf16 v239, v207, v253, v239
    v_dot2_f32_bf16 v240, v208, v252, v240
    v_dot2_f32_bf16 v241, v208, v253, v241
    v_dot2_f32_bf16 v151, v210, v254, v151
    v_dot2_f32_bf16 v152, v210, v255, v152
    v_dot2_f32_bf16 v153, v211, v254, v153
    v_dot2_f32_bf16 v154, v211, v255, v154
    v_dot2_f32_bf16 v155, v212, v254, v155
    v_dot2_f32_bf16 v156, v212, v255, v156
    v_dot2_f32_bf16 v157, v213, v254, v157
    v_dot2_f32_bf16 v158, v213, v255, v158
    v_dot2_f32_bf16 v159, v214, v254, v159
    v_dot2_f32_bf16 v224, v214, v255, v224
    v_dot2_f32_bf16 v234, v215, v254, v234
    v_dot2_f32_bf16 v235, v215, v255, v235
    v_dot2_f32_bf16 v236, v216, v254, v236
    v_dot2_f32_bf16 v237, v216, v255, v237
    v_dot2_f32_bf16 v238, v217, v254, v238
    v_dot2_f32_bf16 v239, v217, v255, v239
    v_dot2_f32_bf16 v240, v218, v254, v240
    v_dot2_f32_bf16 v241, v218, v255, v241
    v_mfma_f32_16x16x32_bf16 v[108:111], a[60:63], a[220:223], v[108:111]
    buffer_load_dwordx4 v232, s[80:83], s96 offen lds
    v_mov_b32 v242, 0
    v_mov_b32 v243, 0
    s_nop 3
    v_permlane32_swap_b32 v151, v234
    v_mfma_f32_16x16x32_bf16 v[124:127], a[64:67], a[220:223], v[124:127]
    s_add_u32 m0, s97, 25600
    ds_read_b64_tr_b16 a[56:57], v145 offset:55488
    ds_read_b64_tr_b16 a[58:59], v145 offset:60096
    v_permlane32_swap_b32 v152, v235
    v_mfma_f32_16x16x32_bf16 v[120:123], a[64:67], a[148:151], v[120:123]
    buffer_load_dwordx4 v233, s[80:83], s96 offen lds
    v_permlane32_swap_b32 v153, v236
    v_mfma_f32_16x16x32_bf16 v[116:119], a[64:67], a[76:79], v[116:119]
    s_add_u32 s96, s96, 73728
    v_permlane32_swap_b32 v154, v237
    v_permlane32_swap_b32 v155, v238
    v_mfma_f32_16x16x32_bf16 v[112:115], a[64:67], a[4:7], v[112:115]
    v_permlane32_swap_b32 v156, v239
    v_permlane32_swap_b32 v157, v240
    v_mfma_f32_16x16x32_bf16 v[128:131], a[68:71], a[4:7], v[128:131]
    ds_read_b64_tr_b16 a[60:61], v145 offset:55520
    ds_read_b64_tr_b16 a[62:63], v145 offset:60128
    v_permlane32_swap_b32 v158, v241
    v_mfma_f32_16x16x32_bf16 v[132:135], a[68:71], a[76:79], v[132:135]
    v_permlane32_swap_b32 v159, v242
    v_permlane32_swap_b32 v224, v243
    v_mfma_f32_16x16x32_bf16 v[136:139], a[68:71], a[148:151], v[136:139]
    s_nop 0
    v_add_f32 v151, v151, v234
    v_add_f32 v152, v152, v235
    v_add_f32 v153, v153, v236
    v_add_f32 v154, v154, v237
    v_mfma_f32_16x16x32_bf16 v[140:143], a[68:71], a[220:223], v[140:143]
    v_add_f32 v155, v155, v238
    v_add_f32 v156, v156, v239
    v_add_f32 v157, v157, v240
    v_add_f32 v158, v158, v241
    v_mfma_f32_16x16x32_bf16 v[0:3], a[112:115], a[8:11], v[0:3]
    ds_read_b64_tr_b16 a[64:65], v145 offset:55552
    ds_read_b64_tr_b16 a[66:67], v145 offset:60160
    v_add_f32 v159, v159, v242
    v_add_f32 v224, v224, v243
    v_mfma_f32_16x16x32_bf16 v[4:7], a[112:115], a[80:83], v[4:7]
    buffer_load_dwordx4 a[16:19], v149, s[16:19], s98 offen offset:2048 sc1
    v_cvt_pk_bf16_f32 v170, v151, v152
    v_cvt_pk_bf16_f32 v171, v153, v154
    v_cvt_pk_bf16_f32 v172, v155, v156
    v_mfma_f32_16x16x32_bf16 v[8:11], a[112:115], a[152:155], v[8:11]
    v_cvt_pk_bf16_f32 v173, v157, v158
    v_cvt_pk_bf16_f32 v174, v159, v224
    v_mfma_f32_16x16x32_bf16 v[12:15], a[112:115], a[224:227], v[12:15]
    v_mfma_f32_16x16x32_bf16 v[28:31], a[116:119], a[224:227], v[28:31]
    ds_read_b64_tr_b16 a[68:69], v169 offset:0
    ds_read_b64_tr_b16 a[70:71], v169 offset:4608
    v_mfma_f32_16x16x32_bf16 v[24:27], a[116:119], a[152:155], v[24:27]
    buffer_store_dwordx4 v[170:173], v149, s[28:31], s62 offen sc0 sc1
    v_mfma_f32_16x16x32_bf16 v[20:23], a[116:119], a[80:83], v[20:23]
    buffer_store_dword v174, v247, s[28:31], s62 offen offset:1024 sc0 sc1
    v_mfma_f32_16x16x32_bf16 v[16:19], a[116:119], a[8:11], v[16:19]
    v_min_u32 v165, 7, v144
    v_lshlrev_b32 v165, 5, v165
    v_mfma_f32_16x16x32_bf16 v[32:35], a[40:43], a[8:11], v[32:35]
    ds_read_b64_tr_b16 a[112:113], v169 offset:32
    ds_read_b64_tr_b16 a[114:115], v169 offset:4640
    v_mfma_f32_16x16x32_bf16 v[36:39], a[40:43], a[80:83], v[36:39]
    buffer_load_dword v166, v165, s[84:87], 0 offen offset:4 sc1
    buffer_load_dwordx4 a[88:91], v149, s[16:19], s99 offen offset:2048 sc1
    v_mfma_f32_16x16x32_bf16 v[40:43], a[40:43], a[152:155], v[40:43]
    s_lshl_b32 s68, s33, 2
    s_add_u32 s68, s68, s35
    s_and_b32 s38, s68, 7
    s_lshl_b32 s38, s38, 5
    v_mfma_f32_16x16x32_bf16 v[44:47], a[40:43], a[224:227], v[44:47]
    s_lshr_b32 s39, s68, 3
    s_add_u32 s38, s38, s39
    v_bfe_u32 v167, v144, 2, 2
    v_lshlrev_b32 v167, 3, v167
    v_mfma_f32_16x16x32_bf16 v[60:63], a[44:47], a[224:227], v[60:63]
    ds_read_b64_tr_b16 a[116:117], v169 offset:64
    ds_read_b64_tr_b16 a[118:119], v169 offset:4672
    v_add_u32 v167, s38, v167
    v_mfma_f32_16x16x32_bf16 v[56:59], a[44:47], a[152:155], v[56:59]
    buffer_load_dwordx4 a[160:163], v149, s[16:19], s100 offen offset:2048 sc1
    v_and_b32 v168, 3, v144
    v_bfe_u32 v163, v167, 3, 3
    v_mfma_f32_16x16x32_bf16 v[52:55], a[44:47], a[80:83], v[52:55]
    v_lshl_add_u32 v163, v163, 2, v168
    v_and_b32 v170, 7, v167
    v_lshl_add_u32 v163, v163, 3, v170
    v_mfma_f32_16x16x32_bf16 v[48:51], a[44:47], a[8:11], v[48:51]
    s_waitcnt lgkmcnt(12)
    v_lshrrev_b32 v170, 6, v167
    v_lshl_add_u32 v163, v163, 2, v170
    v_lshlrev_b32 v163, 5, v163
    v_mfma_f32_16x16x32_bf16 v[64:67], a[48:51], a[8:11], v[64:67]
    ds_read_b64_tr_b16 a[40:41], v169 offset:96
    ds_read_b64_tr_b16 a[42:43], v169 offset:4704
    v_mov_b32 v171, 4
    v_mfma_f32_16x16x32_bf16 v[68:71], a[48:51], a[80:83], v[68:71]
    buffer_load_dwordx4 a[232:235], v149, s[16:19], s101 offen offset:2048 sc1
    s_lshl_b32 s38, s32, 6
    v_add_u32 v167, s38, v144
    v_mfma_f32_16x16x32_bf16 v[72:75], a[48:51], a[152:155], v[72:75]
    v_mul_u32_u24 v168, 3641, v167
    v_bfe_u32 v168, v168, 18, 3
    v_xor_b32 v151, v167, v168
    v_mfma_f32_16x16x32_bf16 v[76:79], a[48:51], a[224:227], v[76:79]
    v_lshlrev_b32 v151, 4, v151
    v_add_u32 v167, 256, v167
    v_mul_u32_u24 v168, 3641, v167
    v_mfma_f32_16x16x32_bf16 v[92:95], a[52:55], a[224:227], v[92:95]
    ds_read_b64_tr_b16 a[44:45], v169 offset:128
    ds_read_b64_tr_b16 a[46:47], v169 offset:4736
    v_bfe_u32 v168, v168, 18, 3
    v_mfma_f32_16x16x32_bf16 v[88:91], a[52:55], a[152:155], v[88:91]
    buffer_load_dwordx4 a[20:23], v149, s[16:19], s98 offen offset:3072 sc1
    v_xor_b32 v152, v167, v168
    v_lshlrev_b32 v152, 4, v152
    v_mfma_f32_16x16x32_bf16 v[84:87], a[52:55], a[80:83], v[84:87]
    s_add_u32 s98, s98, 4096
    buffer_load_dwordx4 a[92:95], v149, s[16:19], s99 offen offset:3072 sc1
    v_add_u32 v167, 256, v167
    v_mul_u32_u24 v168, 3641, v167
    v_mfma_f32_16x16x32_bf16 v[80:83], a[52:55], a[8:11], v[80:83]
    s_waitcnt lgkmcnt(12)
    v_bfe_u32 v168, v168, 18, 3
    v_xor_b32 v153, v167, v168
    v_lshlrev_b32 v153, 4, v153
    v_mfma_f32_16x16x32_bf16 v[96:99], a[56:59], a[8:11], v[96:99]
    s_add_u32 s99, s99, 4096
    ds_read_b64_tr_b16 a[48:49], v169 offset:160
    ds_read_b64_tr_b16 a[50:51], v169 offset:4768
    v_add_u32 v167, 256, v167
    v_mfma_f32_16x16x32_bf16 v[100:103], a[56:59], a[80:83], v[100:103]
    buffer_load_dwordx4 a[164:167], v149, s[16:19], s100 offen offset:3072 sc1
    v_mul_u32_u24 v168, 3641, v167
    v_bfe_u32 v168, v168, 18, 3
    v_mfma_f32_16x16x32_bf16 v[104:107], a[56:59], a[152:155], v[104:107]
    s_add_u32 s100, s100, 4096
    buffer_load_dwordx4 a[236:239], v149, s[16:19], s101 offen offset:3072 sc1
    v_xor_b32 v154, v167, v168
    v_lshlrev_b32 v154, 4, v154
    v_mfma_f32_16x16x32_bf16 v[108:111], a[56:59], a[224:227], v[108:111]
    s_add_u32 s101, s101, 4096
    v_add_u32 v167, 256, v167
    v_mul_u32_u24 v168, 3641, v167
    v_bfe_u32 v168, v168, 18, 3
    v_mfma_f32_16x16x32_bf16 v[124:127], a[60:63], a[224:227], v[124:127]
    ds_read_b64_tr_b16 a[52:53], v169 offset:192
    ds_read_b64_tr_b16 a[54:55], v169 offset:4800
    v_xor_b32 v155, v167, v168
    v_mfma_f32_16x16x32_bf16 v[120:123], a[60:63], a[152:155], v[120:123]
    buffer_load_dwordx4 a[24:27], v149, s[16:19], s98 offen offset:0 sc1
    v_lshlrev_b32 v155, 4, v155
    v_add_u32 v167, 256, v167
    v_mfma_f32_16x16x32_bf16 v[116:119], a[60:63], a[80:83], v[116:119]
    buffer_load_dwordx4 a[96:99], v149, s[16:19], s99 offen offset:0 sc1
    v_mul_u32_u24 v168, 3641, v167
    v_bfe_u32 v168, v168, 18, 3
    v_mfma_f32_16x16x32_bf16 v[112:115], a[60:63], a[8:11], v[112:115]
    s_waitcnt lgkmcnt(12)
    v_xor_b32 v156, v167, v168
    v_lshlrev_b32 v156, 4, v156
    v_add_u32 v167, 256, v167
    v_mfma_f32_16x16x32_bf16 v[128:131], a[64:67], a[8:11], v[128:131]
    ds_read_b64_tr_b16 a[56:57], v169 offset:224
    ds_read_b64_tr_b16 a[58:59], v169 offset:4832
    v_mul_u32_u24 v168, 3641, v167
    v_mfma_f32_16x16x32_bf16 v[132:135], a[64:67], a[80:83], v[132:135]
    buffer_load_dwordx4 a[168:171], v149, s[16:19], s100 offen offset:0 sc1
    v_bfe_u32 v168, v168, 18, 3
    v_xor_b32 v157, v167, v168
    v_mfma_f32_16x16x32_bf16 v[136:139], a[64:67], a[152:155], v[136:139]
    buffer_load_dwordx4 a[240:243], v149, s[16:19], s101 offen offset:0 sc1
    v_lshlrev_b32 v157, 4, v157
    v_add_u32 v167, 256, v167
    v_mfma_f32_16x16x32_bf16 v[140:143], a[64:67], a[224:227], v[140:143]
    s_waitcnt vmcnt(33)
    v_mul_u32_u24 v168, 3641, v167
    v_bfe_u32 v168, v168, 18, 3
    v_xor_b32 v158, v167, v168
    v_mfma_f32_16x16x32_bf16 v[0:3], a[68:71], a[12:15], v[0:3]
    ds_read_b64_tr_b16 a[60:61], v169 offset:256
    ds_read_b64_tr_b16 a[62:63], v169 offset:4864
    v_lshlrev_b32 v158, 4, v158
    v_mfma_f32_16x16x32_bf16 v[4:7], a[68:71], a[84:87], v[4:7]
    buffer_load_dwordx4 a[28:31], v149, s[16:19], s98 offen offset:1024 sc1
    v_add_u32 v167, 256, v167
    v_mul_u32_u24 v168, 3641, v167
    v_mfma_f32_16x16x32_bf16 v[8:11], a[68:71], a[156:159], v[8:11]
    buffer_load_dwordx4 a[100:103], v149, s[16:19], s99 offen offset:1024 sc1
    v_bfe_u32 v168, v168, 18, 3
    v_xor_b32 v159, v167, v168
    v_mfma_f32_16x16x32_bf16 v[12:15], a[68:71], a[228:231], v[12:15]
    s_waitcnt lgkmcnt(12)
    v_lshlrev_b32 v159, 4, v159
    s_waitcnt vmcnt(17)
    s_barrier
    v_mfma_f32_16x16x32_bf16 v[28:31], a[112:115], a[228:231], v[28:31]
    ds_read_b64_tr_b16 a[64:65], v146 offset:0
    ds_read_b64_tr_b16 a[66:67], v146 offset:4608
    v_mfma_f32_16x16x32_bf16 v[24:27], a[112:115], a[156:159], v[24:27]
    buffer_load_dwordx4 a[172:175], v149, s[16:19], s100 offen offset:1024 sc1
    v_mfma_f32_16x16x32_bf16 v[20:23], a[112:115], a[84:87], v[20:23]
    buffer_load_dwordx4 a[244:247], v149, s[16:19], s101 offen offset:1024 sc1
    v_mfma_f32_16x16x32_bf16 v[16:19], a[112:115], a[12:15], v[16:19]
    v_mfma_f32_16x16x32_bf16 v[32:35], a[116:119], a[12:15], v[32:35]
    ds_read_b64_tr_b16 a[68:69], v146 offset:18432
    ds_read_b64_tr_b16 a[70:71], v146 offset:23040
    v_mfma_f32_16x16x32_bf16 v[36:39], a[116:119], a[84:87], v[36:39]
    v_mfma_f32_16x16x32_bf16 v[40:43], a[116:119], a[156:159], v[40:43]
    v_mfma_f32_16x16x32_bf16 v[44:47], a[116:119], a[228:231], v[44:47]
    s_waitcnt lgkmcnt(12)
    v_mfma_f32_16x16x32_bf16 v[60:63], a[40:43], a[228:231], v[60:63]
    ds_read_b64_tr_b16 a[112:113], v145 offset:0
    ds_read_b64_tr_b16 a[114:115], v145 offset:4608
    v_mfma_f32_16x16x32_bf16 v[56:59], a[40:43], a[156:159], v[56:59]
    s_waitcnt vmcnt(15)
    v_cmp_gt_u32 vcc, 32, v166
    s_nop 4
    s_cbranch_vccnz C7_spin
C7_ret:
    v_mfma_f32_16x16x32_bf16 v[52:55], a[40:43], a[84:87], v[52:55]
    v_mfma_f32_16x16x32_bf16 v[48:51], a[40:43], a[12:15], v[48:51]
    v_mfma_f32_16x16x32_bf16 v[64:67], a[44:47], a[12:15], v[64:67]
    ds_read_b64_tr_b16 a[116:117], v145 offset:18432
    ds_read_b64_tr_b16 a[118:119], v145 offset:23040
    v_mfma_f32_16x16x32_bf16 v[68:71], a[44:47], a[84:87], v[68:71]
    s_mov_b64 exec, 1
    buffer_store_dword v171, off, s[92:95], s5 sc0 sc1
    s_mov_b64 exec, -1
    v_mfma_f32_16x16x32_bf16 v[72:75], a[44:47], a[156:159], v[72:75]
    s_mul_i32 s69, s68, 36864
    s_lshl_b32 s38, s67, 5
    s_add_u32 s52, s69, s38
    s_mul_i32 s55, s68, 36
    v_mfma_f32_16x16x32_bf16 v[76:79], a[44:47], a[228:231], v[76:79]
    s_waitcnt lgkmcnt(12)
    s_add_u32 s55, s55, s67
    s_lshl_b32 s55, s55, 10
    v_mfma_f32_16x16x32_bf16 v[92:95], a[48:51], a[228:231], v[92:95]
    ds_read_b64_tr_b16 a[40:41], v146 offset:32
    ds_read_b64_tr_b16 a[42:43], v146 offset:4640
    v_mfma_f32_16x16x32_bf16 v[88:91], a[48:51], a[156:159], v[88:91]
    s_cmp_eq_u32 s32, 0
    s_cselect_b32 s54, s52, 1073741824
    s_cselect_b32 s60, s55, 1073741824
    v_and_b32 v167, 15, v144
    v_mfma_f32_16x16x32_bf16 v[84:87], a[48:51], a[84:87], v[84:87]
    v_mul_u32_u24 v160, 1152, v167
    v_lshrrev_b32 v168, 4, v144
    v_and_b32 v161, 7, v167
    v_mfma_f32_16x16x32_bf16 v[80:83], a[48:51], a[12:15], v[80:83]
    v_xor_b32 v161, v161, v168
    v_xor_b32 v162, 4, v161
    v_add_u32 v167, 110592, v160
    v_mfma_f32_16x16x32_bf16 v[96:99], a[52:55], a[12:15], v[96:99]
    ds_read_b64_tr_b16 a[44:45], v146 offset:18464
    ds_read_b64_tr_b16 a[46:47], v146 offset:23072
    v_lshl_add_u32 v161, v161, 4, v167
    v_mfma_f32_16x16x32_bf16 v[100:103], a[52:55], a[84:87], v[100:103]
    buffer_load_dwordx4 a[120:123], v149, s[56:59], s47 offen offset:0 sc1
    v_lshl_add_u32 v162, v162, 4, v167
    v_and_b32 v167, 1, v168
    v_mfma_f32_16x16x32_bf16 v[104:107], a[52:55], a[156:159], v[104:107]
    v_mul_u32_u24 v167, 18432, v167
    v_add_u32 v160, v160, v167
    v_lshrrev_b32 v168, 1, v168
    v_mfma_f32_16x16x32_bf16 v[108:111], a[52:55], a[228:231], v[108:111]
    s_waitcnt lgkmcnt(12)
    v_lshl_add_u32 v160, v168, 4, v160
    s_mov_b32 s86, 2359296
    s_mov_b64 s[84:85], s[6:7]
    v_mfma_f32_16x16x32_bf16 v[124:127], a[56:59], a[228:231], v[124:127]
    ds_read_b64_tr_b16 a[48:49], v145 offset:32
    ds_read_b64_tr_b16 a[50:51], v145 offset:4640
    v_mfma_f32_16x16x32_bf16 v[120:123], a[56:59], a[156:159], v[120:123]
    buffer_load_dwordx4 a[124:127], v149, s[56:59], s48 offen offset:0 sc1
    v_mfma_f32_16x16x32_bf16 v[116:119], a[56:59], a[84:87], v[116:119]
    s_and_b32 s38, s4, 255
    s_cmp_eq_u32 s38, s2
    s_cselect_b32 s22, 2359296, 0
    v_mfma_f32_16x16x32_bf16 v[112:115], a[56:59], a[12:15], v[112:115]
    s_mov_b32 s23, 0x00020000
    s_lshl_b32 s45, s32, 10
    v_mfma_f32_16x16x32_bf16 v[128:131], a[60:63], a[12:15], v[128:131]
    ds_read_b64_tr_b16 a[52:53], v145 offset:18464
    ds_read_b64_tr_b16 a[54:55], v145 offset:23072
    v_mfma_f32_16x16x32_bf16 v[132:135], a[60:63], a[84:87], v[132:135]
    buffer_load_dwordx4 a[128:131], v149, s[56:59], s49 offen offset:0 sc1
    v_mfma_f32_16x16x32_bf16 v[136:139], a[60:63], a[156:159], v[136:139]
    buffer_load_dwordx4 a[132:135], v149, s[56:59], s47 offen offset:1024 sc1
    v_mfma_f32_16x16x32_bf16 v[140:143], a[60:63], a[228:231], v[140:143]
    s_waitcnt vmcnt(17)
    s_waitcnt lgkmcnt(12)
    v_mfma_f32_16x16x32_bf16 v[0:3], a[64:67], a[16:19], v[0:3]
    ds_read_b64_tr_b16 a[56:57], v146 offset:64
    ds_read_b64_tr_b16 a[58:59], v146 offset:4672
    v_mfma_f32_16x16x32_bf16 v[4:7], a[64:67], a[88:91], v[4:7]
    buffer_load_dwordx4 a[136:139], v149, s[56:59], s48 offen offset:1024 sc1
    v_mfma_f32_16x16x32_bf16 v[8:11], a[64:67], a[160:163], v[8:11]
    v_mfma_f32_16x16x32_bf16 v[12:15], a[64:67], a[232:235], v[12:15]
    s_waitcnt vmcnt(14)
    v_mfma_f32_16x16x32_bf16 v[0:3], a[68:71], a[20:23], v[0:3]
    ds_read_b64_tr_b16 a[60:61], v146 offset:18496
    ds_read_b64_tr_b16 a[62:63], v146 offset:23104
    v_mfma_f32_16x16x32_bf16 v[4:7], a[68:71], a[92:95], v[4:7]
    buffer_load_dwordx4 a[140:143], v149, s[56:59], s49 offen offset:1024 sc1
    v_mfma_f32_16x16x32_bf16 v[8:11], a[68:71], a[164:167], v[8:11]
    v_mfma_f32_16x16x32_bf16 v[12:15], a[68:71], a[236:239], v[12:15]
    s_waitcnt vmcnt(11)
    s_waitcnt lgkmcnt(12)
    v_mfma_f32_16x16x32_bf16 v[0:3], a[112:115], a[24:27], v[0:3]
    ds_read_b64_tr_b16 a[64:65], v145 offset:64
    ds_read_b64_tr_b16 a[66:67], v145 offset:4672
    v_mfma_f32_16x16x32_bf16 v[4:7], a[112:115], a[96:99], v[4:7]
    buffer_load_dwordx4 a[184:187], v149, s[56:59], s47 offen offset:2048 sc1
    v_mfma_f32_16x16x32_bf16 v[8:11], a[112:115], a[168:171], v[8:11]
    v_mfma_f32_16x16x32_bf16 v[12:15], a[112:115], a[240:243], v[12:15]
    s_waitcnt vmcnt(8)
    v_mfma_f32_16x16x32_bf16 v[0:3], a[116:119], a[28:31], v[0:3]
    ds_read_b64_tr_b16 a[68:69], v145 offset:18496
    ds_read_b64_tr_b16 a[70:71], v145 offset:23104
    v_mfma_f32_16x16x32_bf16 v[4:7], a[116:119], a[100:103], v[4:7]
    buffer_load_dwordx4 a[188:191], v149, s[56:59], s48 offen offset:2048 sc1
    v_mfma_f32_16x16x32_bf16 v[8:11], a[116:119], a[172:175], v[8:11]
    v_mfma_f32_16x16x32_bf16 v[12:15], a[116:119], a[244:247], v[12:15]
    s_waitcnt lgkmcnt(12)
    v_mfma_f32_16x16x32_bf16 v[16:19], a[40:43], a[16:19], v[16:19]
    ds_read_b64_tr_b16 a[112:113], v146 offset:96
    ds_read_b64_tr_b16 a[114:115], v146 offset:4704
    v_mfma_f32_16x16x32_bf16 v[20:23], a[40:43], a[88:91], v[20:23]
    buffer_load_dwordx4 a[192:195], v149, s[56:59], s49 offen offset:2048 sc1
    v_mfma_f32_16x16x32_bf16 v[24:27], a[40:43], a[160:163], v[24:27]
    v_mfma_f32_16x16x32_bf16 v[28:31], a[40:43], a[232:235], v[28:31]
    v_cvt_pk_f16_f32 v8, v8, v9
    v_cvt_pk_f16_f32 v9, v10, v11
    v_mfma_f32_16x16x32_bf16 v[16:19], a[44:47], a[20:23], v[16:19]
    ds_read_b64_tr_b16 a[116:117], v146 offset:18528
    ds_read_b64_tr_b16 a[118:119], v146 offset:23136
    v_mfma_f32_16x16x32_bf16 v[20:23], a[44:47], a[92:95], v[20:23]
    buffer_load_dwordx4 a[196:199], v149, s[56:59], s47 offen offset:3072 sc1
    v_cvt_pk_f16_f32 v10, v12, v13
    v_mfma_f32_16x16x32_bf16 v[24:27], a[44:47], a[164:167], v[24:27]
    s_add_u32 s47, s47, 4096
    buffer_load_dwordx4 a[200:203], v149, s[56:59], s48 offen offset:3072 sc1
    v_cvt_pk_f16_f32 v11, v14, v15
    v_mfma_f32_16x16x32_bf16 v[28:31], a[44:47], a[236:239], v[28:31]
    s_waitcnt lgkmcnt(12)
    ds_write_b128 v179, v[8:11] offset:36864
    v_mfma_f32_16x16x32_bf16 v[16:19], a[48:51], a[24:27], v[16:19]
    s_add_u32 s48, s48, 4096
    ds_read_b64_tr_b16 a[40:41], v145 offset:96
    ds_read_b64_tr_b16 a[42:43], v145 offset:4704
    v_mfma_f32_16x16x32_bf16 v[20:23], a[48:51], a[96:99], v[20:23]
    buffer_load_dwordx4 a[204:207], v149, s[56:59], s49 offen offset:3072 sc1
    s_add_u32 s49, s49, 4096
    v_mfma_f32_16x16x32_bf16 v[24:27], a[48:51], a[168:171], v[24:27]
    v_mfma_f32_16x16x32_bf16 v[28:31], a[48:51], a[240:243], v[28:31]
    v_mfma_f32_16x16x32_bf16 v[16:19], a[52:55], a[28:31], v[16:19]
    ds_read_b64_tr_b16 a[44:45], v145 offset:18528
    ds_read_b64_tr_b16 a[46:47], v145 offset:23136
    v_mfma_f32_16x16x32_bf16 v[20:23], a[52:55], a[100:103], v[20:23]
    buffer_load_dwordx4 a[208:211], v149, s[56:59], s47 offen offset:0 sc1
    v_mfma_f32_16x16x32_bf16 v[24:27], a[52:55], a[172:175], v[24:27]
    v_mfma_f32_16x16x32_bf16 v[28:31], a[52:55], a[244:247], v[28:31]
    s_waitcnt lgkmcnt(13)
    v_mfma_f32_16x16x32_bf16 v[32:35], a[56:59], a[16:19], v[32:35]
    ds_read_b64_tr_b16 a[48:49], v146 offset:128
    ds_read_b64_tr_b16 a[50:51], v146 offset:4736
    v_mfma_f32_16x16x32_bf16 v[36:39], a[56:59], a[88:91], v[36:39]
    buffer_load_dwordx4 a[212:215], v149, s[56:59], s48 offen offset:0 sc1
    v_mfma_f32_16x16x32_bf16 v[40:43], a[56:59], a[160:163], v[40:43]
    v_mfma_f32_16x16x32_bf16 v[44:47], a[56:59], a[232:235], v[44:47]
    v_cvt_pk_f16_f32 v24, v24, v25
    v_cvt_pk_f16_f32 v25, v26, v27
    v_mfma_f32_16x16x32_bf16 v[32:35], a[60:63], a[20:23], v[32:35]
    ds_read_b64_tr_b16 a[52:53], v146 offset:18560
    ds_read_b64_tr_b16 a[54:55], v146 offset:23168
    v_mfma_f32_16x16x32_bf16 v[36:39], a[60:63], a[92:95], v[36:39]
    buffer_load_dwordx4 a[32:35], v149, s[56:59], s49 offen offset:0 sc1
    v_cvt_pk_f16_f32 v26, v28, v29
    v_mfma_f32_16x16x32_bf16 v[40:43], a[60:63], a[164:167], v[40:43]
    v_cvt_pk_f16_f32 v27, v30, v31
    v_mfma_f32_16x16x32_bf16 v[44:47], a[60:63], a[236:239], v[44:47]
    s_waitcnt lgkmcnt(13)
    ds_write_b128 v179, v[24:27] offset:38912
    v_mfma_f32_16x16x32_bf16 v[32:35], a[64:67], a[24:27], v[32:35]
    ds_read_b64_tr_b16 a[56:57], v145 offset:128
    ds_read_b64_tr_b16 a[58:59], v145 offset:4736
    v_mfma_f32_16x16x32_bf16 v[36:39], a[64:67], a[96:99], v[36:39]
    buffer_load_dwordx4 a[104:107], v149, s[56:59], s47 offen offset:1024 sc1
    v_mfma_f32_16x16x32_bf16 v[40:43], a[64:67], a[168:171], v[40:43]
    v_mfma_f32_16x16x32_bf16 v[44:47], a[64:67], a[240:243], v[44:47]
    v_mfma_f32_16x16x32_bf16 v[32:35], a[68:71], a[28:31], v[32:35]
    ds_read_b64_tr_b16 a[60:61], v145 offset:18560
    ds_read_b64_tr_b16 a[62:63], v145 offset:23168
    v_mfma_f32_16x16x32_bf16 v[36:39], a[68:71], a[100:103], v[36:39]
    s_waitcnt lgkmcnt(4)
    s_barrier
    buffer_load_dwordx4 a[176:179], v149, s[56:59], s48 offen offset:1024 sc1
    v_mfma_f32_16x16x32_bf16 v[40:43], a[68:71], a[172:175], v[40:43]
    buffer_load_dwordx4 a[248:251], v149, s[56:59], s49 offen offset:1024 sc1
    ds_read_b128 v[12:15], v148 offset:36864
    v_mfma_f32_16x16x32_bf16 v[44:47], a[68:71], a[244:247], v[44:47]
    ds_read_b128 v[28:31], v148 offset:38912
    buffer_load_dword v164, v163, s[92:95], 0 offen sc1
    v_mfma_f32_16x16x32_bf16 v[48:51], a[112:115], a[16:19], v[48:51]
    ds_read_b64_tr_b16 a[64:65], v146 offset:160
    ds_read_b64_tr_b16 a[66:67], v146 offset:4768
    v_mfma_f32_16x16x32_bf16 v[52:55], a[112:115], a[88:91], v[52:55]
    buffer_load_dwordx4 a[36:39], v149, s[56:59], s47 offen offset:2048 sc1
    v_mfma_f32_16x16x32_bf16 v[56:59], a[112:115], a[160:163], v[56:59]
    v_mfma_f32_16x16x32_bf16 v[60:63], a[112:115], a[232:235], v[60:63]
    v_cvt_pk_f16_f32 v40, v40, v41
    v_cvt_pk_f16_f32 v41, v42, v43
    v_mfma_f32_16x16x32_bf16 v[48:51], a[116:119], a[20:23], v[48:51]
    ds_read_b64_tr_b16 a[68:69], v146 offset:18592
    ds_read_b64_tr_b16 a[70:71], v146 offset:23200
    v_mfma_f32_16x16x32_bf16 v[52:55], a[116:119], a[92:95], v[52:55]
    s_waitcnt lgkmcnt(5)
    buffer_load_dwordx4 a[108:111], v149, s[56:59], s48 offen offset:2048 sc1
    v_cvt_pk_f16_f32 v42, v44, v45
    v_mfma_f32_16x16x32_bf16 v[56:59], a[116:119], a[164:167], v[56:59]
    v_cvt_pk_f16_f32 v43, v46, v47
    v_fma_mix_f32 v0, v12, 1.0, v0 op_sel_hi:[1,0,0]
    v_mfma_f32_16x16x32_bf16 v[60:63], a[116:119], a[236:239], v[60:63]
    ds_write_b128 v179, v[40:43] offset:53248
    v_mfma_f32_16x16x32_bf16 v[48:51], a[40:43], a[24:27], v[48:51]
    ds_read_b64_tr_b16 a[112:113], v145 offset:160
    ds_read_b64_tr_b16 a[114:115], v145 offset:4768
    v_mfma_f32_16x16x32_bf16 v[52:55], a[40:43], a[96:99], v[52:55]
    buffer_load_dwordx4 a[180:183], v149, s[56:59], s49 offen offset:2048 sc1
    v_fma_mix_f32 v1, v12, 1.0, v1 op_sel:[1,0,0] op_sel_hi:[1,0,0]
    v_mfma_f32_16x16x32_bf16 v[56:59], a[40:43], a[168:171], v[56:59]
    v_fma_mix_f32 v2, v13, 1.0, v2 op_sel_hi:[1,0,0]
    v_fma_mix_f32 v3, v13, 1.0, v3 op_sel:[1,0,0] op_sel_hi:[1,0,0]
    v_mfma_f32_16x16x32_bf16 v[60:63], a[40:43], a[240:243], v[60:63]
    v_fma_mix_f32 v4, v14, 1.0, v4 op_sel_hi:[1,0,0]
    v_fma_mix_f32 v5, v14, 1.0, v5 op_sel:[1,0,0] op_sel_hi:[1,0,0]
    v_mfma_f32_16x16x32_bf16 v[48:51], a[44:47], a[28:31], v[48:51]
    ds_read_b64_tr_b16 a[116:117], v145 offset:18592
    ds_read_b64_tr_b16 a[118:119], v145 offset:23200
    v_mfma_f32_16x16x32_bf16 v[52:55], a[44:47], a[100:103], v[52:55]
    buffer_load_dwordx4 a[252:255], v149, s[56:59], s47 offen offset:3072 sc1
    v_fma_mix_f32 v6, v15, 1.0, v6 op_sel_hi:[1,0,0]
    v_mfma_f32_16x16x32_bf16 v[56:59], a[44:47], a[172:175], v[56:59]
    s_add_u32 s47, s47, 4096
    v_fma_mix_f32 v7, v15, 1.0, v7 op_sel:[1,0,0] op_sel_hi:[1,0,0]
    v_cvt_pk_f16_f32 v0, v0, v1
    v_mfma_f32_16x16x32_bf16 v[60:63], a[44:47], a[244:247], v[60:63]
    v_cvt_pk_f16_f32 v1, v2, v3
    v_cvt_pk_f16_f32 v2, v4, v5
    v_mfma_f32_16x16x32_bf16 v[64:67], a[48:51], a[16:19], v[64:67]
    ds_read_b64_tr_b16 a[40:41], v146 offset:192
    ds_read_b64_tr_b16 a[42:43], v146 offset:4800
    v_mfma_f32_16x16x32_bf16 v[68:71], a[48:51], a[88:91], v[68:71]
    buffer_load_dwordx4 a[0:3], v149, s[56:59], s48 offen offset:3072 sc1
    v_cvt_pk_f16_f32 v3, v6, v7
    v_mfma_f32_16x16x32_bf16 v[72:75], a[48:51], a[160:163], v[72:75]
    s_add_u32 s48, s48, 4096
    buffer_store_dwordx4 v[0:3], v149, s[12:15], s41 offen offset:0 sc0 sc1
    s_waitcnt lgkmcnt(11)
    v_mfma_f32_16x16x32_bf16 v[76:79], a[48:51], a[232:235], v[76:79]
    v_cvt_pk_f16_f32 v56, v56, v57
    v_cvt_pk_f16_f32 v57, v58, v59
    v_mfma_f32_16x16x32_bf16 v[64:67], a[52:55], a[20:23], v[64:67]
    ds_read_b64_tr_b16 a[44:45], v146 offset:18624
    ds_read_b64_tr_b16 a[46:47], v146 offset:23232
    v_mfma_f32_16x16x32_bf16 v[68:71], a[52:55], a[92:95], v[68:71]
    buffer_load_dwordx4 a[72:75], v149, s[56:59], s49 offen offset:3072 sc1
    v_cvt_pk_f16_f32 v58, v60, v61
    v_mfma_f32_16x16x32_bf16 v[72:75], a[52:55], a[164:167], v[72:75]
    s_add_u32 s49, s49, 4096
    buffer_load_dwordx4 a[144:147], v149, s[56:59], s47 offen offset:0 sc1
    v_cvt_pk_f16_f32 v59, v62, v63
    v_mfma_f32_16x16x32_bf16 v[76:79], a[52:55], a[236:239], v[76:79]
    ds_write_b128 v179, v[56:59] offset:55296
    v_mfma_f32_16x16x32_bf16 v[64:67], a[56:59], a[24:27], v[64:67]
    ds_read_b64_tr_b16 a[48:49], v145 offset:192
    ds_read_b64_tr_b16 a[50:51], v145 offset:4800
    v_mfma_f32_16x16x32_bf16 v[68:71], a[56:59], a[96:99], v[68:71]
    buffer_load_dwordx4 a[216:219], v149, s[56:59], s48 offen offset:0 sc1
    v_fma_mix_f32 v16, v28, 1.0, v16 op_sel_hi:[1,0,0]
    v_mfma_f32_16x16x32_bf16 v[72:75], a[56:59], a[168:171], v[72:75]
    v_fma_mix_f32 v17, v28, 1.0, v17 op_sel:[1,0,0] op_sel_hi:[1,0,0]
    v_fma_mix_f32 v18, v29, 1.0, v18 op_sel_hi:[1,0,0]
    v_mfma_f32_16x16x32_bf16 v[76:79], a[56:59], a[240:243], v[76:79]
    v_fma_mix_f32 v19, v29, 1.0, v19 op_sel:[1,0,0] op_sel_hi:[1,0,0]
    v_fma_mix_f32 v20, v30, 1.0, v20 op_sel_hi:[1,0,0]
    v_mfma_f32_16x16x32_bf16 v[64:67], a[60:63], a[28:31], v[64:67]
    ds_read_b64_tr_b16 a[52:53], v145 offset:18624
    ds_read_b64_tr_b16 a[54:55], v145 offset:23232
    v_mfma_f32_16x16x32_bf16 v[68:71], a[60:63], a[100:103], v[68:71]
    s_waitcnt lgkmcnt(4)
    s_barrier
    buffer_load_dwordx4 a[4:7], v149, s[56:59], s49 offen offset:0 sc1
    v_mfma_f32_16x16x32_bf16 v[72:75], a[60:63], a[172:175], v[72:75]
    ds_read_b128 v[44:47], v148 offset:53248
    ds_read_b128 v[60:63], v148 offset:55296
    v_mfma_f32_16x16x32_bf16 v[76:79], a[60:63], a[244:247], v[76:79]
    v_fma_mix_f32 v21, v30, 1.0, v21 op_sel:[1,0,0] op_sel_hi:[1,0,0]
    v_fma_mix_f32 v22, v31, 1.0, v22 op_sel_hi:[1,0,0]
    v_mfma_f32_16x16x32_bf16 v[80:83], a[64:67], a[16:19], v[80:83]
    ds_read_b64_tr_b16 a[56:57], v146 offset:224
    ds_read_b64_tr_b16 a[58:59], v146 offset:4832
    v_mfma_f32_16x16x32_bf16 v[84:87], a[64:67], a[88:91], v[84:87]
    buffer_load_dwordx4 a[76:79], v149, s[56:59], s47 offen offset:1024 sc1
    v_fma_mix_f32 v23, v31, 1.0, v23 op_sel:[1,0,0] op_sel_hi:[1,0,0]
    v_mfma_f32_16x16x32_bf16 v[88:91], a[64:67], a[160:163], v[88:91]
    v_cvt_pk_f16_f32 v16, v16, v17
    v_cvt_pk_f16_f32 v17, v18, v19
    v_mfma_f32_16x16x32_bf16 v[92:95], a[64:67], a[232:235], v[92:95]
    s_waitcnt vmcnt(11)
    v_cvt_pk_f16_f32 v72, v72, v73
    v_cvt_pk_f16_f32 v73, v74, v75
    v_cmp_gt_u32 vcc, 4, v164
    s_nop 4
    s_cbranch_vccnz C5_spin
C5_ret:
    v_mfma_f32_16x16x32_bf16 v[80:83], a[68:71], a[20:23], v[80:83]
    ds_read_b64_tr_b16 a[60:61], v146 offset:18656
    ds_read_b64_tr_b16 a[62:63], v146 offset:23264
    v_mfma_f32_16x16x32_bf16 v[84:87], a[68:71], a[92:95], v[84:87]
    buffer_load_dwordx4 a[148:151], v149, s[56:59], s48 offen offset:1024 sc1
    v_cvt_pk_f16_f32 v74, v76, v77
    v_mfma_f32_16x16x32_bf16 v[88:91], a[68:71], a[164:167], v[88:91]
    v_cvt_pk_f16_f32 v75, v78, v79
    v_cvt_pk_f16_f32 v18, v20, v21
    v_mfma_f32_16x16x32_bf16 v[92:95], a[68:71], a[236:239], v[92:95]
    ds_write_b128 v179, v[72:75] offset:36864
    v_mfma_f32_16x16x32_bf16 v[80:83], a[112:115], a[24:27], v[80:83]
    s_add_u32 m0, s45, 110592
    ds_read_b64_tr_b16 a[64:65], v145 offset:224
    ds_read_b64_tr_b16 a[66:67], v145 offset:4832
    v_mfma_f32_16x16x32_bf16 v[84:87], a[112:115], a[96:99], v[84:87]
    buffer_load_dwordx4 v151, s[28:31], s69 offen sc1 lds
    v_cvt_pk_f16_f32 v19, v22, v23
    v_mfma_f32_16x16x32_bf16 v[88:91], a[112:115], a[168:171], v[88:91]
    s_add_u32 m0, s45, 114688
    buffer_store_dwordx4 v[16:19], v149, s[12:15], s41 offen offset:1024 sc0 sc1
    s_waitcnt lgkmcnt(8)
    v_mfma_f32_16x16x32_bf16 v[92:95], a[112:115], a[240:243], v[92:95]
    buffer_load_dwordx4 v152, s[28:31], s69 offen sc1 lds
    v_fma_mix_f32 v32, v44, 1.0, v32 op_sel_hi:[1,0,0]
    v_mfma_f32_16x16x32_bf16 v[80:83], a[116:119], a[28:31], v[80:83]
    s_add_u32 m0, s45, 118784
    ds_read_b64_tr_b16 a[68:69], v145 offset:18656
    ds_read_b64_tr_b16 a[70:71], v145 offset:23264
    v_mfma_f32_16x16x32_bf16 v[84:87], a[116:119], a[100:103], v[84:87]
    buffer_load_dwordx4 v153, s[28:31], s69 offen sc1 lds
    v_fma_mix_f32 v33, v44, 1.0, v33 op_sel:[1,0,0] op_sel_hi:[1,0,0]
    v_mfma_f32_16x16x32_bf16 v[88:91], a[116:119], a[172:175], v[88:91]
    s_add_u32 m0, s45, 122880
    v_fma_mix_f32 v34, v45, 1.0, v34 op_sel_hi:[1,0,0]
    v_fma_mix_f32 v35, v45, 1.0, v35 op_sel:[1,0,0] op_sel_hi:[1,0,0]
    v_mfma_f32_16x16x32_bf16 v[92:95], a[116:119], a[244:247], v[92:95]
    buffer_load_dwordx4 v154, s[28:31], s69 offen sc1 lds
    v_fma_mix_f32 v36, v46, 1.0, v36 op_sel_hi:[1,0,0]
    v_mfma_f32_16x16x32_bf16 v[96:99], a[40:43], a[16:19], v[96:99]
    s_add_u32 m0, s45, 126976
    ds_read_b64_tr_b16 a[112:113], v146 offset:256
    ds_read_b64_tr_b16 a[114:115], v146 offset:4864
    v_mfma_f32_16x16x32_bf16 v[100:103], a[40:43], a[88:91], v[100:103]
    buffer_load_dwordx4 v155, s[28:31], s69 offen sc1 lds
    v_fma_mix_f32 v37, v46, 1.0, v37 op_sel:[1,0,0] op_sel_hi:[1,0,0]
    v_mfma_f32_16x16x32_bf16 v[104:107], a[40:43], a[160:163], v[104:107]
    s_add_u32 m0, s45, 131072
    v_fma_mix_f32 v38, v47, 1.0, v38 op_sel_hi:[1,0,0]
    v_fma_mix_f32 v39, v47, 1.0, v39 op_sel:[1,0,0] op_sel_hi:[1,0,0]
    v_mfma_f32_16x16x32_bf16 v[108:111], a[40:43], a[232:235], v[108:111]
    buffer_load_dwordx4 v156, s[28:31], s69 offen sc1 lds
    v_cvt_pk_f16_f32 v88, v88, v89
    v_mfma_f32_16x16x32_bf16 v[96:99], a[44:47], a[20:23], v[96:99]
    s_add_u32 m0, s45, 135168
    ds_read_b64_tr_b16 a[116:117], v146 offset:18688
    ds_read_b64_tr_b16 a[118:119], v146 offset:23296
    v_mfma_f32_16x16x32_bf16 v[100:103], a[44:47], a[92:95], v[100:103]
    buffer_load_dwordx4 v157, s[28:31], s69 offen sc1 lds
    v_cvt_pk_f16_f32 v89, v90, v91
    v_mfma_f32_16x16x32_bf16 v[104:107], a[44:47], a[164:167], v[104:107]
    s_add_u32 m0, s45, 139264
    v_cvt_pk_f16_f32 v90, v92, v93
    v_cvt_pk_f16_f32 v91, v94, v95
    v_mfma_f32_16x16x32_bf16 v[108:111], a[44:47], a[236:239], v[108:111]
    buffer_load_dwordx4 v158, s[28:31], s69 offen sc1 lds
    v_cvt_pk_f16_f32 v32, v32, v33
    v_mfma_f32_16x16x32_bf16 v[96:99], a[48:51], a[24:27], v[96:99]
    s_add_u32 m0, s45, 143360
    ds_read_b64_tr_b16 a[40:41], v145 offset:256
    ds_read_b64_tr_b16 a[42:43], v145 offset:4864
    v_mfma_f32_16x16x32_bf16 v[100:103], a[48:51], a[96:99], v[100:103]
    buffer_load_dwordx4 v159, s[28:31], s69 offen sc1 lds
    v_cvt_pk_f16_f32 v33, v34, v35
    v_mfma_f32_16x16x32_bf16 v[104:107], a[48:51], a[168:171], v[104:107]
    buffer_load_dwordx4 v[228:231], v160, s[84:87], s54 offen offset:0
    v_cvt_pk_f16_f32 v34, v36, v37
    v_mfma_f32_16x16x32_bf16 v[108:111], a[48:51], a[240:243], v[108:111]
    ds_write_b128 v179, v[88:91] offset:38912
    v_mfma_f32_16x16x32_bf16 v[96:99], a[52:55], a[28:31], v[96:99]
    ds_read_b64_tr_b16 a[44:45], v145 offset:18688
    ds_read_b64_tr_b16 a[46:47], v145 offset:23296
    v_mfma_f32_16x16x32_bf16 v[100:103], a[52:55], a[100:103], v[100:103]
    buffer_load_dwordx4 v[232:235], v160, s[84:87], s52 offen offset:32
    v_cvt_pk_f16_f32 v35, v38, v39
    v_mfma_f32_16x16x32_bf16 v[104:107], a[52:55], a[172:175], v[104:107]
    buffer_load_dwordx4 v[236:239], v160, s[84:87], s52 offen offset:160
    buffer_store_dwordx4 v[32:35], v149, s[12:15], s41 offen offset:2048 sc0 sc1
    v_mfma_f32_16x16x32_bf16 v[108:111], a[52:55], a[244:247], v[108:111]
    s_waitcnt lgkmcnt(14)
    v_mfma_f32_16x16x32_bf16 v[112:115], a[56:59], a[16:19], v[112:115]
    s_waitcnt lgkmcnt(2)
    s_barrier
    ds_read_b128 v[76:79], v148 offset:36864
    v_mfma_f32_16x16x32_bf16 v[116:119], a[56:59], a[88:91], v[116:119]
    ds_read_b128 v[92:95], v148 offset:38912
    v_fma_mix_f32 v48, v60, 1.0, v48 op_sel_hi:[1,0,0]
    v_mfma_f32_16x16x32_bf16 v[120:123], a[56:59], a[160:163], v[120:123]
    v_fma_mix_f32 v49, v60, 1.0, v49 op_sel:[1,0,0] op_sel_hi:[1,0,0]
    v_fma_mix_f32 v50, v61, 1.0, v50 op_sel_hi:[1,0,0]
    v_mfma_f32_16x16x32_bf16 v[124:127], a[56:59], a[232:235], v[124:127]
    v_cvt_pk_f16_f32 v104, v104, v105
    v_cvt_pk_f16_f32 v105, v106, v107
    v_mfma_f32_16x16x32_bf16 v[112:115], a[60:63], a[20:23], v[112:115]
    v_cvt_pk_f16_f32 v106, v108, v109
    v_cvt_pk_f16_f32 v107, v110, v111
    v_mfma_f32_16x16x32_bf16 v[116:119], a[60:63], a[92:95], v[116:119]
    ds_write_b128 v179, v[104:107] offset:53248
    v_mfma_f32_16x16x32_bf16 v[120:123], a[60:63], a[164:167], v[120:123]
    v_fma_mix_f32 v51, v61, 1.0, v51 op_sel:[1,0,0] op_sel_hi:[1,0,0]
    v_fma_mix_f32 v52, v62, 1.0, v52 op_sel_hi:[1,0,0]
    v_mfma_f32_16x16x32_bf16 v[124:127], a[60:63], a[236:239], v[124:127]
    v_fma_mix_f32 v53, v62, 1.0, v53 op_sel:[1,0,0] op_sel_hi:[1,0,0]
    v_fma_mix_f32 v54, v63, 1.0, v54 op_sel_hi:[1,0,0]
    v_mfma_f32_16x16x32_bf16 v[112:115], a[64:67], a[24:27], v[112:115]
    v_fma_mix_f32 v55, v63, 1.0, v55 op_sel:[1,0,0] op_sel_hi:[1,0,0]
    v_cvt_pk_f16_f32 v48, v48, v49
    v_mfma_f32_16x16x32_bf16 v[116:119], a[64:67], a[96:99], v[116:119]
    v_cvt_pk_f16_f32 v49, v50, v51
    v_cvt_pk_f16_f32 v50, v52, v53
    v_mfma_f32_16x16x32_bf16 v[120:123], a[64:67], a[168:171], v[120:123]
    v_cvt_pk_f16_f32 v51, v54, v55
    v_mfma_f32_16x16x32_bf16 v[124:127], a[64:67], a[240:243], v[124:127]
    buffer_store_dwordx4 v[48:51], v149, s[12:15], s41 offen offset:3072 sc0 sc1
    s_add_u32 s41, s41, 4096
    v_mfma_f32_16x16x32_bf16 v[112:115], a[68:71], a[28:31], v[112:115]
    s_waitcnt lgkmcnt(2)
    v_fma_mix_f32 v64, v76, 1.0, v64 op_sel_hi:[1,0,0]
    v_fma_mix_f32 v65, v76, 1.0, v65 op_sel:[1,0,0] op_sel_hi:[1,0,0]
    v_mfma_f32_16x16x32_bf16 v[116:119], a[68:71], a[100:103], v[116:119]
    v_fma_mix_f32 v66, v77, 1.0, v66 op_sel_hi:[1,0,0]
    v_fma_mix_f32 v67, v77, 1.0, v67 op_sel:[1,0,0] op_sel_hi:[1,0,0]
    v_mfma_f32_16x16x32_bf16 v[120:123], a[68:71], a[172:175], v[120:123]
    v_fma_mix_f32 v68, v78, 1.0, v68 op_sel_hi:[1,0,0]
    v_fma_mix_f32 v69, v78, 1.0, v69 op_sel:[1,0,0] op_sel_hi:[1,0,0]
    v_mfma_f32_16x16x32_bf16 v[124:127], a[68:71], a[244:247], v[124:127]
    v_fma_mix_f32 v70, v79, 1.0, v70 op_sel_hi:[1,0,0]
    v_fma_mix_f32 v71, v79, 1.0, v71 op_sel:[1,0,0] op_sel_hi:[1,0,0]
    v_mfma_f32_16x16x32_bf16 v[128:131], a[112:115], a[16:19], v[128:131]
    buffer_load_dwordx4 a[220:223], v149, s[56:59], s49 offen offset:1024 sc1
    v_cvt_pk_f16_f32 v64, v64, v65
    v_mfma_f32_16x16x32_bf16 v[132:135], a[112:115], a[88:91], v[132:135]
    buffer_load_dwordx4 a[8:11], v149, s[56:59], s47 offen offset:2048 sc1
    v_cvt_pk_f16_f32 v65, v66, v67
    v_mfma_f32_16x16x32_bf16 v[136:139], a[112:115], a[160:163], v[136:139]
    v_cvt_pk_f16_f32 v66, v68, v69
    v_cvt_pk_f16_f32 v67, v70, v71
    v_mfma_f32_16x16x32_bf16 v[140:143], a[112:115], a[232:235], v[140:143]
    buffer_store_dwordx4 v[64:67], v149, s[12:15], s41 offen offset:0 sc0 sc1
    v_cvt_pk_f16_f32 v120, v120, v121
    v_mfma_f32_16x16x32_bf16 v[128:131], a[116:119], a[20:23], v[128:131]
    s_waitcnt lgkmcnt(1)
    buffer_load_dwordx4 a[80:83], v149, s[56:59], s48 offen offset:2048 sc1
    v_cvt_pk_f16_f32 v121, v122, v123
    v_mfma_f32_16x16x32_bf16 v[132:135], a[116:119], a[92:95], v[132:135]
    v_cvt_pk_f16_f32 v122, v124, v125
    v_cvt_pk_f16_f32 v123, v126, v127
    v_mfma_f32_16x16x32_bf16 v[136:139], a[116:119], a[164:167], v[136:139]
    ds_write_b128 v179, v[120:123] offset:55296
    v_mfma_f32_16x16x32_bf16 v[140:143], a[116:119], a[236:239], v[140:143]
    v_fma_mix_f32 v80, v92, 1.0, v80 op_sel_hi:[1,0,0]
    v_fma_mix_f32 v81, v92, 1.0, v81 op_sel:[1,0,0] op_sel_hi:[1,0,0]
    v_mfma_f32_16x16x32_bf16 v[128:131], a[40:43], a[24:27], v[128:131]
    buffer_load_dwordx4 a[152:155], v149, s[56:59], s49 offen offset:2048 sc1
    v_fma_mix_f32 v82, v93, 1.0, v82 op_sel_hi:[1,0,0]
    v_mfma_f32_16x16x32_bf16 v[132:135], a[40:43], a[96:99], v[132:135]
    v_fma_mix_f32 v83, v93, 1.0, v83 op_sel:[1,0,0] op_sel_hi:[1,0,0]
    v_fma_mix_f32 v84, v94, 1.0, v84 op_sel_hi:[1,0,0]
    v_mfma_f32_16x16x32_bf16 v[136:139], a[40:43], a[168:171], v[136:139]
    v_fma_mix_f32 v85, v94, 1.0, v85 op_sel:[1,0,0] op_sel_hi:[1,0,0]
    v_fma_mix_f32 v86, v95, 1.0, v86 op_sel_hi:[1,0,0]
    v_mfma_f32_16x16x32_bf16 v[140:143], a[40:43], a[240:243], v[140:143]
    s_waitcnt lgkmcnt(0)
    s_barrier
    ds_read_b128 v[108:111], v148 offset:53248
    v_mfma_f32_16x16x32_bf16 v[128:131], a[44:47], a[28:31], v[128:131]
    buffer_load_dwordx4 a[224:227], v149, s[56:59], s47 offen offset:3072 sc1
    ds_read_b128 v[124:127], v148 offset:55296
    v_mfma_f32_16x16x32_bf16 v[132:135], a[44:47], a[100:103], v[132:135]
    s_add_u32 s47, s47, 4096
    v_fma_mix_f32 v87, v95, 1.0, v87 op_sel:[1,0,0] op_sel_hi:[1,0,0]
    v_cvt_pk_f16_f32 v80, v80, v81
    v_mfma_f32_16x16x32_bf16 v[136:139], a[44:47], a[172:175], v[136:139]
    v_cvt_pk_f16_f32 v81, v82, v83
    v_cvt_pk_f16_f32 v82, v84, v85
    v_mfma_f32_16x16x32_bf16 v[140:143], a[44:47], a[244:247], v[140:143]
    v_cvt_pk_f16_f32 v83, v86, v87
K4_entry:
    s_nop 11
    v_cvt_pk_f16_f32 v136, v136, v137
    v_cvt_pk_f16_f32 v137, v138, v139
    v_cvt_pk_f16_f32 v138, v140, v141
    v_cvt_pk_f16_f32 v139, v142, v143
    ds_write_b128 v179, v[136:139] offset:36864
    buffer_store_dwordx4 v[80:83], v149, s[12:15], s41 offen offset:1024 sc0 sc1
    s_waitcnt lgkmcnt(2)
    v_fma_mix_f32 v96, v108, 1.0, v96 op_sel_hi:[1,0,0]
    v_fma_mix_f32 v97, v108, 1.0, v97 op_sel:[1,0,0] op_sel_hi:[1,0,0]
    v_fma_mix_f32 v98, v109, 1.0, v98 op_sel_hi:[1,0,0]
    v_fma_mix_f32 v99, v109, 1.0, v99 op_sel:[1,0,0] op_sel_hi:[1,0,0]
    v_fma_mix_f32 v100, v110, 1.0, v100 op_sel_hi:[1,0,0]
    v_fma_mix_f32 v101, v110, 1.0, v101 op_sel:[1,0,0] op_sel_hi:[1,0,0]
    v_fma_mix_f32 v102, v111, 1.0, v102 op_sel_hi:[1,0,0]
    v_fma_mix_f32 v103, v111, 1.0, v103 op_sel:[1,0,0] op_sel_hi:[1,0,0]
    v_cvt_pk_f16_f32 v96, v96, v97
    v_cvt_pk_f16_f32 v97, v98, v99
    v_cvt_pk_f16_f32 v98, v100, v101
    v_cvt_pk_f16_f32 v99, v102, v103
    buffer_store_dwordx4 v[96:99], v149, s[12:15], s41 offen offset:2048 sc0 sc1
    s_waitcnt lgkmcnt(1)
    v_fma_mix_f32 v112, v124, 1.0, v112 op_sel_hi:[1,0,0]
    v_fma_mix_f32 v113, v124, 1.0, v113 op_sel:[1,0,0] op_sel_hi:[1,0,0]
    v_fma_mix_f32 v114, v125, 1.0, v114 op_sel_hi:[1,0,0]
    v_fma_mix_f32 v115, v125, 1.0, v115 op_sel:[1,0,0] op_sel_hi:[1,0,0]
    v_fma_mix_f32 v116, v126, 1.0, v116 op_sel_hi:[1,0,0]
    v_fma_mix_f32 v117, v126, 1.0, v117 op_sel:[1,0,0] op_sel_hi:[1,0,0]
    v_fma_mix_f32 v118, v127, 1.0, v118 op_sel_hi:[1,0,0]
    v_fma_mix_f32 v119, v127, 1.0, v119 op_sel:[1,0,0] op_sel_hi:[1,0,0]
    v_cvt_pk_f16_f32 v112, v112, v113
    v_cvt_pk_f16_f32 v113, v114, v115
    v_cvt_pk_f16_f32 v114, v116, v117
    v_cvt_pk_f16_f32 v115, v118, v119
    buffer_store_dwordx4 v[112:115], v149, s[12:15], s41 offen offset:3072 sc0 sc1
    s_add_u32 s41, s41, 4096
    s_waitcnt vmcnt(14)
    s_waitcnt lgkmcnt(0)
    s_barrier
    ds_read_b128 v[140:143], v148 offset:36864
    ds_read_b128 v[204:207], v161 offset:0
    ds_read_b128 v[208:211], v161 offset:18432
    ds_read_b128 v[212:215], v162 offset:0
    ds_read_b128 v[216:219], v162 offset:18432
    s_waitcnt lgkmcnt(2)
    v_mfma_f32_16x16x32_bf16 v[180:183], a[120:123], v[204:207], 0
    ds_read_b128 v[220:223], v161 offset:128
    ds_read_b128 v[224:227], v161 offset:18560
    v_mfma_f32_16x16x32_bf16 v[184:187], a[120:123], v[208:211], 0
    buffer_load_dwordx4 a[12:15], v149, s[56:59], s48 offen offset:3072 sc1
    s_add_u32 s48, s48, 4096
    v_mfma_f32_16x16x32_bf16 v[188:191], a[124:127], v[204:207], 0
    buffer_load_dwordx4 a[84:87], v149, s[56:59], s49 offen offset:3072 sc1
    s_add_u32 s49, s49, 4096
    v_mfma_f32_16x16x32_bf16 v[192:195], a[124:127], v[208:211], 0
    buffer_load_dwordx4 a[156:159], v149, s[56:59], s47 offen offset:0 sc1
    v_mfma_f32_16x16x32_bf16 v[196:199], a[128:131], v[204:207], 0
    v_mfma_f32_16x16x32_bf16 v[200:203], a[128:131], v[208:211], 0
    s_waitcnt lgkmcnt(2)
    v_mfma_f32_16x16x32_bf16 v[180:183], a[132:135], v[212:215], v[180:183]
    ds_read_b128 v[204:207], v162 offset:128
    ds_read_b128 v[208:211], v162 offset:18560
    v_mfma_f32_16x16x32_bf16 v[184:187], a[132:135], v[216:219], v[184:187]
    buffer_load_dwordx4 a[228:231], v149, s[56:59], s48 offen offset:0 sc1
    v_fma_mix_f32 v128, v140, 1.0, v128 op_sel_hi:[1,0,0]
    v_mfma_f32_16x16x32_bf16 v[188:191], a[136:139], v[212:215], v[188:191]
    buffer_load_dwordx4 a[48:51], v149, s[56:59], s49 offen offset:0 sc1
    v_fma_mix_f32 v129, v140, 1.0, v129 op_sel:[1,0,0] op_sel_hi:[1,0,0]
    v_mfma_f32_16x16x32_bf16 v[192:195], a[136:139], v[216:219], v[192:195]
    buffer_load_dwordx4 a[52:55], v149, s[56:59], s47 offen offset:1024 sc1
    v_fma_mix_f32 v130, v141, 1.0, v130 op_sel_hi:[1,0,0]
    v_mfma_f32_16x16x32_bf16 v[196:199], a[140:143], v[212:215], v[196:199]
    v_fma_mix_f32 v131, v141, 1.0, v131 op_sel:[1,0,0] op_sel_hi:[1,0,0]
    v_fma_mix_f32 v132, v142, 1.0, v132 op_sel_hi:[1,0,0]
    v_mfma_f32_16x16x32_bf16 v[200:203], a[140:143], v[216:219], v[200:203]
    s_waitcnt lgkmcnt(2)
    v_fma_mix_f32 v133, v142, 1.0, v133 op_sel:[1,0,0] op_sel_hi:[1,0,0]
    v_fma_mix_f32 v134, v143, 1.0, v134 op_sel_hi:[1,0,0]
    v_mfma_f32_16x16x32_bf16 v[180:183], a[184:187], v[220:223], v[180:183]
    ds_read_b128 v[212:215], v161 offset:256
    ds_read_b128 v[216:219], v161 offset:18688
    v_mfma_f32_16x16x32_bf16 v[184:187], a[184:187], v[224:227], v[184:187]
    buffer_load_dwordx4 a[56:59], v149, s[56:59], s48 offen offset:1024 sc1
    v_fma_mix_f32 v135, v143, 1.0, v135 op_sel:[1,0,0] op_sel_hi:[1,0,0]
    v_mfma_f32_16x16x32_bf16 v[188:191], a[188:191], v[220:223], v[188:191]
    buffer_load_dwordx4 a[60:63], v149, s[56:59], s49 offen offset:1024 sc1
    v_cvt_pk_f16_f32 v128, v128, v129
    v_mfma_f32_16x16x32_bf16 v[192:195], a[188:191], v[224:227], v[192:195]
    buffer_load_dwordx4 a[64:67], v149, s[56:59], s47 offen offset:2048 sc1
    v_cvt_pk_f16_f32 v129, v130, v131
    v_mfma_f32_16x16x32_bf16 v[196:199], a[192:195], v[220:223], v[196:199]
    v_cvt_pk_f16_f32 v130, v132, v133
    v_cvt_pk_f16_f32 v131, v134, v135
    v_mfma_f32_16x16x32_bf16 v[200:203], a[192:195], v[224:227], v[200:203]
    s_waitcnt lgkmcnt(2)
    buffer_store_dwordx4 v[128:131], v149, s[12:15], s41 offen offset:0 sc0 sc1
    v_mfma_f32_16x16x32_bf16 v[180:183], a[196:199], v[204:207], v[180:183]
    ds_read_b128 v[220:223], v162 offset:256
    ds_read_b128 v[224:227], v162 offset:18688
    v_mfma_f32_16x16x32_bf16 v[184:187], a[196:199], v[208:211], v[184:187]
    buffer_load_dwordx4 a[68:71], v149, s[56:59], s48 offen offset:2048 sc1
    v_mfma_f32_16x16x32_bf16 v[188:191], a[200:203], v[204:207], v[188:191]
    buffer_load_dwordx4 a[16:19], v149, s[56:59], s49 offen offset:2048 sc1
    v_mfma_f32_16x16x32_bf16 v[192:195], a[200:203], v[208:211], v[192:195]
    buffer_load_dwordx4 a[88:91], v149, s[56:59], s47 offen offset:3072 sc1
    s_add_u32 s47, s47, 4096
    v_mfma_f32_16x16x32_bf16 v[196:199], a[204:207], v[204:207], v[196:199]
    v_mfma_f32_16x16x32_bf16 v[200:203], a[204:207], v[208:211], v[200:203]
    s_waitcnt lgkmcnt(2)
    v_mfma_f32_16x16x32_bf16 v[180:183], a[208:211], v[212:215], v[180:183]
    ds_read_b128 v[204:207], v161 offset:384
    ds_read_b128 v[208:211], v161 offset:18816
    v_mfma_f32_16x16x32_bf16 v[184:187], a[208:211], v[216:219], v[184:187]
    buffer_load_dwordx4 a[160:163], v149, s[56:59], s48 offen offset:3072 sc1
    s_add_u32 s48, s48, 4096
    v_mfma_f32_16x16x32_bf16 v[188:191], a[212:215], v[212:215], v[188:191]
    buffer_load_dwordx4 a[232:235], v149, s[56:59], s49 offen offset:3072 sc1
    s_add_u32 s49, s49, 4096
    v_mfma_f32_16x16x32_bf16 v[192:195], a[212:215], v[216:219], v[192:195]
    buffer_load_dwordx4 a[112:115], v149, s[56:59], s47 offen offset:0 sc1
    v_mfma_f32_16x16x32_bf16 v[196:199], a[32:35], v[212:215], v[196:199]
    v_mfma_f32_16x16x32_bf16 v[200:203], a[32:35], v[216:219], v[200:203]
    s_waitcnt lgkmcnt(2)
    v_mfma_f32_16x16x32_bf16 v[180:183], a[104:107], v[220:223], v[180:183]
    ds_read_b128 v[212:215], v162 offset:384
    ds_read_b128 v[216:219], v162 offset:18816
    v_mfma_f32_16x16x32_bf16 v[184:187], a[104:107], v[224:227], v[184:187]
    buffer_load_dwordx4 a[20:23], v149, s[56:59], s48 offen offset:0 sc1
    v_mfma_f32_16x16x32_bf16 v[188:191], a[176:179], v[220:223], v[188:191]
    buffer_load_dwordx4 a[92:95], v149, s[56:59], s49 offen offset:0 sc1
    v_mfma_f32_16x16x32_bf16 v[192:195], a[176:179], v[224:227], v[192:195]
    buffer_load_dwordx4 a[164:167], v149, s[56:59], s47 offen offset:1024 sc1
    v_mfma_f32_16x16x32_bf16 v[196:199], a[248:251], v[220:223], v[196:199]
    v_mfma_f32_16x16x32_bf16 v[200:203], a[248:251], v[224:227], v[200:203]
    s_waitcnt lgkmcnt(2)
    v_mfma_f32_16x16x32_bf16 v[180:183], a[36:39], v[204:207], v[180:183]
    ds_read_b128 v[220:223], v161 offset:512
    ds_read_b128 v[224:227], v161 offset:18944
    v_mfma_f32_16x16x32_bf16 v[184:187], a[36:39], v[208:211], v[184:187]
    buffer_load_dwordx4 a[236:239], v149, s[56:59], s48 offen offset:1024 sc1
    v_mfma_f32_16x16x32_bf16 v[188:191], a[108:111], v[204:207], v[188:191]
    buffer_load_dwordx4 a[116:119], v149, s[56:59], s49 offen offset:1024 sc1
    v_mfma_f32_16x16x32_bf16 v[192:195], a[108:111], v[208:211], v[192:195]
    s_add_u32 s40, s55, 1024
    buffer_load_dwordx4 v[16:19], v149, s[12:15], s40 offen sc1
    v_mfma_f32_16x16x32_bf16 v[196:199], a[180:183], v[204:207], v[196:199]
    s_add_u32 s40, s55, 2360320
    buffer_load_dwordx4 v[20:23], v149, s[12:15], s40 offen sc1
    v_mfma_f32_16x16x32_bf16 v[200:203], a[180:183], v[208:211], v[200:203]
    s_waitcnt lgkmcnt(2)
    v_mfma_f32_16x16x32_bf16 v[180:183], a[252:255], v[212:215], v[180:183]
    ds_read_b128 v[204:207], v162 offset:512
    ds_read_b128 v[208:211], v162 offset:18944
    v_mfma_f32_16x16x32_bf16 v[184:187], a[252:255], v[216:219], v[184:187]
    s_add_u32 s40, s55, 4719616
    buffer_load_dwordx4 v[24:27], v149, s[12:15], s40 offen sc1
    v_mfma_f32_16x16x32_bf16 v[188:191], a[0:3], v[212:215], v[188:191]
    s_add_u32 s40, s55, 7078912
    buffer_load_dwordx4 v[28:31], v149, s[12:15], s40 offen sc1
    v_mfma_f32_16x16x32_bf16 v[192:195], a[0:3], v[216:219], v[192:195]
    s_add_u32 s40, s60, 0
    buffer_load_dwordx4 v[0:3], v149, s[12:15], s40 offen sc1
    v_mfma_f32_16x16x32_bf16 v[196:199], a[72:75], v[212:215], v[196:199]
    s_add_u32 s40, s60, 2359296
    buffer_load_dwordx4 v[4:7], v149, s[12:15], s40 offen sc1
    v_mfma_f32_16x16x32_bf16 v[200:203], a[72:75], v[216:219], v[200:203]
    s_waitcnt lgkmcnt(2)
    v_mfma_f32_16x16x32_bf16 v[180:183], a[144:147], v[220:223], v[180:183]
    ds_read_b128 v[212:215], v161 offset:640
    ds_read_b128 v[216:219], v161 offset:19072
    v_mfma_f32_16x16x32_bf16 v[184:187], a[144:147], v[224:227], v[184:187]
    s_add_u32 s40, s60, 4718592
    buffer_load_dwordx4 v[8:11], v149, s[12:15], s40 offen sc1
    v_mfma_f32_16x16x32_bf16 v[188:191], a[216:219], v[220:223], v[188:191]
    s_add_u32 s40, s60, 7077888
    buffer_load_dwordx4 v[12:15], v149, s[12:15], s40 offen sc1
    s_waitcnt vmcnt(40)
    v_lshlrev_b32 v88, 16, v228
    v_mfma_f32_16x16x32_bf16 v[192:195], a[216:219], v[224:227], v[192:195]
    v_and_b32 v89, s63, v228
    v_lshlrev_b32 v90, 16, v229
    v_and_b32 v91, s63, v229
    v_mfma_f32_16x16x32_bf16 v[196:199], a[4:7], v[220:223], v[196:199]
    v_lshlrev_b32 v92, 16, v230
    v_and_b32 v93, s63, v230
    v_lshlrev_b32 v94, 16, v231
    v_mfma_f32_16x16x32_bf16 v[200:203], a[4:7], v[224:227], v[200:203]
    s_waitcnt vmcnt(37)
    s_waitcnt lgkmcnt(2)
    v_and_b32 v95, s63, v231
    v_lshlrev_b32 v96, 16, v232
    v_mfma_f32_16x16x32_bf16 v[180:183], a[76:79], v[204:207], v[180:183]
    ds_read_b128 v[220:223], v162 offset:640
    ds_read_b128 v[224:227], v162 offset:19072
    v_and_b32 v97, s63, v232
    v_mfma_f32_16x16x32_bf16 v[184:187], a[76:79], v[208:211], v[184:187]
    v_lshlrev_b32 v98, 16, v233
    v_and_b32 v99, s63, v233
    v_lshlrev_b32 v100, 16, v234
    v_mfma_f32_16x16x32_bf16 v[188:191], a[148:151], v[204:207], v[188:191]
    v_and_b32 v101, s63, v234
    v_lshlrev_b32 v102, 16, v235
    v_and_b32 v103, s63, v235
    v_mfma_f32_16x16x32_bf16 v[192:195], a[148:151], v[208:211], v[192:195]
    v_lshlrev_b32 v104, 16, v236
    v_and_b32 v105, s63, v236
    v_lshlrev_b32 v106, 16, v237
    v_mfma_f32_16x16x32_bf16 v[196:199], a[220:223], v[204:207], v[196:199]
    v_and_b32 v107, s63, v237
    v_lshlrev_b32 v108, 16, v238
    v_and_b32 v109, s63, v238
    v_mfma_f32_16x16x32_bf16 v[200:203], a[220:223], v[208:211], v[200:203]
    s_waitcnt vmcnt(33)
    s_waitcnt lgkmcnt(2)
    v_lshlrev_b32 v110, 16, v239
    v_and_b32 v111, s63, v239
    v_mfma_f32_16x16x32_bf16 v[180:183], a[8:11], v[212:215], v[180:183]
    ds_read_b128 v[204:207], v161 offset:768
    ds_read_b128 v[208:211], v161 offset:19200
    v_mfma_f32_16x16x32_bf16 v[184:187], a[8:11], v[216:219], v[184:187]
    v_mfma_f32_16x16x32_bf16 v[188:191], a[80:83], v[212:215], v[188:191]
    v_mfma_f32_16x16x32_bf16 v[192:195], a[80:83], v[216:219], v[192:195]
    v_mfma_f32_16x16x32_bf16 v[196:199], a[152:155], v[212:215], v[196:199]
    v_mfma_f32_16x16x32_bf16 v[200:203], a[152:155], v[216:219], v[200:203]
    s_waitcnt vmcnt(27)
    s_waitcnt lgkmcnt(2)
    v_mfma_f32_16x16x32_bf16 v[180:183], a[224:227], v[220:223], v[180:183]
    ds_read_b128 v[212:215], v162 offset:768
    ds_read_b128 v[216:219], v162 offset:19200
    v_mfma_f32_16x16x32_bf16 v[184:187], a[224:227], v[224:227], v[184:187]
    v_mfma_f32_16x16x32_bf16 v[188:191], a[12:15], v[220:223], v[188:191]
    v_mfma_f32_16x16x32_bf16 v[192:195], a[12:15], v[224:227], v[192:195]
    v_mfma_f32_16x16x32_bf16 v[196:199], a[84:87], v[220:223], v[196:199]
    v_mfma_f32_16x16x32_bf16 v[200:203], a[84:87], v[224:227], v[200:203]
    s_waitcnt vmcnt(24)
    s_waitcnt lgkmcnt(2)
    v_mfma_f32_16x16x32_bf16 v[180:183], a[156:159], v[204:207], v[180:183]
    ds_read_b128 v[220:223], v161 offset:896
    ds_read_b128 v[224:227], v161 offset:19328
    v_mfma_f32_16x16x32_bf16 v[184:187], a[156:159], v[208:211], v[184:187]
    v_mfma_f32_16x16x32_bf16 v[188:191], a[228:231], v[204:207], v[188:191]
    v_mfma_f32_16x16x32_bf16 v[192:195], a[228:231], v[208:211], v[192:195]
    v_mfma_f32_16x16x32_bf16 v[196:199], a[48:51], v[204:207], v[196:199]
    v_mfma_f32_16x16x32_bf16 v[200:203], a[48:51], v[208:211], v[200:203]
    s_waitcnt vmcnt(21)
    s_waitcnt lgkmcnt(2)
    v_mfma_f32_16x16x32_bf16 v[180:183], a[52:55], v[212:215], v[180:183]
    ds_read_b128 v[204:207], v162 offset:896
    ds_read_b128 v[208:211], v162 offset:19328
    v_mfma_f32_16x16x32_bf16 v[184:187], a[52:55], v[216:219], v[184:187]
    s_add_u32 s39, s55, 5120
    buffer_load_dwordx4 v[32:35], v149, s[12:15], s39 offen sc1
    v_mfma_f32_16x16x32_bf16 v[188:191], a[56:59], v[212:215], v[188:191]
    s_add_u32 s39, s55, 2364416
    buffer_load_dwordx4 v[36:39], v149, s[12:15], s39 offen sc1
    v_mfma_f32_16x16x32_bf16 v[192:195], a[56:59], v[216:219], v[192:195]
    s_add_u32 s39, s55, 4723712
    buffer_load_dwordx4 v[40:43], v149, s[12:15], s39 offen sc1
    v_mfma_f32_16x16x32_bf16 v[196:199], a[60:63], v[212:215], v[196:199]
    s_add_u32 s39, s55, 7083008
    buffer_load_dwordx4 v[44:47], v149, s[12:15], s39 offen sc1
    v_mfma_f32_16x16x32_bf16 v[200:203], a[60:63], v[216:219], v[200:203]
    s_waitcnt vmcnt(21)
    s_waitcnt lgkmcnt(2)
    v_mfma_f32_16x16x32_bf16 v[180:183], a[64:67], v[220:223], v[180:183]
    ds_read_b128 v[212:215], v161 offset:1024
    ds_read_b128 v[216:219], v161 offset:19456
    v_mfma_f32_16x16x32_bf16 v[184:187], a[64:67], v[224:227], v[184:187]
    v_mfma_f32_16x16x32_bf16 v[188:191], a[68:71], v[220:223], v[188:191]
    v_mfma_f32_16x16x32_bf16 v[192:195], a[68:71], v[224:227], v[192:195]
    v_mfma_f32_16x16x32_bf16 v[196:199], a[16:19], v[220:223], v[196:199]
    v_mfma_f32_16x16x32_bf16 v[200:203], a[16:19], v[224:227], v[200:203]
    s_waitcnt vmcnt(18)
    s_waitcnt lgkmcnt(2)
    s_waitcnt vmcnt(8)
    v_max3_u32 v166, v16, v17, v18
    v_mfma_f32_16x16x32_bf16 v[180:183], a[88:91], v[204:207], v[180:183]
    ds_read_b128 v[220:223], v162 offset:1024
    ds_read_b128 v[224:227], v162 offset:19456
    v_max3_u32 v166, v166, v19, v20
    v_mfma_f32_16x16x32_bf16 v[184:187], a[88:91], v[208:211], v[184:187]
    v_max3_u32 v166, v166, v21, v22
    v_max3_u32 v166, v166, v23, v24
    v_max3_u32 v166, v166, v25, v26
    v_mfma_f32_16x16x32_bf16 v[188:191], a[160:163], v[204:207], v[188:191]
    v_max3_u32 v166, v166, v27, v28
    v_max3_u32 v166, v166, v29, v30
    v_max_u32 v166, v166, v31
    v_cmp_eq_u32 vcc, -1, v166
    s_nop 4
    s_cbranch_vccnz D1_spin
D1_ret:
    v_mfma_f32_16x16x32_bf16 v[192:195], a[160:163], v[208:211], v[192:195]
    v_fma_mix_f32 v56, v20, 1.0, v16 op_sel_hi:[1,0,1]
    v_fma_mix_f32 v57, v20, 1.0, v16 op_sel:[1,0,1] op_sel_hi:[1,0,1]
    v_fma_mix_f32 v58, v21, 1.0, v17 op_sel_hi:[1,0,1]
    v_mfma_f32_16x16x32_bf16 v[196:199], a[232:235], v[204:207], v[196:199]
    v_fma_mix_f32 v59, v21, 1.0, v17 op_sel:[1,0,1] op_sel_hi:[1,0,1]
    v_fma_mix_f32 v60, v22, 1.0, v18 op_sel_hi:[1,0,1]
    v_fma_mix_f32 v61, v22, 1.0, v18 op_sel:[1,0,1] op_sel_hi:[1,0,1]
    v_mfma_f32_16x16x32_bf16 v[200:203], a[232:235], v[208:211], v[200:203]
    s_waitcnt lgkmcnt(2)
    v_fma_mix_f32 v62, v23, 1.0, v19 op_sel_hi:[1,0,1]
    v_fma_mix_f32 v63, v23, 1.0, v19 op_sel:[1,0,1] op_sel_hi:[1,0,1]
    v_fma_mix_f32 v56, v24, 1.0, v56 op_sel_hi:[1,0,0]
    v_mfma_f32_16x16x32_bf16 v[180:183], a[112:115], v[212:215], v[180:183]
    v_fma_mix_f32 v57, v24, 1.0, v57 op_sel:[1,0,0] op_sel_hi:[1,0,0]
    v_fma_mix_f32 v58, v25, 1.0, v58 op_sel_hi:[1,0,0]
    v_fma_mix_f32 v59, v25, 1.0, v59 op_sel:[1,0,0] op_sel_hi:[1,0,0]
    v_mfma_f32_16x16x32_bf16 v[184:187], a[112:115], v[216:219], v[184:187]
    v_fma_mix_f32 v60, v26, 1.0, v60 op_sel_hi:[1,0,0]
    v_fma_mix_f32 v61, v26, 1.0, v61 op_sel:[1,0,0] op_sel_hi:[1,0,0]
    v_fma_mix_f32 v62, v27, 1.0, v62 op_sel_hi:[1,0,0]
    v_mfma_f32_16x16x32_bf16 v[188:191], a[20:23], v[212:215], v[188:191]
    v_fma_mix_f32 v63, v27, 1.0, v63 op_sel:[1,0,0] op_sel_hi:[1,0,0]
    v_fma_mix_f32 v56, v28, 1.0, v56 op_sel_hi:[1,0,0]
    v_fma_mix_f32 v57, v28, 1.0, v57 op_sel:[1,0,0] op_sel_hi:[1,0,0]
    v_mfma_f32_16x16x32_bf16 v[192:195], a[20:23], v[216:219], v[192:195]
    v_fma_mix_f32 v58, v29, 1.0, v58 op_sel_hi:[1,0,0]
    v_fma_mix_f32 v59, v29, 1.0, v59 op_sel:[1,0,0] op_sel_hi:[1,0,0]
    v_fma_mix_f32 v60, v30, 1.0, v60 op_sel_hi:[1,0,0]
    v_mfma_f32_16x16x32_bf16 v[196:199], a[92:95], v[212:215], v[196:199]
    v_fma_mix_f32 v61, v30, 1.0, v61 op_sel:[1,0,0] op_sel_hi:[1,0,0]
    v_fma_mix_f32 v62, v31, 1.0, v62 op_sel_hi:[1,0,0]
    v_fma_mix_f32 v63, v31, 1.0, v63 op_sel:[1,0,0] op_sel_hi:[1,0,0]
    v_mfma_f32_16x16x32_bf16 v[200:203], a[92:95], v[216:219], v[200:203]
    s_waitcnt lgkmcnt(0)
    v_cvt_pk_bf16_f32 v72, v56, v57
    v_cvt_pk_bf16_f32 v73, v58, v59
    v_cvt_pk_bf16_f32 v74, v60, v61
    v_mfma_f32_16x16x32_bf16 v[180:183], a[164:167], v[220:223], v[180:183]
    v_cvt_pk_bf16_f32 v75, v62, v63
    v_lshlrev_b32 v56, 16, v72
    v_and_b32 v57, s63, v72
    v_mfma_f32_16x16x32_bf16 v[184:187], a[164:167], v[224:227], v[184:187]
    v_lshlrev_b32 v58, 16, v73
    v_and_b32 v59, s63, v73
    v_lshlrev_b32 v60, 16, v74
    v_mfma_f32_16x16x32_bf16 v[188:191], a[236:239], v[220:223], v[188:191]
    v_and_b32 v61, s63, v74
    v_lshlrev_b32 v62, 16, v75
    v_and_b32 v63, s63, v75
    v_mfma_f32_16x16x32_bf16 v[192:195], a[236:239], v[224:227], v[192:195]
    v_mul_f32 v80, 0xbfb8aa3b, v56
    v_mul_f32 v81, 0xbfb8aa3b, v57
    v_mul_f32 v82, 0xbfb8aa3b, v58
    v_mfma_f32_16x16x32_bf16 v[196:199], a[116:119], v[220:223], v[196:199]
    v_mul_f32 v83, 0xbfb8aa3b, v59
    v_mul_f32 v84, 0xbfb8aa3b, v60
    v_mul_f32 v85, 0xbfb8aa3b, v61
    v_mfma_f32_16x16x32_bf16 v[200:203], a[116:119], v[224:227], v[200:203]
    v_mul_f32 v86, 0xbfb8aa3b, v62
    v_mul_f32 v87, 0xbfb8aa3b, v63
    s_nop 7
    v_cvt_pk_bf16_f32 v76, v180, v181
    v_cvt_pk_bf16_f32 v77, v182, v183
    v_cvt_pk_bf16_f32 v78, v184, v185
    v_cvt_pk_bf16_f32 v79, v186, v187
    v_lshlrev_b32 v180, 16, v76
    v_and_b32 v181, s63, v76
    v_lshlrev_b32 v182, 16, v77
    v_and_b32 v183, s63, v77
    v_lshlrev_b32 v184, 16, v78
    v_and_b32 v185, s63, v78
    v_lshlrev_b32 v186, 16, v79
    v_and_b32 v187, s63, v79
    v_cvt_pk_bf16_f32 v76, v188, v189
    v_cvt_pk_bf16_f32 v77, v190, v191
    v_cvt_pk_bf16_f32 v78, v192, v193
    v_cvt_pk_bf16_f32 v79, v194, v195
    v_lshlrev_b32 v188, 16, v76
    v_and_b32 v189, s63, v76
    v_lshlrev_b32 v190, 16, v77
    v_and_b32 v191, s63, v77
    v_lshlrev_b32 v192, 16, v78
    v_and_b32 v193, s63, v78
    v_lshlrev_b32 v194, 16, v79
    v_and_b32 v195, s63, v79
    v_cvt_pk_bf16_f32 v76, v196, v197
    v_cvt_pk_bf16_f32 v77, v198, v199
    v_cvt_pk_bf16_f32 v78, v200, v201
    v_cvt_pk_bf16_f32 v79, v202, v203
    v_lshlrev_b32 v196, 16, v76
    v_and_b32 v197, s63, v76
    v_lshlrev_b32 v198, 16, v77
    v_and_b32 v199, s63, v77
    v_lshlrev_b32 v200, 16, v78
    v_and_b32 v201, s63, v78
    v_lshlrev_b32 v202, 16, v79
    v_and_b32 v203, s63, v79
    v_exp_f32 v80, v80
    v_exp_f32 v81, v81
    v_exp_f32 v82, v82
    v_exp_f32 v83, v83
    v_exp_f32 v84, v84
    v_exp_f32 v85, v85
    v_exp_f32 v86, v86
    v_exp_f32 v87, v87
    s_nop 0
    v_add_f32 v80, 1.0, v80
    v_add_f32 v81, 1.0, v81
    v_add_f32 v82, 1.0, v82
    v_add_f32 v83, 1.0, v83
    v_add_f32 v84, 1.0, v84
    v_add_f32 v85, 1.0, v85
    v_add_f32 v86, 1.0, v86
    v_add_f32 v87, 1.0, v87
    v_rcp_f32 v80, v80
    v_rcp_f32 v81, v81
    v_rcp_f32 v82, v82
    v_rcp_f32 v83, v83
    v_rcp_f32 v84, v84
    v_rcp_f32 v85, v85
    v_rcp_f32 v86, v86
    v_rcp_f32 v87, v87
    s_nop 0
    v_mul_f32 v56, v56, v80
    v_mul_f32 v57, v57, v81
    v_mul_f32 v58, v58, v82
    v_mul_f32 v59, v59, v83
    v_mul_f32 v60, v60, v84
    v_mul_f32 v61, v61, v85
    v_mul_f32 v62, v62, v86
    v_mul_f32 v63, v63, v87
    v_cvt_pk_bf16_f32 v72, v56, v57
    v_cvt_pk_bf16_f32 v73, v58, v59
    v_cvt_pk_bf16_f32 v74, v60, v61
    v_cvt_pk_bf16_f32 v75, v62, v63
    v_lshlrev_b32 v56, 16, v72
    v_and_b32 v57, s63, v72
    v_lshlrev_b32 v58, 16, v73
    v_and_b32 v59, s63, v73
    v_lshlrev_b32 v60, 16, v74
    v_and_b32 v61, s63, v74
    v_lshlrev_b32 v62, 16, v75
    v_and_b32 v63, s63, v75
    v_mul_f32 v56, v56, v188
    v_mul_f32 v57, v57, v189
    v_mul_f32 v58, v58, v190
    v_mul_f32 v59, v59, v191
    v_mul_f32 v60, v60, v192
    v_mul_f32 v61, v61, v193
    v_mul_f32 v62, v62, v194
    v_mul_f32 v63, v63, v195
    v_cvt_pk_bf16_f32 v72, v56, v57
    v_cvt_pk_bf16_f32 v73, v58, v59
    v_cvt_pk_bf16_f32 v74, v60, v61
    v_cvt_pk_bf16_f32 v75, v62, v63
    s_nop 1
    v_permlane16_swap_b32 v72, v74
    v_permlane16_swap_b32 v73, v75
    s_nop 1
    v_lshlrev_b32 v56, 16, v72
    v_and_b32 v57, s63, v72
    v_lshlrev_b32 v58, 16, v73
    v_and_b32 v59, s63, v73
    v_lshlrev_b32 v60, 16, v74
    v_and_b32 v61, s63, v74
    v_lshlrev_b32 v62, 16, v75
    v_and_b32 v63, s63, v75
    v_add_f32 v56, v56, v96
    v_add_f32 v57, v57, v97
    v_add_f32 v58, v58, v98
    v_add_f32 v59, v59, v99
    v_add_f32 v60, v60, v100
    v_add_f32 v61, v61, v101
    v_add_f32 v62, v62, v102
    v_add_f32 v63, v63, v103
    v_cvt_pk_bf16_f32 v96, v56, v57
    v_cvt_pk_bf16_f32 v97, v58, v59
    v_cvt_pk_bf16_f32 v98, v60, v61
    v_cvt_pk_bf16_f32 v99, v62, v63
    buffer_store_dwordx4 v[96:99], v160, s[20:23], s52 offen offset:32
    s_cmp_lg_u32 s32, 0
    s_cbranch_scc1 K4_skip
    s_waitcnt vmcnt(5)
    v_max3_u32 v166, v0, v1, v2
    v_max3_u32 v166, v166, v3, v4
    v_max3_u32 v166, v166, v5, v6
    v_max3_u32 v166, v166, v7, v8
    v_max3_u32 v166, v166, v9, v10
    v_max3_u32 v166, v166, v11, v12
    v_max3_u32 v166, v166, v13, v14
    v_max_u32 v166, v166, v15
    v_cmp_eq_u32 vcc, -1, v166
    s_nop 4
    s_cbranch_vccnz D0_spin
D0_ret:
    v_fma_mix_f32 v48, v4, 1.0, v0 op_sel_hi:[1,0,1]
    v_fma_mix_f32 v49, v4, 1.0, v0 op_sel:[1,0,1] op_sel_hi:[1,0,1]
    v_fma_mix_f32 v50, v5, 1.0, v1 op_sel_hi:[1,0,1]
    v_fma_mix_f32 v51, v5, 1.0, v1 op_sel:[1,0,1] op_sel_hi:[1,0,1]
    v_fma_mix_f32 v52, v6, 1.0, v2 op_sel_hi:[1,0,1]
    v_fma_mix_f32 v53, v6, 1.0, v2 op_sel:[1,0,1] op_sel_hi:[1,0,1]
    v_fma_mix_f32 v54, v7, 1.0, v3 op_sel_hi:[1,0,1]
    v_fma_mix_f32 v55, v7, 1.0, v3 op_sel:[1,0,1] op_sel_hi:[1,0,1]
    v_fma_mix_f32 v48, v8, 1.0, v48 op_sel_hi:[1,0,0]
    v_fma_mix_f32 v49, v8, 1.0, v49 op_sel:[1,0,0] op_sel_hi:[1,0,0]
    v_fma_mix_f32 v50, v9, 1.0, v50 op_sel_hi:[1,0,0]
    v_fma_mix_f32 v51, v9, 1.0, v51 op_sel:[1,0,0] op_sel_hi:[1,0,0]
    v_fma_mix_f32 v52, v10, 1.0, v52 op_sel_hi:[1,0,0]
    v_fma_mix_f32 v53, v10, 1.0, v53 op_sel:[1,0,0] op_sel_hi:[1,0,0]
    v_fma_mix_f32 v54, v11, 1.0, v54 op_sel_hi:[1,0,0]
    v_fma_mix_f32 v55, v11, 1.0, v55 op_sel:[1,0,0] op_sel_hi:[1,0,0]
    v_fma_mix_f32 v48, v12, 1.0, v48 op_sel_hi:[1,0,0]
    v_fma_mix_f32 v49, v12, 1.0, v49 op_sel:[1,0,0] op_sel_hi:[1,0,0]
    v_fma_mix_f32 v50, v13, 1.0, v50 op_sel_hi:[1,0,0]
    v_fma_mix_f32 v51, v13, 1.0, v51 op_sel:[1,0,0] op_sel_hi:[1,0,0]
    v_fma_mix_f32 v52, v14, 1.0, v52 op_sel_hi:[1,0,0]
    v_fma_mix_f32 v53, v14, 1.0, v53 op_sel:[1,0,0] op_sel_hi:[1,0,0]
    v_fma_mix_f32 v54, v15, 1.0, v54 op_sel_hi:[1,0,0]
    v_fma_mix_f32 v55, v15, 1.0, v55 op_sel:[1,0,0] op_sel_hi:[1,0,0]
    v_cvt_pk_bf16_f32 v72, v48, v49
    v_cvt_pk_bf16_f32 v73, v50, v51
    v_cvt_pk_bf16_f32 v74, v52, v53
    v_cvt_pk_bf16_f32 v75, v54, v55
    v_lshlrev_b32 v48, 16, v72
    v_and_b32 v49, s63, v72
    v_lshlrev_b32 v50, 16, v73
    v_and_b32 v51, s63, v73
    v_lshlrev_b32 v52, 16, v74
    v_and_b32 v53, s63, v74
    v_lshlrev_b32 v54, 16, v75
    v_and_b32 v55, s63, v75
    v_mul_f32 v80, 0xbfb8aa3b, v48
    v_mul_f32 v81, 0xbfb8aa3b, v49
    v_mul_f32 v82, 0xbfb8aa3b, v50
    v_mul_f32 v83, 0xbfb8aa3b, v51
    v_mul_f32 v84, 0xbfb8aa3b, v52
    v_mul_f32 v85, 0xbfb8aa3b, v53
    v_mul_f32 v86, 0xbfb8aa3b, v54
    v_mul_f32 v87, 0xbfb8aa3b, v55
    v_exp_f32 v80, v80
    v_exp_f32 v81, v81
    v_exp_f32 v82, v82
    v_exp_f32 v83, v83
    v_exp_f32 v84, v84
    v_exp_f32 v85, v85
    v_exp_f32 v86, v86
    v_exp_f32 v87, v87
    s_nop 0
    v_add_f32 v80, 1.0, v80
    v_add_f32 v81, 1.0, v81
    v_add_f32 v82, 1.0, v82
    v_add_f32 v83, 1.0, v83
    v_add_f32 v84, 1.0, v84
    v_add_f32 v85, 1.0, v85
    v_add_f32 v86, 1.0, v86
    v_add_f32 v87, 1.0, v87
    v_rcp_f32 v80, v80
    v_rcp_f32 v81, v81
    v_rcp_f32 v82, v82
    v_rcp_f32 v83, v83
    v_rcp_f32 v84, v84
    v_rcp_f32 v85, v85
    v_rcp_f32 v86, v86
    v_rcp_f32 v87, v87
    s_nop 0
    v_mul_f32 v48, v48, v80
    v_mul_f32 v49, v49, v81
    v_mul_f32 v50, v50, v82
    v_mul_f32 v51, v51, v83
    v_mul_f32 v52, v52, v84
    v_mul_f32 v53, v53, v85
    v_mul_f32 v54, v54, v86
    v_mul_f32 v55, v55, v87
    v_cvt_pk_bf16_f32 v72, v48, v49
    v_cvt_pk_bf16_f32 v73, v50, v51
    v_cvt_pk_bf16_f32 v74, v52, v53
    v_cvt_pk_bf16_f32 v75, v54, v55
    v_lshlrev_b32 v48, 16, v72
    v_and_b32 v49, s63, v72
    v_lshlrev_b32 v50, 16, v73
    v_and_b32 v51, s63, v73
    v_lshlrev_b32 v52, 16, v74
    v_and_b32 v53, s63, v74
    v_lshlrev_b32 v54, 16, v75
    v_and_b32 v55, s63, v75
    v_mul_f32 v48, v48, v180
    v_mul_f32 v49, v49, v181
    v_mul_f32 v50, v50, v182
    v_mul_f32 v51, v51, v183
    v_mul_f32 v52, v52, v184
    v_mul_f32 v53, v53, v185
    v_mul_f32 v54, v54, v186
    v_mul_f32 v55, v55, v187
    v_cvt_pk_bf16_f32 v72, v48, v49
    v_cvt_pk_bf16_f32 v73, v50, v51
    v_cvt_pk_bf16_f32 v74, v52, v53
    v_cvt_pk_bf16_f32 v75, v54, v55
    s_nop 1
    v_permlane16_swap_b32 v72, v74
    v_permlane16_swap_b32 v73, v75
    s_nop 1
    v_lshlrev_b32 v48, 16, v72
    v_and_b32 v49, s63, v72
    v_lshlrev_b32 v50, 16, v73
    v_and_b32 v51, s63, v73
    v_lshlrev_b32 v52, 16, v74
    v_and_b32 v53, s63, v74
    v_lshlrev_b32 v54, 16, v75
    v_and_b32 v55, s63, v75
    v_add_f32 v48, v48, v88
    v_add_f32 v49, v49, v89
    v_add_f32 v50, v50, v90
    v_add_f32 v51, v51, v91
    v_add_f32 v52, v52, v92
    v_add_f32 v53, v53, v93
    v_add_f32 v54, v54, v94
    v_add_f32 v55, v55, v95
    v_cvt_pk_bf16_f32 v88, v48, v49
    v_cvt_pk_bf16_f32 v89, v50, v51
    v_cvt_pk_bf16_f32 v90, v52, v53
    v_cvt_pk_bf16_f32 v91, v54, v55
    buffer_store_dwordx4 v[88:91], v160, s[20:23], s54 offen offset:0
K4_skip:
    s_waitcnt vmcnt(1)
    v_max3_u32 v166, v32, v33, v34
    v_max3_u32 v166, v166, v35, v36
    v_max3_u32 v166, v166, v37, v38
    v_max3_u32 v166, v166, v39, v40
    v_max3_u32 v166, v166, v41, v42
    v_max3_u32 v166, v166, v43, v44
    v_max3_u32 v166, v166, v45, v46
    v_max_u32 v166, v166, v47
    v_cmp_eq_u32 vcc, -1, v166
    s_nop 4
    s_cbranch_vccnz D2_spin
D2_ret:
    s_lshl_b32 s38, s32, 2
    s_add_u32 s38, s38, 57344
    v_mov_b32 v167, s38
    v_mov_b32 v168, s4
    ds_write_b32 v167, v168
    v_mov_b32 v170, 57344
    s_waitcnt lgkmcnt(0)
    v_fma_mix_f32 v64, v36, 1.0, v32 op_sel_hi:[1,0,1]
    v_fma_mix_f32 v65, v36, 1.0, v32 op_sel:[1,0,1] op_sel_hi:[1,0,1]
    v_fma_mix_f32 v66, v37, 1.0, v33 op_sel_hi:[1,0,1]
    v_fma_mix_f32 v67, v37, 1.0, v33 op_sel:[1,0,1] op_sel_hi:[1,0,1]
    v_fma_mix_f32 v68, v38, 1.0, v34 op_sel_hi:[1,0,1]
    v_fma_mix_f32 v69, v38, 1.0, v34 op_sel:[1,0,1] op_sel_hi:[1,0,1]
    v_fma_mix_f32 v70, v39, 1.0, v35 op_sel_hi:[1,0,1]
    v_fma_mix_f32 v71, v39, 1.0, v35 op_sel:[1,0,1] op_sel_hi:[1,0,1]
    v_fma_mix_f32 v64, v40, 1.0, v64 op_sel_hi:[1,0,0]
    v_fma_mix_f32 v65, v40, 1.0, v65 op_sel:[1,0,0] op_sel_hi:[1,0,0]
    v_fma_mix_f32 v66, v41, 1.0, v66 op_sel_hi:[1,0,0]
    v_fma_mix_f32 v67, v41, 1.0, v67 op_sel:[1,0,0] op_sel_hi:[1,0,0]
    v_fma_mix_f32 v68, v42, 1.0, v68 op_sel_hi:[1,0,0]
    v_fma_mix_f32 v69, v42, 1.0, v69 op_sel:[1,0,0] op_sel_hi:[1,0,0]
    v_fma_mix_f32 v70, v43, 1.0, v70 op_sel_hi:[1,0,0]
    v_fma_mix_f32 v71, v43, 1.0, v71 op_sel:[1,0,0] op_sel_hi:[1,0,0]
    v_fma_mix_f32 v64, v44, 1.0, v64 op_sel_hi:[1,0,0]
    v_fma_mix_f32 v65, v44, 1.0, v65 op_sel:[1,0,0] op_sel_hi:[1,0,0]
    v_fma_mix_f32 v66, v45, 1.0, v66 op_sel_hi:[1,0,0]
    v_fma_mix_f32 v67, v45, 1.0, v67 op_sel:[1,0,0] op_sel_hi:[1,0,0]
    v_fma_mix_f32 v68, v46, 1.0, v68 op_sel_hi:[1,0,0]
    v_fma_mix_f32 v69, v46, 1.0, v69 op_sel:[1,0,0] op_sel_hi:[1,0,0]
    v_fma_mix_f32 v70, v47, 1.0, v70 op_sel_hi:[1,0,0]
    v_fma_mix_f32 v71, v47, 1.0, v71 op_sel:[1,0,0] op_sel_hi:[1,0,0]
    v_cvt_pk_bf16_f32 v72, v64, v65
    v_cvt_pk_bf16_f32 v73, v66, v67
    v_cvt_pk_bf16_f32 v74, v68, v69
    v_cvt_pk_bf16_f32 v75, v70, v71
    v_lshlrev_b32 v64, 16, v72
    v_and_b32 v65, s63, v72
    v_lshlrev_b32 v66, 16, v73
    v_and_b32 v67, s63, v73
    v_lshlrev_b32 v68, 16, v74
    v_and_b32 v69, s63, v74
    v_lshlrev_b32 v70, 16, v75
    v_and_b32 v71, s63, v75
    v_mul_f32 v80, 0xbfb8aa3b, v64
    v_mul_f32 v81, 0xbfb8aa3b, v65
    v_mul_f32 v82, 0xbfb8aa3b, v66
    v_mul_f32 v83, 0xbfb8aa3b, v67
    v_mul_f32 v84, 0xbfb8aa3b, v68
    v_mul_f32 v85, 0xbfb8aa3b, v69
    v_mul_f32 v86, 0xbfb8aa3b, v70
    v_mul_f32 v87, 0xbfb8aa3b, v71
    v_exp_f32 v80, v80
    v_exp_f32 v81, v81
    v_exp_f32 v82, v82
    v_exp_f32 v83, v83
    v_exp_f32 v84, v84
    v_exp_f32 v85, v85
    v_exp_f32 v86, v86
    v_exp_f32 v87, v87
    s_nop 0
    v_add_f32 v80, 1.0, v80
    v_add_f32 v81, 1.0, v81
    v_add_f32 v82, 1.0, v82
    v_add_f32 v83, 1.0, v83
    v_add_f32 v84, 1.0, v84
    v_add_f32 v85, 1.0, v85
    v_add_f32 v86, 1.0, v86
    v_add_f32 v87, 1.0, v87
    v_rcp_f32 v80, v80
    v_rcp_f32 v81, v81
    v_rcp_f32 v82, v82
    v_rcp_f32 v83, v83
    v_rcp_f32 v84, v84
    v_rcp_f32 v85, v85
    v_rcp_f32 v86, v86
    v_rcp_f32 v87, v87
    s_nop 0
    v_mul_f32 v64, v64, v80
    v_mul_f32 v65, v65, v81
    v_mul_f32 v66, v66, v82
    v_mul_f32 v67, v67, v83
    v_mul_f32 v68, v68, v84
    v_mul_f32 v69, v69, v85
    v_mul_f32 v70, v70, v86
    v_mul_f32 v71, v71, v87
    v_cvt_pk_bf16_f32 v72, v64, v65
    v_cvt_pk_bf16_f32 v73, v66, v67
    v_cvt_pk_bf16_f32 v74, v68, v69
    v_cvt_pk_bf16_f32 v75, v70, v71
    v_lshlrev_b32 v64, 16, v72
    v_and_b32 v65, s63, v72
    v_lshlrev_b32 v66, 16, v73
    v_and_b32 v67, s63, v73
    v_lshlrev_b32 v68, 16, v74
    v_and_b32 v69, s63, v74
    v_lshlrev_b32 v70, 16, v75
    v_and_b32 v71, s63, v75
    v_mul_f32 v64, v64, v196
    v_mul_f32 v65, v65, v197
    v_mul_f32 v66, v66, v198
    v_mul_f32 v67, v67, v199
    v_mul_f32 v68, v68, v200
    v_mul_f32 v69, v69, v201
    v_mul_f32 v70, v70, v202
    v_mul_f32 v71, v71, v203
    v_cvt_pk_bf16_f32 v72, v64, v65
    v_cvt_pk_bf16_f32 v73, v66, v67
    v_cvt_pk_bf16_f32 v74, v68, v69
    v_cvt_pk_bf16_f32 v75, v70, v71
    s_nop 1
    v_permlane16_swap_b32 v72, v74
    v_permlane16_swap_b32 v73, v75
    s_nop 1
    v_lshlrev_b32 v64, 16, v72
    v_and_b32 v65, s63, v72
    v_lshlrev_b32 v66, 16, v73
    v_and_b32 v67, s63, v73
    v_lshlrev_b32 v68, 16, v74
    v_and_b32 v69, s63, v74
    v_lshlrev_b32 v70, 16, v75
    v_and_b32 v71, s63, v75
    v_add_f32 v64, v64, v104
    v_add_f32 v65, v65, v105
    v_add_f32 v66, v66, v106
    v_add_f32 v67, v67, v107
    v_add_f32 v68, v68, v108
    v_add_f32 v69, v69, v109
    v_add_f32 v70, v70, v110
    v_add_f32 v71, v71, v111
    v_cvt_pk_bf16_f32 v104, v64, v65
    v_cvt_pk_bf16_f32 v105, v66, v67
    v_cvt_pk_bf16_f32 v106, v68, v69
    v_cvt_pk_bf16_f32 v107, v70, v71
    buffer_store_dwordx4 v[104:107], v160, s[20:23], s52 offen offset:160
    s_barrier
    ds_read_b128 v[172:175], v170
    s_waitcnt lgkmcnt(0)
    v_or3_b32 v172, v172, v173, v174
    v_or_b32 v172, v172, v175
    v_cmp_le_u32 vcc, 0x200, v172
    s_nop 4
    s_cbranch_vccnz K3_abort
    s_cmp_eq_u32 s22, 0
    s_cbranch_scc1 K4_next
K3_done:
    s_endpgm
C2_spin:
    s_movk_i32 s66, 4000
    s_cmp_ge_u32 s4, 256
    s_cbranch_scc1 C2_ret
C2_loop:
    s_sleep 2
    buffer_load_dword v249, v248, s[92:95], s64 offen sc1
    s_waitcnt vmcnt(0)
    v_cmp_gt_u32 vcc, 2, v249
    s_sub_u32 s66, s66, 1
    s_nop 3
    s_cbranch_vccz C2_ret
    s_cbranch_scc0 C2_loop
    s_bitset1_b32 s4, 9
    s_mov_b32 s18, 0
    s_mov_b32 s26, 0
    s_branch C2_ret
C3_spin:
    s_movk_i32 s66, 4000
    s_cmp_ge_u32 s4, 256
    s_cbranch_scc1 C3_ret
C3_loop:
    s_sleep 2
    buffer_load_dword v249, v248, s[92:95], s64 offen sc1
    s_waitcnt vmcnt(0)
    v_cmp_gt_u32 vcc, 3, v249
    s_sub_u32 s66, s66, 1
    s_nop 3
    s_cbranch_vccz C3_ret
    s_cbranch_scc0 C3_loop
    s_bitset1_b32 s4, 9
    s_mov_b32 s18, 0
    s_mov_b32 s26, 0
    s_branch C3_ret
C4_spin:
    s_movk_i32 s66, 4000
    s_cmp_ge_u32 s4, 256
    s_cbranch_scc1 C4_ret
C4_loop:
    s_sleep 2
    buffer_load_dword v251, v250, s[92:95], s65 offen sc1
    s_waitcnt vmcnt(0)
    v_cmp_gt_u32 vcc, 3, v251
    s_sub_u32 s66, s66, 1
    s_nop 3
    s_cbranch_vccz C4_ret
    s_cbranch_scc0 C4_loop
    s_bitset1_b32 s4, 9
    s_mov_b32 s18, 0
    s_mov_b32 s26, 0
    s_branch C4_ret
C7_spin:
    s_movk_i32 s66, 4000
    s_cmp_ge_u32 s4, 256
    s_cbranch_scc1 C7_ret
C7_loop:
    s_sleep 2
    buffer_load_dword v166, v165, s[84:87], 0 offen offset:4 sc1
    s_waitcnt vmcnt(0)
    v_cmp_gt_u32 vcc, 32, v166
    s_sub_u32 s66, s66, 1
    s_nop 3
    s_cbranch_vccz C7_ret
    s_cbranch_scc0 C7_loop
    s_bitset1_b32 s4, 9
    s_mov_b32 s58, 0
    s_branch C7_ret
C5_spin:
    s_movk_i32 s66, 4000
    s_cmp_ge_u32 s4, 256
    s_cbranch_scc1 C5_ret
C5_loop:
    s_sleep 2
    buffer_load_dword v164, v163, s[92:95], 0 offen sc1
    s_waitcnt vmcnt(0)
    v_cmp_gt_u32 vcc, 4, v164
    s_sub_u32 s66, s66, 1
    s_nop 3
    s_cbranch_vccz C5_ret
    s_cbranch_scc0 C5_loop
    s_bitset1_b32 s4, 9
    s_mov_b32 s30, 0
    s_branch C5_ret
D1_spin:
    s_movk_i32 s66, 3000
    s_cmp_eq_u32 s22, 0
    s_cbranch_scc1 D1_ret
    s_cmp_ge_u32 s90, 6
    s_cbranch_scc1 D1_ret
D1_loop:
    s_add_u32 s38, s55, 1024
    buffer_load_dwordx4 v[16:19], v149, s[12:15], s38 offen sc1
    s_add_u32 s38, s55, 2360320
    buffer_load_dwordx4 v[20:23], v149, s[12:15], s38 offen sc1
    s_add_u32 s38, s55, 4719616
    buffer_load_dwordx4 v[24:27], v149, s[12:15], s38 offen sc1
    s_add_u32 s38, s55, 7078912
    buffer_load_dwordx4 v[28:31], v149, s[12:15], s38 offen sc1
    s_waitcnt vmcnt(0)
    v_max3_u32 v166, v16, v17, v18
    v_max3_u32 v166, v166, v19, v20
    v_max3_u32 v166, v166, v21, v22
    v_max3_u32 v166, v166, v23, v24
    v_max3_u32 v166, v166, v25, v26
    v_max3_u32 v166, v166, v27, v28
    v_max3_u32 v166, v166, v29, v30
    v_max_u32 v166, v166, v31
    v_cmp_eq_u32 vcc, -1, v166
    s_sub_u32 s66, s66, 1
    s_nop 3
    s_cbranch_vccz D1_ret
    s_cbranch_scc0 D1_loop
    s_bitset1_b32 s4, 9
    s_branch D1_ret
D0_spin:
    s_movk_i32 s66, 3000
    s_cmp_eq_u32 s22, 0
    s_cbranch_scc1 D0_ret
    s_cmp_ge_u32 s90, 6
    s_cbranch_scc1 D0_ret
D0_loop:
    s_add_u32 s38, s60, 0
    buffer_load_dwordx4 v[0:3], v149, s[12:15], s38 offen sc1
    s_add_u32 s38, s60, 2359296
    buffer_load_dwordx4 v[4:7], v149, s[12:15], s38 offen sc1
    s_add_u32 s38, s60, 4718592
    buffer_load_dwordx4 v[8:11], v149, s[12:15], s38 offen sc1
    s_add_u32 s38, s60, 7077888
    buffer_load_dwordx4 v[12:15], v149, s[12:15], s38 offen sc1
    s_waitcnt vmcnt(0)
    v_max3_u32 v166, v0, v1, v2
    v_max3_u32 v166, v166, v3, v4
    v_max3_u32 v166, v166, v5, v6
    v_max3_u32 v166, v166, v7, v8
    v_max3_u32 v166, v166, v9, v10
    v_max3_u32 v166, v166, v11, v12
    v_max3_u32 v166, v166, v13, v14
    v_max_u32 v166, v166, v15
    v_cmp_eq_u32 vcc, -1, v166
    s_sub_u32 s66, s66, 1
    s_nop 3
    s_cbranch_vccz D0_ret
    s_cbranch_scc0 D0_loop
    s_bitset1_b32 s4, 9
    s_branch D0_ret
D2_spin:
    s_movk_i32 s66, 3000
    s_cmp_eq_u32 s22, 0
    s_cbranch_scc1 D2_ret
    s_cmp_ge_u32 s90, 6
    s_cbranch_scc1 D2_ret
D2_loop:
    s_add_u32 s38, s55, 5120
    buffer_load_dwordx4 v[32:35], v149, s[12:15], s38 offen sc1
    s_add_u32 s38, s55, 2364416
    buffer_load_dwordx4 v[36:39], v149, s[12:15], s38 offen sc1
    s_add_u32 s38, s55, 4723712
    buffer_load_dwordx4 v[40:43], v149, s[12:15], s38 offen sc1
    s_add_u32 s38, s55, 7083008
    buffer_load_dwordx4 v[44:47], v149, s[12:15], s38 offen sc1
    s_waitcnt vmcnt(0)
    v_max3_u32 v166, v32, v33, v34
    v_max3_u32 v166, v166, v35, v36
    v_max3_u32 v166, v166, v37, v38
    v_max3_u32 v166, v166, v39, v40
    v_max3_u32 v166, v166, v41, v42
    v_max3_u32 v166, v166, v43, v44
    v_max3_u32 v166, v166, v45, v46
    v_max_u32 v166, v166, v47
    v_cmp_eq_u32 vcc, -1, v166
    s_sub_u32 s66, s66, 1
    s_nop 3
    s_cbranch_vccz D2_ret
    s_cbranch_scc0 D2_loop
    s_bitset1_b32 s4, 9
    s_branch D2_ret
K4_next:
    s_waitcnt vmcnt(0) lgkmcnt(0)
    s_barrier
    s_add_u32 s2, s2, 1
    s_and_b32 s2, s2, 255
    s_lshl_b32 s38, s32, 6
    v_add_u32 v0, s38, v144
    s_branch K3_solo
K3_abort:
    s_waitcnt vmcnt(0) lgkmcnt(0)
    s_barrier
    s_or_b32 s4, s2, 0x100
    s_add_u32 s90, s90, 1
    s_mov_b32 s2, 0
    s_lshl_b32 s38, s32, 6
    v_add_u32 v0, s38, v144
    s_branch K1_task
K3_end:
.section .rodata,"a"
.p2align 6
KDS:
.p2align 6
.amdhsa_kernel gemm1_kernel
  .amdhsa_next_free_vgpr 512
  .amdhsa_next_free_sgpr 102
  .amdhsa_accum_offset 256
  .amdhsa_group_segment_fixed_size 0
  .amdhsa_kernarg_size 80
  .amdhsa_user_sgpr_count 2
  .amdhsa_user_sgpr_kernarg_segment_ptr 1
  .amdhsa_system_sgpr_workgroup_id_x 1
.end_amdhsa_kernel
```
